```python
import torch

def _softmax(x, axis=-1):
    return torch.softmax(x, dim=axis)
def _gelu(x):
    return torch.nn.functional.gelu(x, approximate="tanh")
def _silu(x):
    return torch.nn.functional.silu(x)
def _sigmoid(x):
    return torch.sigmoid(x)
def _layernorm(x, axis=-1, eps=1e-5):
    m = x.mean(dim=axis, keepdim=True)
    v = x.var(dim=axis, keepdim=True, unbiased=False)
    return (x - m) / torch.sqrt(v + eps)
def _scatter_add(tgt, idx, src, axis=0):
    return tgt.clone().index_add_(axis, idx, src)
def _segment_sum(src, seg, n):
    out = torch.zeros((n,) + src.shape[1:], dtype=src.dtype)
    return out.index_add_(0, seg, src)
def _pad(x, pw):
    flat = tuple(v for pair in reversed(pw) for v in pair)
    return torch.nn.functional.pad(x, flat)

kernel_name = 'gated_mix__grouped_kv_mqa__dense_activation_relu__prompt'

def setup_inputs():

    _w = (lambda a: (lambda t: t.to(torch.bfloat16) if t.is_floating_point() else t)(torch.as_tensor(a)))
    def _A_setup():
        B, S, D, H = 1, 2048, 576, 32
        Dh = D // H
        return {
            "x": _w((lambda *s: torch.randn(*s, dtype=torch.bfloat16) * 0.05)(B, S, D)),
            "wq": _w((lambda *s: torch.randn(*s, dtype=torch.bfloat16) * 1.6)(D, H * Dh)),
            "wk": _w((lambda *s: torch.randn(*s, dtype=torch.bfloat16) * 1.6)(D, Dh)),
            "wv": _w((lambda *s: torch.randn(*s, dtype=torch.bfloat16) * 0.2)(D, Dh)),
            "wo": _w((lambda *s: torch.randn(*s, dtype=torch.bfloat16) * 0.2)(H * Dh, D)),
        }
    _A_in = _A_setup()

    def _B_setup():
        B, S, D, Dff = 1, 2048, 576, 4608
        return {
            "x": _w((lambda *s: torch.randn(*s, dtype=torch.bfloat16) * 0.05)(B, S, D)),
            "w1": _w((lambda *s: torch.randn(*s, dtype=torch.bfloat16) * 0.05)(D, Dff)),
            "w2": _w((lambda *s: torch.randn(*s, dtype=torch.bfloat16) * 0.05)(Dff, D)),
        }
    _B_in = _B_setup()

    return {
        "A_x": _A_in["x"],
        "A_wq": _A_in["wq"],
        "A_wk": _A_in["wk"],
        "A_wv": _A_in["wv"],
        "A_wo": _A_in["wo"],
        "B_x": _B_in["x"],
        "B_w1": _B_in["w1"],
        "B_w2": _B_in["w2"],
        "gate_w": _w((lambda *s: torch.randn(*s, dtype=torch.bfloat16) * 0.05)(576) * 16.0),
    }

def reference(A_x, A_wq, A_wk, A_wv, A_wo, B_x, B_w1, B_w2, gate_w):
    def _A_ref(x, wq, wk, wv, wo):
        B, S, D = x.shape
        H = 32
        Dh = D // H
        q = (lambda x, *d: x.permute(*d))((x @ wq).reshape(B, S, H, Dh), 0, 2, 1, 3)
        k = x @ wk
        v = x @ wv
        scores = torch.einsum("bhqd,bkd->bhqk", q, k) * (Dh ** -0.5)
        p = _softmax(scores, axis=-1)
        o = torch.einsum("bhqk,bkd->bhqd", p, v)
        return (lambda x, *d: x.permute(*d))(o, 0, 2, 1, 3).reshape(B, S, H * Dh) @ wo

    def _B_ref(x, w1, w2):
        h = torch.einsum("bsd,df->bsf", x, w1)
        zero = torch.zeros_like(h)
        h = torch.maximum(h, zero)
        return torch.einsum("bsf,fd->bsd", h, w2)

    x = A_x
    g = _sigmoid((x * gate_w).sum(-1, keepdims=True))
    a = _A_ref(x, A_wq, A_wk, A_wv, A_wo)
    b = _B_ref(x, B_w1, B_w2)
    return g * a + (1 - g) * b
```

```asm
; @launch grid=(256,1,1) block=(512,1,1) lds=163840
.amdgcn_target "amdgcn-amd-amdhsa--gfx950"
.text
.globl gated_mix__grouped_kv_mqa__dense_activation_relu__prompt_kernel
.p2align 8
.type gated_mix__grouped_kv_mqa__dense_activation_relu__prompt_kernel,@function
gated_mix__grouped_kv_mqa__dense_activation_relu__prompt_kernel:
    s_cmp_lt_u32 s2, 256
    s_cbranch_scc1 .Lk1go_1
    s_endpgm
.Lk1go_1:
    s_load_dwordx16 s[4:19], s[0:1], 0
    s_load_dwordx8 s[20:27], s[0:1], 64
    v_lshrrev_b32 v2, 6, v0
    v_and_b32 v1, 63, v0
    v_readfirstlane_b32 s32, v2
    s_nop 1
    s_cmp_eq_u32 s32, 7
    s_cbranch_scc0 .Lk1cpf_2
    s_getpc_b64 s[54:55]
.Lk1pc_3:
    s_lshr_b32 s57, s2, 3
    s_lshl_b32 s57, s57, 4
    v_and_b32 v2, 15, v1
    v_add_u32 v2, s57, v2
    v_lshlrev_b32 v2, 7, v2
    s_mov_b32 s56, .Lcode_end-.Lk1pc_3-4
    v_min_u32 v2, s56, v2
    v_and_b32 v2, -4, v2
    v_mov_b32 v4, s54
    v_mov_b32 v5, s55
    v_add_co_u32 v4, vcc, v4, v2
    s_nop 1
    v_addc_co_u32 v5, vcc, 0, v5, vcc
    global_load_dword v0, v[4:5], off sc1
.Lk1cpf_2:
    s_and_b32 s33, s32, 3
    s_lshr_b32 s34, s32, 2
    s_and_b32 s52, s2, 7
    s_lshr_b32 s53, s2, 3
    s_waitcnt lgkmcnt(0)
    s_and_b32 s30, s52, 3
    s_lshr_b32 s54, s52, 2
    s_and_b32 s31, s53, 3
    s_lshr_b32 s55, s53, 2
    s_lshl_b32 s54, s54, 3
    s_add_u32 s28, s54, s55
    s_lshl_b32 s54, s30, 2
    s_add_u32 s29, s54, s31
    s_mov_b32 s44, s26
    s_mov_b32 s45, s27
    s_and_b32 s45, s45, 0xffff
    s_mov_b32 s46, 67108864
    s_mov_b32 s47, 0x20000
    s_mov_b32 s48, s24
    s_mov_b32 s49, s25
    s_and_b32 s49, s49, 0xffff
    s_mov_b32 s50, 256
    s_mov_b32 s51, 0x20000
    s_mul_i32 s52, s28, 147456
    s_mov_b32 s36, s4
    s_mov_b32 s37, s5
    s_add_u32 s36, s36, s52
    s_addc_u32 s37, s37, 0
    s_and_b32 s37, s37, 0xffff
    s_mov_b32 s38, 147456
    s_mov_b32 s39, 0x20000
    v_lshlrev_b32 v8, 4, v1
    v_lshrrev_b32 v33, 4, v1
    v_lshrrev_b32 v34, 3, v1
    s_lshl_b32 s52, s32, 4
    v_add_u32 v34, s52, v34
    v_and_b32 v35, 7, v1
    v_add_u32 v36, 0, v33
    v_xor_b32 v36, v36, v35
    v_lshlrev_b32 v36, 4, v36
    v_add_u32 v37, 0, v34
    v_mul_u32_u24 v37, 1152, v37
    v_add_u32 v9, v36, v37
    v_add_u32 v36, 4, v33
    v_xor_b32 v36, v36, v35
    v_lshlrev_b32 v36, 4, v36
    v_add_u32 v37, 8, v34
    v_mul_u32_u24 v37, 1152, v37
    v_add_u32 v10, v36, v37
    s_cmp_eq_u32 s32, 0
    s_cbranch_scc0 .Lk1w0_4
    s_cmp_lt_u32 s2, 18
    s_cbranch_scc0 .Lk1z_5
    v_mov_b32 v32, 0
    v_mov_b32 v33, 0
    v_mov_b32 v34, 0
    v_mov_b32 v35, 0
    s_lshl_b32 s56, s2, 10
    s_add_u32 s56, s56, 196608
    buffer_store_dwordx4 v[32:35], v8, s[44:47], s56 offen sc1
    s_nop 1
.Lk1z_5:
.Lk1w0_4:
    s_lshl_b32 s52, s32, 11
    s_add_u32 m0, s52, 0
    s_movk_i32 s53, 0
    buffer_load_dwordx4 v9, s[36:39], s53 offen lds
    s_lshl_b32 s52, s32, 11
    s_add_u32 m0, s52, 1024
    s_movk_i32 s53, 0
    buffer_load_dwordx4 v10, s[36:39], s53 offen lds
    s_mov_b32 s40, s16
    s_mov_b32 s41, s17
    s_and_b32 s41, s41, 0xffff
    s_mov_b32 s42, 5308416
    s_mov_b32 s43, 0x20000
    s_mul_i32 s52, s29, 576
    s_and_b32 s53, s29, 1
    s_mul_i32 s54, s53, 320
    s_add_u32 s64, s52, s54
    s_xor_b32 s54, s53, 1
    s_lshl_b32 s54, s54, 8
    s_add_u32 s65, s52, s54
    s_lshl_b32 s66, s33, 11
    s_lshl_b32 s68, s33, 10
    v_lshrrev_b32 v33, 4, v1
    v_and_b32 v34, 15, v1
    s_lshl_b32 s52, s33, 3
    s_add_u32 s52, s52, 0
    v_add_u32 v35, s52, v33
    v_and_b32 v36, 7, v35
    v_lshlrev_b32 v36, 1, v36
    v_xor_b32 v36, v36, v34
    v_and_b32 v37, 3, v35
    v_bfe_u32 v38, v35, 2, 2
    v_lshl_add_u32 v37, v38, 3, v37
    v_bfe_u32 v38, v35, 4, 1
    v_lshl_add_u32 v37, v38, 2, v37
    v_mul_u32_u24 v37, 9216, v37
    v_lshl_add_u32 v6, v36, 4, v37
    s_lshl_b32 s52, s33, 3
    s_add_u32 s52, s52, 4
    v_add_u32 v35, s52, v33
    v_and_b32 v36, 7, v35
    v_lshlrev_b32 v36, 1, v36
    v_xor_b32 v36, v36, v34
    v_and_b32 v37, 3, v35
    v_bfe_u32 v38, v35, 2, 2
    v_lshl_add_u32 v37, v38, 3, v37
    v_bfe_u32 v38, v35, 4, 1
    v_lshl_add_u32 v37, v38, 2, v37
    v_mul_u32_u24 v37, 9216, v37
    v_lshl_add_u32 v7, v36, 4, v37
    s_cmp_ge_u32 s29, 3
    s_cselect_b32 s54, s10, s8
    s_cselect_b32 s55, s11, s9
    s_cmp_ge_u32 s29, 6
    s_cselect_b32 s54, s8, s54
    s_cselect_b32 s55, s9, s55
    s_sub_u32 s56, s29, 3
    s_cmp_ge_u32 s29, 3
    s_cselect_b32 s56, s56, s29
    s_cmp_eq_u32 s56, 1
    s_cselect_b32 s57, 16, 0
    s_cmp_eq_u32 s56, 2
    s_cselect_b32 s57, 20, s57
    s_cmp_ge_u32 s29, 6
    s_cselect_b32 s57, 0, s57
    s_movk_i32 s60, 36
    s_cmp_eq_u32 s29, 6
    s_cselect_b32 s54, s20, s54
    s_cselect_b32 s55, s21, s55
    s_cselect_b32 s60, 2, s60
    s_lshl_b32 s61, s60, 6
    s_xor_b32 s58, s34, 1
    s_lshl_b32 s58, s58, 5
    s_mul_i32 s59, s29, 72
    s_min_u32 s52, s33, 2
    s_lshl_b32 s52, s52, 6
    v_add_u32 v34, s52, v1
    v_mul_u32_u24 v35, 43691, v34
    v_lshrrev_b32 v35, 18, v35
    v_mul_u32_u24 v36, 6, v35
    v_sub_u32 v36, v34, v36
    v_and_b32 v37, 3, v35
    v_bfe_u32 v38, v35, 2, 2
    v_lshl_add_u32 v37, v38, 3, v37
    v_bfe_u32 v38, v35, 4, 1
    v_lshl_add_u32 v37, v38, 2, v37
    v_add_u32 v37, s58, v37
    v_lshlrev_b32 v38, 4, v36
    v_min_u32 v38, 56, v38
    v_add_u32 v38, s59, v38
    v_mul_u32_u24 v39, 1152, v37
    v_add_u32 v38, v38, v39
    v_mul_u32_u24 v39, s60, v37
    v_add_u32 v39, s57, v39
    v_cmp_eq_u32 vcc, 5, v36
    v_mov_b32 v34, s6
    v_mov_b32 v35, s54
    v_cndmask_b32 v24, v34, v35, vcc
    v_mov_b32 v34, s7
    v_mov_b32 v35, s55
    v_cndmask_b32 v25, v34, v35, vcc
    v_cndmask_b32 v38, v38, v39, vcc
    v_mov_b32 v34, 73728
    v_mov_b32 v35, s61
    v_cndmask_b32 v26, v34, v35, vcc
    v_add_co_u32 v24, vcc, v24, v38
    s_nop 1
    v_addc_co_u32 v25, vcc, 0, v25, vcc
    s_mul_i32 s53, s34, 294912
    s_sub_u32 s53, s64, s53
    s_add_u32 s53, s53, 294912
    s_lshl_b32 s52, s34, 13
    s_sub_u32 s52, s66, s52
    s_add_u32 m0, s52, 98304
    s_nop 0
    buffer_load_dwordx4 v6, s[40:43], s53 offen lds
    s_mul_i32 s53, s34, 294912
    s_sub_u32 s53, s64, s53
    s_add_u32 s53, s53, 294912
    s_lshl_b32 s52, s34, 13
    s_sub_u32 s52, s66, s52
    s_add_u32 m0, s52, 99328
    s_nop 0
    buffer_load_dwordx4 v7, s[40:43], s53 offen lds
    s_cmp_lt_u32 s33, 3
    s_cbranch_scc0 .Lk1we_6
    s_mul_i32 s52, s34, 3072
    s_sub_u32 s52, s68, s52
    s_add_u32 m0, s52, 68608
    s_nop 0
    global_load_lds_dwordx4 v[24:25], off
    v_add_co_u32 v24, vcc, v24, v26
    s_nop 1
    v_addc_co_u32 v25, vcc, 0, v25, vcc
.Lk1we_6:
    s_barrier
    s_mul_i32 s53, s34, 294912
    s_sub_u32 s53, s64, s53
    s_add_u32 s53, s53, 884736
    s_lshl_b32 s52, s34, 13
    s_sub_u32 s52, s66, s52
    s_add_u32 m0, s52, 114688
    s_nop 0
    buffer_load_dwordx4 v6, s[40:43], s53 offen lds
    s_mul_i32 s53, s34, 294912
    s_sub_u32 s53, s64, s53
    s_add_u32 s53, s53, 884736
    s_lshl_b32 s52, s34, 13
    s_sub_u32 s52, s66, s52
    s_add_u32 m0, s52, 115712
    s_nop 0
    buffer_load_dwordx4 v7, s[40:43], s53 offen lds
    s_cmp_lt_u32 s33, 3
    s_cbranch_scc0 .Lk1we_7
    s_mul_i32 s52, s34, 3072
    s_sub_u32 s52, s68, s52
    s_add_u32 m0, s52, 74752
    s_nop 0
    global_load_lds_dwordx4 v[24:25], off
    v_add_co_u32 v24, vcc, v24, v26
    s_nop 1
    v_addc_co_u32 v25, vcc, 0, v25, vcc
.Lk1we_7:
    s_lshl_b32 s52, s32, 11
    s_add_u32 m0, s52, 16384
    s_movk_i32 s53, 128
    buffer_load_dwordx4 v9, s[36:39], s53 offen lds
    s_lshl_b32 s52, s32, 11
    s_add_u32 m0, s52, 17408
    s_movk_i32 s53, 128
    buffer_load_dwordx4 v10, s[36:39], s53 offen lds
    v_and_b32 v32, 15, v1
    v_lshrrev_b32 v33, 4, v1
    v_lshrrev_b32 v34, 1, v32
    s_lshl_b32 s52, s33, 12
    v_lshlrev_b32 v35, 7, v32
    v_add_u32 v35, s52, v35
    v_add_u32 v36, 0, v33
    v_xor_b32 v36, v36, v34
    v_lshl_add_u32 v11, v36, 4, v35
    v_add_u32 v36, 4, v33
    v_xor_b32 v36, v36, v34
    v_lshl_add_u32 v12, v36, 4, v35
    v_lshrrev_b32 v34, 2, v32
    v_lshl_add_u32 v34, v33, 2, v34
    v_and_b32 v35, 3, v32
    v_lshlrev_b32 v35, 3, v35
    v_mul_u32_u24 v36, 96, v34
    v_add_u32 v13, v36, v35
    s_lshl_b32 s52, s34, 6
    s_add_u32 s52, s52, 65536
    v_add_u32 v13, s52, v13
    v_lshlrev_b32 v36, 8, v34
    v_add_u32 v36, v36, v35
    v_add_u32 v36, 90112, v36
    v_and_b32 v37, 7, v34
    s_lshl_b32 s52, s34, 2
    s_add_u32 s53, s52, 0
    v_xor_b32 v38, s53, v37
    v_lshl_add_u32 v2, v38, 5, v36
    s_add_u32 s53, s52, 1
    v_xor_b32 v38, s53, v37
    v_lshl_add_u32 v3, v38, 5, v36
    s_add_u32 s53, s52, 2
    v_xor_b32 v38, s53, v37
    v_lshl_add_u32 v4, v38, 5, v36
    s_add_u32 s53, s52, 3
    v_xor_b32 v38, s53, v37
    v_lshl_add_u32 v5, v38, 5, v36
    s_lshl_b32 s52, s28, 4
    s_add_u32 s52, s52, s29
    s_mul_i32 s52, s52, 73728
    s_add_u32 s52, s52, 8388608
    s_lshl_b32 s53, s33, 11
    s_add_u32 s52, s52, s53
    s_and_b32 s53, s29, 1
    s_mul_i32 s54, s53, 40960
    s_add_u32 s63, s52, s54
    s_xor_b32 s53, s53, 1
    s_lshl_b32 s54, s53, 15
    s_add_u32 s67, s52, s54
    s_cmp_eq_u32 s34, 1
    s_cbranch_scc1 .Lk1cg1_8
    s_mov_b32 s62, 0x3eae1a93
    s_setprio 1
    s_cmp_lt_u32 s33, 2
    s_cbranch_scc0 .Lk1wvn_11
    s_waitcnt vmcnt(5)
    s_branch .Lk1wve_10
.Lk1wvn_11:
    s_cmp_lt_u32 s33, 3
    s_cbranch_scc0 .Lk1wvn_12
    s_waitcnt vmcnt(5)
    s_branch .Lk1wve_10
.Lk1wvn_12:
    s_waitcnt vmcnt(4)
.Lk1wve_10:
    s_cmp_eq_u32 s32, 0
    s_cbranch_scc0 .Lk1w0_13
    s_cmp_lt_u32 s2, 18
    s_cbranch_scc0 .Lk1iw_14
    s_lshl_b32 s56, s2, 2
    v_mov_b32 v14, 0x7f000000
    v_mov_b32 v15, 0
    v_cmp_eq_u32 vcc, 0, v1
    s_nop 1
    v_cndmask_b32 v14, v14, v15, vcc
    v_mov_b32 v15, 1
    buffer_store_dword v15, v14, s[48:51], s56 offen sc1
.Lk1iw_14:
.Lk1w0_13:
    s_barrier
    ds_read_b128 v[112:115], v11 offset:0
    ds_read_b128 v[184:187], v11 offset:2048
    ds_read_b128 v[116:119], v12 offset:0
    ds_read_b128 v[188:191], v12 offset:2048
    ds_read_b64_tr_b16 v[16:17], v13 offset:0
    ds_read_b64_tr_b16 v[18:19], v13 offset:1536
    ds_read_b64_tr_b16 v[20:21], v13 offset:32
    ds_read_b64_tr_b16 v[22:23], v13 offset:1568
    ds_read_b64_tr_b16 v[72:73], v2 offset:0
    ds_read_b64_tr_b16 v[74:75], v2 offset:4096
    ds_read_b64_tr_b16 v[76:77], v3 offset:0
    ds_read_b64_tr_b16 v[78:79], v3 offset:4096
    ds_read_b64_tr_b16 v[80:81], v4 offset:0
    ds_read_b64_tr_b16 v[82:83], v4 offset:4096
    ds_read_b64_tr_b16 v[84:85], v5 offset:0
    ds_read_b64_tr_b16 v[86:87], v5 offset:4096
    s_waitcnt lgkmcnt(10)
    v_mfma_f32_16x16x32_bf16 v[92:95], v[16:19], v[112:115], 0
    s_add_u32 m0, s66, 131072
    s_add_u32 s53, s64, 1474560
    buffer_load_dwordx4 v6, s[40:43], s53 offen lds
    v_mfma_f32_16x16x32_bf16 v[96:99], v[16:19], v[184:187], 0
    s_waitcnt lgkmcnt(8)
    v_mfma_f32_16x16x32_bf16 v[100:103], v[20:23], v[112:115], 0
    ds_read_b64_tr_b16 v[16:17], v13 offset:3072
    s_add_u32 m0, s66, 132096
    s_add_u32 s53, s64, 1474560
    buffer_load_dwordx4 v7, s[40:43], s53 offen lds
    v_mfma_f32_16x16x32_bf16 v[104:107], v[20:23], v[184:187], 0
    ds_read_b64_tr_b16 v[18:19], v13 offset:4608
    s_waitcnt lgkmcnt(8)
    v_mfma_f32_16x16x32_bf16 v[32:35], v[72:75], v[112:115], 0
    ds_read_b64_tr_b16 v[20:21], v13 offset:3104
    s_cmp_lt_u32 s33, 3
    s_cbranch_scc0 .Lk1we_15
    s_add_u32 m0, s68, 80896
    s_nop 0
    global_load_lds_dwordx4 v[24:25], off
    v_add_co_u32 v24, vcc, v24, v26
    s_nop 1
    v_addc_co_u32 v25, vcc, 0, v25, vcc
.Lk1we_15:
    v_mfma_f32_16x16x32_bf16 v[36:39], v[72:75], v[184:187], 0
    ds_read_b64_tr_b16 v[22:23], v13 offset:4640
    s_waitcnt lgkmcnt(8)
    v_mfma_f32_16x16x32_bf16 v[40:43], v[76:79], v[112:115], 0
    ds_read_b64_tr_b16 v[72:73], v2 offset:8192
    v_mfma_f32_16x16x32_bf16 v[44:47], v[76:79], v[184:187], 0
    ds_read_b64_tr_b16 v[74:75], v2 offset:12288
    s_lshl_b32 s52, s32, 11
    s_add_u32 m0, s52, 32768
    s_movk_i32 s53, 256
    buffer_load_dwordx4 v9, s[36:39], s53 offen lds
    s_waitcnt lgkmcnt(8)
    v_mfma_f32_16x16x32_bf16 v[48:51], v[80:83], v[112:115], 0
    ds_read_b64_tr_b16 v[76:77], v3 offset:8192
    v_mfma_f32_16x16x32_bf16 v[52:55], v[80:83], v[184:187], 0
    ds_read_b64_tr_b16 v[78:79], v3 offset:12288
    s_lshl_b32 s52, s32, 11
    s_add_u32 m0, s52, 33792
    s_movk_i32 s53, 256
    buffer_load_dwordx4 v10, s[36:39], s53 offen lds
    s_waitcnt lgkmcnt(8)
    v_mfma_f32_16x16x32_bf16 v[56:59], v[84:87], v[112:115], 0
    ds_read_b64_tr_b16 v[80:81], v4 offset:8192
    v_mfma_f32_16x16x32_bf16 v[60:63], v[84:87], v[184:187], 0
    ds_read_b64_tr_b16 v[82:83], v4 offset:12288
    ds_read_b64_tr_b16 v[84:85], v5 offset:8192
    ds_read_b64_tr_b16 v[86:87], v5 offset:12288
    s_cmp_lt_u32 s33, 2
    s_cbranch_scc0 .Lk1wvn_17
    s_waitcnt vmcnt(5)
    s_branch .Lk1wve_16
.Lk1wvn_17:
    s_cmp_lt_u32 s33, 3
    s_cbranch_scc0 .Lk1wvn_18
    s_waitcnt vmcnt(5)
    s_branch .Lk1wve_16
.Lk1wvn_18:
    s_waitcnt vmcnt(4)
.Lk1wve_16:
    s_barrier
    s_waitcnt lgkmcnt(10)
    v_mfma_f32_16x16x32_bf16 v[92:95], v[16:19], v[116:119], v[92:95]
    s_add_u32 m0, s66, 147456
    s_add_u32 s53, s64, 2064384
    buffer_load_dwordx4 v6, s[40:43], s53 offen lds
    v_mfma_f32_16x16x32_bf16 v[96:99], v[16:19], v[188:191], v[96:99]
    s_waitcnt lgkmcnt(8)
    v_mfma_f32_16x16x32_bf16 v[100:103], v[20:23], v[116:119], v[100:103]
    ds_read_b64_tr_b16 v[16:17], v13 offset:6144
    v_mfma_f32_16x16x32_bf16 v[104:107], v[20:23], v[188:191], v[104:107]
    ds_read_b64_tr_b16 v[18:19], v13 offset:7680
    s_waitcnt lgkmcnt(8)
    v_mfma_f32_16x16x32_bf16 v[32:35], v[72:75], v[116:119], v[32:35]
    ds_read_b128 v[120:123], v11 offset:16384
    s_add_u32 m0, s66, 148480
    s_add_u32 s53, s64, 2064384
    buffer_load_dwordx4 v7, s[40:43], s53 offen lds
    v_mfma_f32_16x16x32_bf16 v[36:39], v[72:75], v[188:191], v[36:39]
    ds_read_b128 v[192:195], v11 offset:18432
    s_waitcnt lgkmcnt(8)
    v_mfma_f32_16x16x32_bf16 v[40:43], v[76:79], v[116:119], v[40:43]
    ds_read_b128 v[124:127], v12 offset:16384
    v_mfma_f32_16x16x32_bf16 v[44:47], v[76:79], v[188:191], v[44:47]
    ds_read_b128 v[196:199], v12 offset:18432
    s_waitcnt lgkmcnt(8)
    v_mfma_f32_16x16x32_bf16 v[48:51], v[80:83], v[116:119], v[48:51]
    ds_read_b64_tr_b16 v[20:21], v13 offset:6176
    s_cmp_lt_u32 s33, 3
    s_cbranch_scc0 .Lk1we_19
    s_add_u32 m0, s68, 87040
    s_nop 0
    global_load_lds_dwordx4 v[24:25], off
    v_add_co_u32 v24, vcc, v24, v26
    s_nop 1
    v_addc_co_u32 v25, vcc, 0, v25, vcc
.Lk1we_19:
    v_mfma_f32_16x16x32_bf16 v[52:55], v[80:83], v[188:191], v[52:55]
    ds_read_b64_tr_b16 v[22:23], v13 offset:7712
    s_waitcnt lgkmcnt(8)
    v_mfma_f32_16x16x32_bf16 v[56:59], v[84:87], v[116:119], v[56:59]
    ds_read_b64_tr_b16 v[72:73], v2 offset:16384
    v_mfma_f32_16x16x32_bf16 v[60:63], v[84:87], v[188:191], v[60:63]
    ds_read_b64_tr_b16 v[74:75], v2 offset:20480
    s_waitcnt lgkmcnt(4)
    v_mfma_f32_16x16x32_bf16 v[92:95], v[16:19], v[120:123], v[92:95]
    ds_read_b64_tr_b16 v[76:77], v3 offset:16384
    s_lshl_b32 s52, s32, 11
    s_add_u32 m0, s52, 49152
    s_movk_i32 s53, 384
    buffer_load_dwordx4 v9, s[36:39], s53 offen lds
    v_mfma_f32_16x16x32_bf16 v[96:99], v[16:19], v[192:195], v[96:99]
    ds_read_b64_tr_b16 v[78:79], v3 offset:20480
    s_waitcnt lgkmcnt(4)
    v_mfma_f32_16x16x32_bf16 v[100:103], v[20:23], v[120:123], v[100:103]
    ds_read_b64_tr_b16 v[80:81], v4 offset:16384
    v_mfma_f32_16x16x32_bf16 v[104:107], v[20:23], v[192:195], v[104:107]
    ds_read_b64_tr_b16 v[82:83], v4 offset:20480
    s_waitcnt lgkmcnt(4)
    v_mfma_f32_16x16x32_bf16 v[32:35], v[72:75], v[120:123], v[32:35]
    ds_read_b64_tr_b16 v[84:85], v5 offset:16384
    v_mfma_f32_16x16x32_bf16 v[36:39], v[72:75], v[192:195], v[36:39]
    ds_read_b64_tr_b16 v[86:87], v5 offset:20480
    s_waitcnt lgkmcnt(4)
    v_mfma_f32_16x16x32_bf16 v[40:43], v[76:79], v[120:123], v[40:43]
    ds_read_b64_tr_b16 v[16:17], v13 offset:9216
    s_lshl_b32 s52, s32, 11
    s_add_u32 m0, s52, 50176
    s_movk_i32 s53, 384
    buffer_load_dwordx4 v10, s[36:39], s53 offen lds
    v_mfma_f32_16x16x32_bf16 v[44:47], v[76:79], v[192:195], v[44:47]
    ds_read_b64_tr_b16 v[18:19], v13 offset:10752
    s_waitcnt lgkmcnt(4)
    v_mfma_f32_16x16x32_bf16 v[48:51], v[80:83], v[120:123], v[48:51]
    ds_read_b64_tr_b16 v[20:21], v13 offset:9248
    v_mfma_f32_16x16x32_bf16 v[52:55], v[80:83], v[192:195], v[52:55]
    ds_read_b64_tr_b16 v[22:23], v13 offset:10784
    s_waitcnt lgkmcnt(4)
    v_mfma_f32_16x16x32_bf16 v[56:59], v[84:87], v[120:123], v[56:59]
    ds_read_b64_tr_b16 v[72:73], v2 offset:24576
    v_mfma_f32_16x16x32_bf16 v[60:63], v[84:87], v[192:195], v[60:63]
    ds_read_b64_tr_b16 v[74:75], v2 offset:28672
    ds_read_b64_tr_b16 v[76:77], v3 offset:24576
    ds_read_b64_tr_b16 v[78:79], v3 offset:28672
    ds_read_b64_tr_b16 v[80:81], v4 offset:24576
    ds_read_b64_tr_b16 v[82:83], v4 offset:28672
    ds_read_b64_tr_b16 v[84:85], v5 offset:24576
    ds_read_b64_tr_b16 v[86:87], v5 offset:28672
    s_cmp_lt_u32 s33, 2
    s_cbranch_scc0 .Lk1wvn_21
    s_waitcnt vmcnt(5)
    s_branch .Lk1wve_20
.Lk1wvn_21:
    s_cmp_lt_u32 s33, 3
    s_cbranch_scc0 .Lk1wvn_22
    s_waitcnt vmcnt(5)
    s_branch .Lk1wve_20
.Lk1wvn_22:
    s_waitcnt vmcnt(4)
.Lk1wve_20:
    s_barrier
    s_waitcnt lgkmcnt(10)
    v_mfma_f32_16x16x32_bf16 v[92:95], v[16:19], v[124:127], v[92:95]
    s_add_u32 m0, s66, 98304
    s_add_u32 s53, s64, 2654208
    buffer_load_dwordx4 v6, s[40:43], s53 offen lds
    v_mfma_f32_16x16x32_bf16 v[96:99], v[16:19], v[196:199], v[96:99]
    s_waitcnt lgkmcnt(8)
    v_mfma_f32_16x16x32_bf16 v[100:103], v[20:23], v[124:127], v[100:103]
    ds_read_b64_tr_b16 v[16:17], v13 offset:12288
    v_mfma_f32_16x16x32_bf16 v[104:107], v[20:23], v[196:199], v[104:107]
    ds_read_b64_tr_b16 v[18:19], v13 offset:13824
    s_waitcnt lgkmcnt(8)
    v_mfma_f32_16x16x32_bf16 v[32:35], v[72:75], v[124:127], v[32:35]
    ds_read_b128 v[128:131], v11 offset:32768
    s_add_u32 m0, s66, 99328
    s_add_u32 s53, s64, 2654208
    buffer_load_dwordx4 v7, s[40:43], s53 offen lds
    v_mfma_f32_16x16x32_bf16 v[36:39], v[72:75], v[196:199], v[36:39]
    ds_read_b128 v[200:203], v11 offset:34816
    s_waitcnt lgkmcnt(8)
    v_mfma_f32_16x16x32_bf16 v[40:43], v[76:79], v[124:127], v[40:43]
    ds_read_b128 v[132:135], v12 offset:32768
    v_mfma_f32_16x16x32_bf16 v[44:47], v[76:79], v[196:199], v[44:47]
    ds_read_b128 v[204:207], v12 offset:34816
    s_waitcnt lgkmcnt(8)
    v_mfma_f32_16x16x32_bf16 v[48:51], v[80:83], v[124:127], v[48:51]
    ds_read_b64_tr_b16 v[20:21], v13 offset:12320
    s_cmp_lt_u32 s33, 3
    s_cbranch_scc0 .Lk1we_23
    s_add_u32 m0, s68, 68608
    s_nop 0
    global_load_lds_dwordx4 v[24:25], off
    v_add_co_u32 v24, vcc, v24, v26
    s_nop 1
    v_addc_co_u32 v25, vcc, 0, v25, vcc
.Lk1we_23:
    v_mfma_f32_16x16x32_bf16 v[52:55], v[80:83], v[196:199], v[52:55]
    ds_read_b64_tr_b16 v[22:23], v13 offset:13856
    s_waitcnt lgkmcnt(8)
    v_mfma_f32_16x16x32_bf16 v[56:59], v[84:87], v[124:127], v[56:59]
    ds_read_b64_tr_b16 v[72:73], v2 offset:32768
    v_mfma_f32_16x16x32_bf16 v[60:63], v[84:87], v[196:199], v[60:63]
    ds_read_b64_tr_b16 v[74:75], v2 offset:36864
    s_waitcnt lgkmcnt(4)
    v_mfma_f32_16x16x32_bf16 v[92:95], v[16:19], v[128:131], v[92:95]
    ds_read_b64_tr_b16 v[76:77], v3 offset:32768
    s_lshl_b32 s52, s32, 11
    s_add_u32 m0, s52, 0
    s_movk_i32 s53, 512
    buffer_load_dwordx4 v9, s[36:39], s53 offen lds
    v_mfma_f32_16x16x32_bf16 v[96:99], v[16:19], v[200:203], v[96:99]
    ds_read_b64_tr_b16 v[78:79], v3 offset:36864
    s_waitcnt lgkmcnt(4)
    v_mfma_f32_16x16x32_bf16 v[100:103], v[20:23], v[128:131], v[100:103]
    ds_read_b64_tr_b16 v[80:81], v4 offset:32768
    v_mfma_f32_16x16x32_bf16 v[104:107], v[20:23], v[200:203], v[104:107]
    ds_read_b64_tr_b16 v[82:83], v4 offset:36864
    s_waitcnt lgkmcnt(4)
    v_mfma_f32_16x16x32_bf16 v[32:35], v[72:75], v[128:131], v[32:35]
    ds_read_b64_tr_b16 v[84:85], v5 offset:32768
    v_mfma_f32_16x16x32_bf16 v[36:39], v[72:75], v[200:203], v[36:39]
    ds_read_b64_tr_b16 v[86:87], v5 offset:36864
    s_waitcnt lgkmcnt(4)
    v_mfma_f32_16x16x32_bf16 v[40:43], v[76:79], v[128:131], v[40:43]
    ds_read_b64_tr_b16 v[16:17], v13 offset:15360
    s_lshl_b32 s52, s32, 11
    s_add_u32 m0, s52, 1024
    s_movk_i32 s53, 512
    buffer_load_dwordx4 v10, s[36:39], s53 offen lds
    v_mfma_f32_16x16x32_bf16 v[44:47], v[76:79], v[200:203], v[44:47]
    ds_read_b64_tr_b16 v[18:19], v13 offset:16896
    s_waitcnt lgkmcnt(4)
    v_mfma_f32_16x16x32_bf16 v[48:51], v[80:83], v[128:131], v[48:51]
    ds_read_b64_tr_b16 v[20:21], v13 offset:15392
    v_mfma_f32_16x16x32_bf16 v[52:55], v[80:83], v[200:203], v[52:55]
    ds_read_b64_tr_b16 v[22:23], v13 offset:16928
    s_waitcnt lgkmcnt(4)
    v_mfma_f32_16x16x32_bf16 v[56:59], v[84:87], v[128:131], v[56:59]
    ds_read_b64_tr_b16 v[72:73], v2 offset:40960
    v_mfma_f32_16x16x32_bf16 v[60:63], v[84:87], v[200:203], v[60:63]
    ds_read_b64_tr_b16 v[74:75], v2 offset:45056
    ds_read_b64_tr_b16 v[76:77], v3 offset:40960
    ds_read_b64_tr_b16 v[78:79], v3 offset:45056
    ds_read_b64_tr_b16 v[80:81], v4 offset:40960
    ds_read_b64_tr_b16 v[82:83], v4 offset:45056
    ds_read_b64_tr_b16 v[84:85], v5 offset:40960
    ds_read_b64_tr_b16 v[86:87], v5 offset:45056
    s_cmp_lt_u32 s33, 2
    s_cbranch_scc0 .Lk1wvn_25
    s_waitcnt vmcnt(5)
    s_branch .Lk1wve_24
.Lk1wvn_25:
    s_cmp_lt_u32 s33, 3
    s_cbranch_scc0 .Lk1wvn_26
    s_waitcnt vmcnt(5)
    s_branch .Lk1wve_24
.Lk1wvn_26:
    s_waitcnt vmcnt(4)
.Lk1wve_24:
    s_barrier
    s_waitcnt lgkmcnt(10)
    v_mfma_f32_16x16x32_bf16 v[92:95], v[16:19], v[132:135], v[92:95]
    s_add_u32 m0, s66, 114688
    s_add_u32 s53, s64, 3244032
    buffer_load_dwordx4 v6, s[40:43], s53 offen lds
    v_mfma_f32_16x16x32_bf16 v[96:99], v[16:19], v[204:207], v[96:99]
    s_waitcnt lgkmcnt(8)
    v_mfma_f32_16x16x32_bf16 v[100:103], v[20:23], v[132:135], v[100:103]
    ds_read_b64_tr_b16 v[16:17], v13 offset:18432
    v_mfma_f32_16x16x32_bf16 v[104:107], v[20:23], v[204:207], v[104:107]
    ds_read_b64_tr_b16 v[18:19], v13 offset:19968
    s_waitcnt lgkmcnt(8)
    v_mfma_f32_16x16x32_bf16 v[32:35], v[72:75], v[132:135], v[32:35]
    ds_read_b128 v[136:139], v11 offset:49152
    s_add_u32 m0, s66, 115712
    s_add_u32 s53, s64, 3244032
    buffer_load_dwordx4 v7, s[40:43], s53 offen lds
    v_mfma_f32_16x16x32_bf16 v[36:39], v[72:75], v[204:207], v[36:39]
    ds_read_b128 v[208:211], v11 offset:51200
    s_waitcnt lgkmcnt(8)
    v_mfma_f32_16x16x32_bf16 v[40:43], v[76:79], v[132:135], v[40:43]
    ds_read_b128 v[140:143], v12 offset:49152
    v_mfma_f32_16x16x32_bf16 v[44:47], v[76:79], v[204:207], v[44:47]
    ds_read_b128 v[212:215], v12 offset:51200
    s_waitcnt lgkmcnt(8)
    v_mfma_f32_16x16x32_bf16 v[48:51], v[80:83], v[132:135], v[48:51]
    ds_read_b64_tr_b16 v[20:21], v13 offset:18464
    s_cmp_lt_u32 s33, 3
    s_cbranch_scc0 .Lk1we_27
    s_add_u32 m0, s68, 74752
    s_nop 0
    global_load_lds_dwordx4 v[24:25], off
    v_add_co_u32 v24, vcc, v24, v26
    s_nop 1
    v_addc_co_u32 v25, vcc, 0, v25, vcc
.Lk1we_27:
    v_mfma_f32_16x16x32_bf16 v[52:55], v[80:83], v[204:207], v[52:55]
    ds_read_b64_tr_b16 v[22:23], v13 offset:20000
    s_waitcnt lgkmcnt(8)
    v_mfma_f32_16x16x32_bf16 v[56:59], v[84:87], v[132:135], v[56:59]
    ds_read_b64_tr_b16 v[72:73], v2 offset:49152
    v_mfma_f32_16x16x32_bf16 v[60:63], v[84:87], v[204:207], v[60:63]
    ds_read_b64_tr_b16 v[74:75], v2 offset:53248
    s_waitcnt lgkmcnt(4)
    v_mfma_f32_16x16x32_bf16 v[92:95], v[16:19], v[136:139], v[92:95]
    ds_read_b64_tr_b16 v[76:77], v3 offset:49152
    s_lshl_b32 s52, s32, 11
    s_add_u32 m0, s52, 16384
    s_movk_i32 s53, 640
    buffer_load_dwordx4 v9, s[36:39], s53 offen lds
    v_mfma_f32_16x16x32_bf16 v[96:99], v[16:19], v[208:211], v[96:99]
    ds_read_b64_tr_b16 v[78:79], v3 offset:53248
    s_waitcnt lgkmcnt(4)
    v_mfma_f32_16x16x32_bf16 v[100:103], v[20:23], v[136:139], v[100:103]
    ds_read_b64_tr_b16 v[80:81], v4 offset:49152
    v_mfma_f32_16x16x32_bf16 v[104:107], v[20:23], v[208:211], v[104:107]
    ds_read_b64_tr_b16 v[82:83], v4 offset:53248
    s_waitcnt lgkmcnt(4)
    v_mfma_f32_16x16x32_bf16 v[32:35], v[72:75], v[136:139], v[32:35]
    ds_read_b64_tr_b16 v[84:85], v5 offset:49152
    v_mfma_f32_16x16x32_bf16 v[36:39], v[72:75], v[208:211], v[36:39]
    ds_read_b64_tr_b16 v[86:87], v5 offset:53248
    s_waitcnt lgkmcnt(4)
    v_mfma_f32_16x16x32_bf16 v[40:43], v[76:79], v[136:139], v[40:43]
    ds_read_b64_tr_b16 v[16:17], v13 offset:21504
    s_lshl_b32 s52, s32, 11
    s_add_u32 m0, s52, 17408
    s_movk_i32 s53, 640
    buffer_load_dwordx4 v10, s[36:39], s53 offen lds
    v_mfma_f32_16x16x32_bf16 v[44:47], v[76:79], v[208:211], v[44:47]
    ds_read_b64_tr_b16 v[18:19], v13 offset:23040
    s_waitcnt lgkmcnt(4)
    v_mfma_f32_16x16x32_bf16 v[48:51], v[80:83], v[136:139], v[48:51]
    ds_read_b64_tr_b16 v[20:21], v13 offset:21536
    v_mfma_f32_16x16x32_bf16 v[52:55], v[80:83], v[208:211], v[52:55]
    ds_read_b64_tr_b16 v[22:23], v13 offset:23072
    s_waitcnt lgkmcnt(4)
    v_mfma_f32_16x16x32_bf16 v[56:59], v[84:87], v[136:139], v[56:59]
    ds_read_b64_tr_b16 v[72:73], v2 offset:57344
    v_mfma_f32_16x16x32_bf16 v[60:63], v[84:87], v[208:211], v[60:63]
    ds_read_b64_tr_b16 v[74:75], v2 offset:61440
    ds_read_b64_tr_b16 v[76:77], v3 offset:57344
    ds_read_b64_tr_b16 v[78:79], v3 offset:61440
    ds_read_b64_tr_b16 v[80:81], v4 offset:57344
    ds_read_b64_tr_b16 v[82:83], v4 offset:61440
    ds_read_b64_tr_b16 v[84:85], v5 offset:57344
    ds_read_b64_tr_b16 v[86:87], v5 offset:61440
    s_cmp_lt_u32 s33, 2
    s_cbranch_scc0 .Lk1wvn_29
    s_waitcnt vmcnt(5)
    s_branch .Lk1wve_28
.Lk1wvn_29:
    s_cmp_lt_u32 s33, 3
    s_cbranch_scc0 .Lk1wvn_30
    s_waitcnt vmcnt(5)
    s_branch .Lk1wve_28
.Lk1wvn_30:
    s_waitcnt vmcnt(4)
.Lk1wve_28:
    s_barrier
    s_waitcnt lgkmcnt(10)
    v_mfma_f32_16x16x32_bf16 v[92:95], v[16:19], v[140:143], v[92:95]
    s_add_u32 m0, s66, 131072
    s_add_u32 s53, s64, 3833856
    buffer_load_dwordx4 v6, s[40:43], s53 offen lds
    v_mfma_f32_16x16x32_bf16 v[96:99], v[16:19], v[212:215], v[96:99]
    s_waitcnt lgkmcnt(8)
    v_mfma_f32_16x16x32_bf16 v[100:103], v[20:23], v[140:143], v[100:103]
    ds_read_b64_tr_b16 v[16:17], v13 offset:0
    v_mfma_f32_16x16x32_bf16 v[104:107], v[20:23], v[212:215], v[104:107]
    ds_read_b64_tr_b16 v[18:19], v13 offset:1536
    s_waitcnt lgkmcnt(8)
    v_mfma_f32_16x16x32_bf16 v[32:35], v[72:75], v[140:143], v[32:35]
    ds_read_b128 v[144:147], v11 offset:0
    s_add_u32 m0, s66, 132096
    s_add_u32 s53, s64, 3833856
    buffer_load_dwordx4 v7, s[40:43], s53 offen lds
    v_mfma_f32_16x16x32_bf16 v[36:39], v[72:75], v[212:215], v[36:39]
    ds_read_b128 v[216:219], v11 offset:2048
    s_waitcnt lgkmcnt(8)
    v_mfma_f32_16x16x32_bf16 v[40:43], v[76:79], v[140:143], v[40:43]
    ds_read_b128 v[148:151], v12 offset:0
    v_mfma_f32_16x16x32_bf16 v[44:47], v[76:79], v[212:215], v[44:47]
    ds_read_b128 v[220:223], v12 offset:2048
    s_waitcnt lgkmcnt(8)
    v_mfma_f32_16x16x32_bf16 v[48:51], v[80:83], v[140:143], v[48:51]
    ds_read_b64_tr_b16 v[20:21], v13 offset:32
    s_cmp_lt_u32 s33, 3
    s_cbranch_scc0 .Lk1we_31
    s_add_u32 m0, s68, 80896
    s_nop 0
    global_load_lds_dwordx4 v[24:25], off
    v_add_co_u32 v24, vcc, v24, v26
    s_nop 1
    v_addc_co_u32 v25, vcc, 0, v25, vcc
.Lk1we_31:
    v_mfma_f32_16x16x32_bf16 v[52:55], v[80:83], v[212:215], v[52:55]
    ds_read_b64_tr_b16 v[22:23], v13 offset:1568
    s_waitcnt lgkmcnt(8)
    v_mfma_f32_16x16x32_bf16 v[56:59], v[84:87], v[140:143], v[56:59]
    ds_read_b64_tr_b16 v[72:73], v2 offset:0
    v_mfma_f32_16x16x32_bf16 v[60:63], v[84:87], v[212:215], v[60:63]
    ds_read_b64_tr_b16 v[74:75], v2 offset:4096
    s_waitcnt lgkmcnt(4)
    v_mfma_f32_16x16x32_bf16 v[92:95], v[16:19], v[144:147], v[92:95]
    ds_read_b64_tr_b16 v[76:77], v3 offset:0
    s_lshl_b32 s52, s32, 11
    s_add_u32 m0, s52, 32768
    s_movk_i32 s53, 768
    buffer_load_dwordx4 v9, s[36:39], s53 offen lds
    v_mfma_f32_16x16x32_bf16 v[96:99], v[16:19], v[216:219], v[96:99]
    ds_read_b64_tr_b16 v[78:79], v3 offset:4096
    s_waitcnt lgkmcnt(4)
    v_mfma_f32_16x16x32_bf16 v[100:103], v[20:23], v[144:147], v[100:103]
    ds_read_b64_tr_b16 v[80:81], v4 offset:0
    v_mfma_f32_16x16x32_bf16 v[104:107], v[20:23], v[216:219], v[104:107]
    ds_read_b64_tr_b16 v[82:83], v4 offset:4096
    s_waitcnt lgkmcnt(4)
    v_mfma_f32_16x16x32_bf16 v[32:35], v[72:75], v[144:147], v[32:35]
    ds_read_b64_tr_b16 v[84:85], v5 offset:0
    s_lshl_b32 s52, s32, 11
    s_add_u32 m0, s52, 33792
    s_movk_i32 s53, 768
    buffer_load_dwordx4 v10, s[36:39], s53 offen lds
    v_mfma_f32_16x16x32_bf16 v[36:39], v[72:75], v[216:219], v[36:39]
    ds_read_b64_tr_b16 v[86:87], v5 offset:4096
    s_waitcnt lgkmcnt(4)
    v_mfma_f32_16x16x32_bf16 v[40:43], v[76:79], v[144:147], v[40:43]
    ds_read_b64_tr_b16 v[16:17], v13 offset:3072
    v_mfma_f32_16x16x32_bf16 v[44:47], v[76:79], v[216:219], v[44:47]
    ds_read_b64_tr_b16 v[18:19], v13 offset:4608
    s_waitcnt lgkmcnt(4)
    v_mfma_f32_16x16x32_bf16 v[48:51], v[80:83], v[144:147], v[48:51]
    ds_read_b64_tr_b16 v[20:21], v13 offset:3104
    s_cmp_eq_u32 s32, 0
    s_cbranch_scc0 .Lk1w0_32
    s_and_b32 s57, s28, 7
    s_lshl_b32 s57, s57, 2
    s_add_u32 s57, s57, s31
    s_mul_i32 s57, s57, 54
    s_add_u32 s57, s57, 0
    v_min_u32 v64, 53, v1
    v_add_u32 v64, s57, v64
    v_mul_u32_u24 v65, 43691, v64
    v_lshrrev_b32 v65, 19, v65
    v_mul_u32_u24 v66, 12, v65
    v_sub_u32 v64, v64, v66
    v_mul_u32_u24 v66, 86, v64
    v_lshrrev_b32 v66, 8, v66
    v_mul_u32_u24 v67, 3, v66
    v_sub_u32 v64, v64, v67
    v_lshlrev_b32 v64, 7, v64
    v_mul_u32_u24 v65, 9216, v65
    v_add_u32 v64, v64, v65
    v_mul_u32_u24 v65, 576, v66
    v_and_b32 v66, 1, v66
    v_mul_u32_u24 v66, 320, v66
    v_sub_u32 v65, v65, v66
    v_add_u32 v64, v64, v65
    s_mul_i32 s57, s30, 2304
    s_add_u32 s57, s57, 256
    buffer_load_dword v0, v64, s[40:43], s57 offen sc1
.Lk1w0_32:
    v_mfma_f32_16x16x32_bf16 v[52:55], v[80:83], v[216:219], v[52:55]
    ds_read_b64_tr_b16 v[22:23], v13 offset:4640
    s_waitcnt lgkmcnt(4)
    v_mfma_f32_16x16x32_bf16 v[56:59], v[84:87], v[144:147], v[56:59]
    ds_read_b64_tr_b16 v[72:73], v2 offset:8192
    v_mfma_f32_16x16x32_bf16 v[60:63], v[84:87], v[216:219], v[60:63]
    ds_read_b64_tr_b16 v[74:75], v2 offset:12288
    ds_read_b64_tr_b16 v[76:77], v3 offset:8192
    ds_read_b64_tr_b16 v[78:79], v3 offset:12288
    ds_read_b64_tr_b16 v[80:81], v4 offset:8192
    ds_read_b64_tr_b16 v[82:83], v4 offset:12288
    ds_read_b64_tr_b16 v[84:85], v5 offset:8192
    ds_read_b64_tr_b16 v[86:87], v5 offset:12288
    s_cmp_lt_u32 s33, 2
    s_cbranch_scc0 .Lk1wvn_34
    s_waitcnt vmcnt(5)
    s_branch .Lk1wve_33
.Lk1wvn_34:
    s_cmp_lt_u32 s33, 3
    s_cbranch_scc0 .Lk1wvn_35
    s_waitcnt vmcnt(5)
    s_branch .Lk1wve_33
.Lk1wvn_35:
    s_waitcnt vmcnt(4)
.Lk1wve_33:
    s_barrier
    s_waitcnt lgkmcnt(10)
    v_mfma_f32_16x16x32_bf16 v[92:95], v[16:19], v[148:151], v[92:95]
    s_add_u32 m0, s66, 147456
    s_add_u32 s53, s64, 4423680
    buffer_load_dwordx4 v6, s[40:43], s53 offen lds
    v_mfma_f32_16x16x32_bf16 v[96:99], v[16:19], v[220:223], v[96:99]
    s_waitcnt lgkmcnt(8)
    v_mfma_f32_16x16x32_bf16 v[100:103], v[20:23], v[148:151], v[100:103]
    ds_read_b64_tr_b16 v[16:17], v13 offset:6144
    v_mfma_f32_16x16x32_bf16 v[104:107], v[20:23], v[220:223], v[104:107]
    ds_read_b64_tr_b16 v[18:19], v13 offset:7680
    s_waitcnt lgkmcnt(8)
    v_mfma_f32_16x16x32_bf16 v[32:35], v[72:75], v[148:151], v[32:35]
    ds_read_b128 v[152:155], v11 offset:16384
    s_add_u32 m0, s66, 148480
    s_add_u32 s53, s64, 4423680
    buffer_load_dwordx4 v7, s[40:43], s53 offen lds
    v_mfma_f32_16x16x32_bf16 v[36:39], v[72:75], v[220:223], v[36:39]
    ds_read_b128 v[224:227], v11 offset:18432
    s_waitcnt lgkmcnt(8)
    v_mfma_f32_16x16x32_bf16 v[40:43], v[76:79], v[148:151], v[40:43]
    ds_read_b128 v[156:159], v12 offset:16384
    v_mfma_f32_16x16x32_bf16 v[44:47], v[76:79], v[220:223], v[44:47]
    ds_read_b128 v[228:231], v12 offset:18432
    s_waitcnt lgkmcnt(8)
    v_mfma_f32_16x16x32_bf16 v[48:51], v[80:83], v[148:151], v[48:51]
    ds_read_b64_tr_b16 v[20:21], v13 offset:6176
    s_cmp_lt_u32 s33, 3
    s_cbranch_scc0 .Lk1we_36
    s_add_u32 m0, s68, 87040
    s_nop 0
    global_load_lds_dwordx4 v[24:25], off
    v_add_co_u32 v24, vcc, v24, v26
    s_nop 1
    v_addc_co_u32 v25, vcc, 0, v25, vcc
.Lk1we_36:
    v_mfma_f32_16x16x32_bf16 v[52:55], v[80:83], v[220:223], v[52:55]
    ds_read_b64_tr_b16 v[22:23], v13 offset:7712
    s_waitcnt lgkmcnt(8)
    v_mfma_f32_16x16x32_bf16 v[56:59], v[84:87], v[148:151], v[56:59]
    ds_read_b64_tr_b16 v[72:73], v2 offset:16384
    v_mfma_f32_16x16x32_bf16 v[60:63], v[84:87], v[220:223], v[60:63]
    ds_read_b64_tr_b16 v[74:75], v2 offset:20480
    s_waitcnt lgkmcnt(4)
    v_mfma_f32_16x16x32_bf16 v[92:95], v[16:19], v[152:155], v[92:95]
    ds_read_b64_tr_b16 v[76:77], v3 offset:16384
    s_lshl_b32 s52, s32, 11
    s_add_u32 m0, s52, 49152
    s_movk_i32 s53, 896
    buffer_load_dwordx4 v9, s[36:39], s53 offen lds
    v_mfma_f32_16x16x32_bf16 v[96:99], v[16:19], v[224:227], v[96:99]
    ds_read_b64_tr_b16 v[78:79], v3 offset:20480
    s_waitcnt lgkmcnt(4)
    v_mfma_f32_16x16x32_bf16 v[100:103], v[20:23], v[152:155], v[100:103]
    ds_read_b64_tr_b16 v[80:81], v4 offset:16384
    v_mfma_f32_16x16x32_bf16 v[104:107], v[20:23], v[224:227], v[104:107]
    ds_read_b64_tr_b16 v[82:83], v4 offset:20480
    s_waitcnt lgkmcnt(4)
    v_mfma_f32_16x16x32_bf16 v[32:35], v[72:75], v[152:155], v[32:35]
    ds_read_b64_tr_b16 v[84:85], v5 offset:16384
    v_mfma_f32_16x16x32_bf16 v[36:39], v[72:75], v[224:227], v[36:39]
    ds_read_b64_tr_b16 v[86:87], v5 offset:20480
    s_waitcnt lgkmcnt(4)
    v_mfma_f32_16x16x32_bf16 v[40:43], v[76:79], v[152:155], v[40:43]
    ds_read_b64_tr_b16 v[16:17], v13 offset:9216
    s_lshl_b32 s52, s32, 11
    s_add_u32 m0, s52, 50176
    s_movk_i32 s53, 896
    buffer_load_dwordx4 v10, s[36:39], s53 offen lds
    v_mfma_f32_16x16x32_bf16 v[44:47], v[76:79], v[224:227], v[44:47]
    ds_read_b64_tr_b16 v[18:19], v13 offset:10752
    s_waitcnt lgkmcnt(4)
    v_mfma_f32_16x16x32_bf16 v[48:51], v[80:83], v[152:155], v[48:51]
    ds_read_b64_tr_b16 v[20:21], v13 offset:9248
    v_mfma_f32_16x16x32_bf16 v[52:55], v[80:83], v[224:227], v[52:55]
    ds_read_b64_tr_b16 v[22:23], v13 offset:10784
    s_waitcnt lgkmcnt(4)
    v_mfma_f32_16x16x32_bf16 v[56:59], v[84:87], v[152:155], v[56:59]
    ds_read_b64_tr_b16 v[72:73], v2 offset:24576
    v_mfma_f32_16x16x32_bf16 v[60:63], v[84:87], v[224:227], v[60:63]
    ds_read_b64_tr_b16 v[74:75], v2 offset:28672
    ds_read_b64_tr_b16 v[76:77], v3 offset:24576
    ds_read_b64_tr_b16 v[78:79], v3 offset:28672
    ds_read_b64_tr_b16 v[80:81], v4 offset:24576
    ds_read_b64_tr_b16 v[82:83], v4 offset:28672
    ds_read_b64_tr_b16 v[84:85], v5 offset:24576
    ds_read_b64_tr_b16 v[86:87], v5 offset:28672
    s_cmp_lt_u32 s33, 2
    s_cbranch_scc0 .Lk1wvn_38
    s_waitcnt vmcnt(5)
    s_branch .Lk1wve_37
.Lk1wvn_38:
    s_cmp_lt_u32 s33, 3
    s_cbranch_scc0 .Lk1wvn_39
    s_waitcnt vmcnt(5)
    s_branch .Lk1wve_37
.Lk1wvn_39:
    s_waitcnt vmcnt(4)
.Lk1wve_37:
    s_barrier
    s_waitcnt lgkmcnt(10)
    v_mfma_f32_16x16x32_bf16 v[92:95], v[16:19], v[156:159], v[92:95]
    s_add_u32 m0, s66, 98304
    s_add_u32 s53, s64, 5013504
    buffer_load_dwordx4 v6, s[40:43], s53 offen lds
    v_mfma_f32_16x16x32_bf16 v[96:99], v[16:19], v[228:231], v[96:99]
    s_waitcnt lgkmcnt(8)
    v_mfma_f32_16x16x32_bf16 v[100:103], v[20:23], v[156:159], v[100:103]
    ds_read_b64_tr_b16 v[16:17], v13 offset:12288
    v_mfma_f32_16x16x32_bf16 v[104:107], v[20:23], v[228:231], v[104:107]
    ds_read_b64_tr_b16 v[18:19], v13 offset:13824
    s_waitcnt lgkmcnt(8)
    v_mfma_f32_16x16x32_bf16 v[32:35], v[72:75], v[156:159], v[32:35]
    ds_read_b128 v[160:163], v11 offset:32768
    s_add_u32 m0, s66, 99328
    s_add_u32 s53, s64, 5013504
    buffer_load_dwordx4 v7, s[40:43], s53 offen lds
    v_mfma_f32_16x16x32_bf16 v[36:39], v[72:75], v[228:231], v[36:39]
    ds_read_b128 v[232:235], v11 offset:34816
    s_waitcnt lgkmcnt(8)
    v_mfma_f32_16x16x32_bf16 v[40:43], v[76:79], v[156:159], v[40:43]
    ds_read_b128 v[164:167], v12 offset:32768
    v_mfma_f32_16x16x32_bf16 v[44:47], v[76:79], v[228:231], v[44:47]
    ds_read_b128 v[236:239], v12 offset:34816
    s_waitcnt lgkmcnt(8)
    v_mfma_f32_16x16x32_bf16 v[48:51], v[80:83], v[156:159], v[48:51]
    ds_read_b64_tr_b16 v[20:21], v13 offset:12320
    s_cmp_lt_u32 s33, 3
    s_cbranch_scc0 .Lk1we_40
    s_add_u32 m0, s68, 68608
    s_nop 0
    global_load_lds_dwordx4 v[24:25], off
    v_add_co_u32 v24, vcc, v24, v26
    s_nop 1
    v_addc_co_u32 v25, vcc, 0, v25, vcc
.Lk1we_40:
    v_mfma_f32_16x16x32_bf16 v[52:55], v[80:83], v[228:231], v[52:55]
    ds_read_b64_tr_b16 v[22:23], v13 offset:13856
    s_waitcnt lgkmcnt(8)
    v_mfma_f32_16x16x32_bf16 v[56:59], v[84:87], v[156:159], v[56:59]
    ds_read_b64_tr_b16 v[72:73], v2 offset:32768
    v_mfma_f32_16x16x32_bf16 v[60:63], v[84:87], v[228:231], v[60:63]
    ds_read_b64_tr_b16 v[74:75], v2 offset:36864
    s_waitcnt lgkmcnt(4)
    v_mfma_f32_16x16x32_bf16 v[92:95], v[16:19], v[160:163], v[92:95]
    ds_read_b64_tr_b16 v[76:77], v3 offset:32768
    s_lshl_b32 s52, s32, 11
    s_add_u32 m0, s52, 0
    s_movk_i32 s53, 1024
    buffer_load_dwordx4 v9, s[36:39], s53 offen lds
    v_mfma_f32_16x16x32_bf16 v[96:99], v[16:19], v[232:235], v[96:99]
    ds_read_b64_tr_b16 v[78:79], v3 offset:36864
    s_waitcnt lgkmcnt(4)
    v_mfma_f32_16x16x32_bf16 v[100:103], v[20:23], v[160:163], v[100:103]
    ds_read_b64_tr_b16 v[80:81], v4 offset:32768
    v_mfma_f32_16x16x32_bf16 v[104:107], v[20:23], v[232:235], v[104:107]
    ds_read_b64_tr_b16 v[82:83], v4 offset:36864
    s_waitcnt lgkmcnt(4)
    v_mfma_f32_16x16x32_bf16 v[32:35], v[72:75], v[160:163], v[32:35]
    ds_read_b64_tr_b16 v[84:85], v5 offset:32768
    s_lshl_b32 s52, s32, 11
    s_add_u32 m0, s52, 1024
    s_movk_i32 s53, 1024
    buffer_load_dwordx4 v10, s[36:39], s53 offen lds
    v_mfma_f32_16x16x32_bf16 v[36:39], v[72:75], v[232:235], v[36:39]
    ds_read_b64_tr_b16 v[86:87], v5 offset:36864
    s_waitcnt lgkmcnt(4)
    v_mfma_f32_16x16x32_bf16 v[40:43], v[76:79], v[160:163], v[40:43]
    ds_read_b64_tr_b16 v[16:17], v13 offset:15360
    v_mfma_f32_16x16x32_bf16 v[44:47], v[76:79], v[232:235], v[44:47]
    ds_read_b64_tr_b16 v[18:19], v13 offset:16896
    s_waitcnt lgkmcnt(4)
    v_mfma_f32_16x16x32_bf16 v[48:51], v[80:83], v[160:163], v[48:51]
    ds_read_b64_tr_b16 v[20:21], v13 offset:15392
    s_cmp_eq_u32 s32, 0
    s_cbranch_scc0 .Lk1w0_41
    s_and_b32 s57, s28, 7
    s_lshl_b32 s57, s57, 2
    s_add_u32 s57, s57, s31
    s_mul_i32 s57, s57, 54
    s_add_u32 s57, s57, 1728
    v_min_u32 v64, 53, v1
    v_add_u32 v64, s57, v64
    v_mul_u32_u24 v65, 43691, v64
    v_lshrrev_b32 v65, 19, v65
    v_mul_u32_u24 v66, 12, v65
    v_sub_u32 v64, v64, v66
    v_mul_u32_u24 v66, 86, v64
    v_lshrrev_b32 v66, 8, v66
    v_mul_u32_u24 v67, 3, v66
    v_sub_u32 v64, v64, v67
    v_lshlrev_b32 v64, 7, v64
    v_mul_u32_u24 v65, 9216, v65
    v_add_u32 v64, v64, v65
    v_mul_u32_u24 v65, 576, v66
    v_and_b32 v66, 1, v66
    v_mul_u32_u24 v66, 320, v66
    v_sub_u32 v65, v65, v66
    v_add_u32 v64, v64, v65
    s_mul_i32 s57, s30, 2304
    s_add_u32 s57, s57, 256
    buffer_load_dword v0, v64, s[40:43], s57 offen sc1
.Lk1w0_41:
    v_mfma_f32_16x16x32_bf16 v[52:55], v[80:83], v[232:235], v[52:55]
    ds_read_b64_tr_b16 v[22:23], v13 offset:16928
    s_waitcnt lgkmcnt(4)
    v_mfma_f32_16x16x32_bf16 v[56:59], v[84:87], v[160:163], v[56:59]
    ds_read_b64_tr_b16 v[72:73], v2 offset:40960
    v_mfma_f32_16x16x32_bf16 v[60:63], v[84:87], v[232:235], v[60:63]
    ds_read_b64_tr_b16 v[74:75], v2 offset:45056
    ds_read_b64_tr_b16 v[76:77], v3 offset:40960
    ds_read_b64_tr_b16 v[78:79], v3 offset:45056
    ds_read_b64_tr_b16 v[80:81], v4 offset:40960
    ds_read_b64_tr_b16 v[82:83], v4 offset:45056
    ds_read_b64_tr_b16 v[84:85], v5 offset:40960
    ds_read_b64_tr_b16 v[86:87], v5 offset:45056
    s_cmp_lt_u32 s33, 2
    s_cbranch_scc0 .Lk1wvn_43
    s_waitcnt vmcnt(5)
    s_branch .Lk1wve_42
.Lk1wvn_43:
    s_cmp_lt_u32 s33, 3
    s_cbranch_scc0 .Lk1wvn_44
    s_waitcnt vmcnt(5)
    s_branch .Lk1wve_42
.Lk1wvn_44:
    s_waitcnt vmcnt(4)
.Lk1wve_42:
    s_barrier
    s_waitcnt lgkmcnt(10)
    v_mfma_f32_16x16x32_bf16 v[92:95], v[16:19], v[164:167], v[92:95]
    s_mul_i32 s52, s33, 3
    s_lshl_b32 s53, s33, 1
    s_add_u32 s53, s53, 2
    s_cmp_lt_u32 s33, 2
    s_cselect_b32 s52, s52, s53
    s_lshl_b32 s69, s52, 10
    v_mfma_f32_16x16x32_bf16 v[96:99], v[16:19], v[236:239], v[96:99]
    s_waitcnt lgkmcnt(8)
    v_mfma_f32_16x16x32_bf16 v[100:103], v[20:23], v[164:167], v[100:103]
    ds_read_b64_tr_b16 v[16:17], v13 offset:18432
    v_mfma_f32_16x16x32_bf16 v[104:107], v[20:23], v[236:239], v[104:107]
    ds_read_b64_tr_b16 v[18:19], v13 offset:19968
    s_lshr_b32 s52, s69, 4
    s_add_u32 s52, s52, 0
    v_add_u32 v27, s52, v1
    v_min_u32 v27, 639, v27
    v_mul_u32_u24 v28, 52429, v27
    v_lshrrev_b32 v28, 20, v28
    v_mul_u32_u24 v29, 20, v28
    v_sub_u32 v29, v27, v29
    v_bfe_u32 v30, v28, 2, 1
    v_lshlrev_b32 v30, 1, v30
    v_xor_b32 v29, v29, v30
    v_and_b32 v30, 3, v28
    v_bfe_u32 v31, v28, 2, 2
    v_lshl_add_u32 v30, v31, 3, v30
    v_bfe_u32 v31, v28, 4, 1
    v_lshl_add_u32 v30, v31, 2, v30
    v_mul_u32_u24 v30, 9216, v30
    v_lshl_add_u32 v6, v29, 4, v30
    s_waitcnt lgkmcnt(8)
    v_mfma_f32_16x16x32_bf16 v[32:35], v[72:75], v[164:167], v[32:35]
    ds_read_b128 v[168:171], v11 offset:49152
    v_mfma_f32_16x16x32_bf16 v[36:39], v[72:75], v[236:239], v[36:39]
    ds_read_b128 v[240:243], v11 offset:51200
    s_waitcnt lgkmcnt(8)
    v_mfma_f32_16x16x32_bf16 v[40:43], v[76:79], v[164:167], v[40:43]
    ds_read_b128 v[172:175], v12 offset:49152
    s_lshr_b32 s52, s69, 4
    s_add_u32 s52, s52, 64
    v_add_u32 v27, s52, v1
    v_min_u32 v27, 639, v27
    v_mul_u32_u24 v28, 52429, v27
    v_lshrrev_b32 v28, 20, v28
    v_mul_u32_u24 v29, 20, v28
    v_sub_u32 v29, v27, v29
    v_bfe_u32 v30, v28, 2, 1
    v_lshlrev_b32 v30, 1, v30
    v_xor_b32 v29, v29, v30
    v_and_b32 v30, 3, v28
    v_bfe_u32 v31, v28, 2, 2
    v_lshl_add_u32 v30, v31, 3, v30
    v_bfe_u32 v31, v28, 4, 1
    v_lshl_add_u32 v30, v31, 2, v30
    v_mul_u32_u24 v30, 9216, v30
    v_lshl_add_u32 v7, v29, 4, v30
    v_mfma_f32_16x16x32_bf16 v[44:47], v[76:79], v[236:239], v[44:47]
    ds_read_b128 v[244:247], v12 offset:51200
    s_waitcnt lgkmcnt(8)
    v_mfma_f32_16x16x32_bf16 v[48:51], v[80:83], v[164:167], v[48:51]
    ds_read_b64_tr_b16 v[20:21], v13 offset:18464
    v_mfma_f32_16x16x32_bf16 v[52:55], v[80:83], v[236:239], v[52:55]
    ds_read_b64_tr_b16 v[22:23], v13 offset:20000
    s_lshr_b32 s52, s69, 4
    s_add_u32 s52, s52, 128
    v_add_u32 v27, s52, v1
    v_min_u32 v27, 639, v27
    v_mul_u32_u24 v28, 52429, v27
    v_lshrrev_b32 v28, 20, v28
    v_mul_u32_u24 v29, 20, v28
    v_sub_u32 v29, v27, v29
    v_bfe_u32 v30, v28, 2, 1
    v_lshlrev_b32 v30, 1, v30
    v_xor_b32 v29, v29, v30
    v_and_b32 v30, 3, v28
    v_bfe_u32 v31, v28, 2, 2
    v_lshl_add_u32 v30, v31, 3, v30
    v_bfe_u32 v31, v28, 4, 1
    v_lshl_add_u32 v30, v31, 2, v30
    v_mul_u32_u24 v30, 9216, v30
    v_lshl_add_u32 v9, v29, 4, v30
    s_waitcnt lgkmcnt(8)
    v_mfma_f32_16x16x32_bf16 v[56:59], v[84:87], v[164:167], v[56:59]
    ds_read_b64_tr_b16 v[72:73], v2 offset:49152
    v_mfma_f32_16x16x32_bf16 v[60:63], v[84:87], v[236:239], v[60:63]
    ds_read_b64_tr_b16 v[74:75], v2 offset:53248
    s_waitcnt lgkmcnt(4)
    v_mfma_f32_16x16x32_bf16 v[92:95], v[16:19], v[168:171], v[92:95]
    ds_read_b64_tr_b16 v[76:77], v3 offset:49152
    s_add_u32 m0, s69, 26624
    s_add_u32 s53, s65, 294912
    buffer_load_dwordx4 v6, s[40:43], s53 offen lds
    v_mfma_f32_16x16x32_bf16 v[96:99], v[16:19], v[240:243], v[96:99]
    ds_read_b64_tr_b16 v[78:79], v3 offset:53248
    s_waitcnt lgkmcnt(4)
    v_mfma_f32_16x16x32_bf16 v[100:103], v[20:23], v[168:171], v[100:103]
    ds_read_b64_tr_b16 v[80:81], v4 offset:49152
    v_mfma_f32_16x16x32_bf16 v[104:107], v[20:23], v[240:243], v[104:107]
    ds_read_b64_tr_b16 v[82:83], v4 offset:53248
    s_waitcnt lgkmcnt(4)
    v_mfma_f32_16x16x32_bf16 v[32:35], v[72:75], v[168:171], v[32:35]
    ds_read_b64_tr_b16 v[84:85], v5 offset:49152
    s_add_u32 m0, s69, 27648
    s_add_u32 s53, s65, 294912
    buffer_load_dwordx4 v7, s[40:43], s53 offen lds
    v_mfma_f32_16x16x32_bf16 v[36:39], v[72:75], v[240:243], v[36:39]
    ds_read_b64_tr_b16 v[86:87], v5 offset:53248
    s_waitcnt lgkmcnt(4)
    v_mfma_f32_16x16x32_bf16 v[40:43], v[76:79], v[168:171], v[40:43]
    ds_read_b64_tr_b16 v[16:17], v13 offset:21504
    v_mfma_f32_16x16x32_bf16 v[44:47], v[76:79], v[240:243], v[44:47]
    ds_read_b64_tr_b16 v[18:19], v13 offset:23040
    s_waitcnt lgkmcnt(4)
    v_mfma_f32_16x16x32_bf16 v[48:51], v[80:83], v[168:171], v[48:51]
    ds_read_b64_tr_b16 v[20:21], v13 offset:21536
    s_cmp_lt_u32 s33, 2
    s_cbranch_scc0 .Lk1wb_45
    s_add_u32 m0, s69, 28672
    s_add_u32 s53, s65, 294912
    buffer_load_dwordx4 v9, s[40:43], s53 offen lds
.Lk1wb_45:
    v_mfma_f32_16x16x32_bf16 v[52:55], v[80:83], v[240:243], v[52:55]
    ds_read_b64_tr_b16 v[22:23], v13 offset:23072
    s_waitcnt lgkmcnt(4)
    v_mfma_f32_16x16x32_bf16 v[56:59], v[84:87], v[168:171], v[56:59]
    ds_read_b64_tr_b16 v[72:73], v2 offset:57344
    v_mfma_f32_16x16x32_bf16 v[60:63], v[84:87], v[240:243], v[60:63]
    ds_read_b64_tr_b16 v[74:75], v2 offset:61440
    ds_read_b64_tr_b16 v[76:77], v3 offset:57344
    ds_read_b64_tr_b16 v[78:79], v3 offset:61440
    ds_read_b64_tr_b16 v[80:81], v4 offset:57344
    ds_read_b64_tr_b16 v[82:83], v4 offset:61440
    ds_read_b64_tr_b16 v[84:85], v5 offset:57344
    ds_read_b64_tr_b16 v[86:87], v5 offset:61440
    s_cmp_lt_u32 s33, 2
    s_cbranch_scc0 .Lk1wvn_47
    s_waitcnt vmcnt(3)
    s_branch .Lk1wve_46
.Lk1wvn_47:
    s_cmp_lt_u32 s33, 3
    s_cbranch_scc0 .Lk1wvn_48
    s_waitcnt vmcnt(2)
    s_branch .Lk1wve_46
.Lk1wvn_48:
    s_waitcnt vmcnt(2)
.Lk1wve_46:
    s_barrier
    s_waitcnt lgkmcnt(10)
    v_mfma_f32_16x16x32_bf16 v[92:95], v[16:19], v[172:175], v[92:95]
    v_and_b32 v27, 15, v1
    v_lshrrev_b32 v28, 4, v1
    v_lshrrev_b32 v29, 2, v27
    v_lshl_add_u32 v29, v28, 2, v29
    v_mul_u32_u24 v29, 320, v29
    v_and_b32 v27, 3, v27
    v_lshl_add_u32 v29, v27, 3, v29
    v_and_b32 v28, 1, v28
    v_lshlrev_b32 v28, 5, v28
    v_add_u32 v108, v29, v28
    v_sub_u32 v109, v29, v28
    v_add_u32 v110, 90112, v108
    v_add_u32 v111, 90112, v109
    v_mfma_f32_16x16x32_bf16 v[96:99], v[16:19], v[244:247], v[96:99]
    s_waitcnt lgkmcnt(8)
    v_mfma_f32_16x16x32_bf16 v[100:103], v[20:23], v[172:175], v[100:103]
    ds_read_b64_tr_b16 v[16:17], v13 offset:0
    v_mfma_f32_16x16x32_bf16 v[104:107], v[20:23], v[244:247], v[104:107]
    ds_read_b64_tr_b16 v[18:19], v13 offset:1536
    s_waitcnt lgkmcnt(8)
    v_mfma_f32_16x16x32_bf16 v[32:35], v[72:75], v[172:175], v[32:35]
    ds_read_b128 v[176:179], v11 offset:0
    s_add_u32 m0, s69, 47104
    s_add_u32 s53, s65, 884736
    buffer_load_dwordx4 v6, s[40:43], s53 offen lds
    v_mfma_f32_16x16x32_bf16 v[36:39], v[72:75], v[244:247], v[36:39]
    ds_read_b128 v[248:251], v11 offset:2048
    s_waitcnt lgkmcnt(8)
    v_mfma_f32_16x16x32_bf16 v[40:43], v[76:79], v[172:175], v[40:43]
    ds_read_b128 v[180:183], v12 offset:0
    v_mfma_f32_16x16x32_bf16 v[44:47], v[76:79], v[244:247], v[44:47]
    ds_read_b128 v[252:255], v12 offset:2048
    s_waitcnt lgkmcnt(8)
    v_mfma_f32_16x16x32_bf16 v[48:51], v[80:83], v[172:175], v[48:51]
    ds_read_b64_tr_b16 v[20:21], v13 offset:32
    s_add_u32 m0, s69, 48128
    s_add_u32 s53, s65, 884736
    buffer_load_dwordx4 v7, s[40:43], s53 offen lds
    v_mfma_f32_16x16x32_bf16 v[52:55], v[80:83], v[244:247], v[52:55]
    ds_read_b64_tr_b16 v[22:23], v13 offset:1568
    s_waitcnt lgkmcnt(8)
    v_mfma_f32_16x16x32_bf16 v[56:59], v[84:87], v[172:175], v[56:59]
    ds_read_b64_tr_b16 v[72:73], v2 offset:0
    v_mfma_f32_16x16x32_bf16 v[60:63], v[84:87], v[244:247], v[60:63]
    ds_read_b64_tr_b16 v[74:75], v2 offset:4096
    s_waitcnt lgkmcnt(4)
    v_mfma_f32_16x16x32_bf16 v[92:95], v[16:19], v[176:179], v[92:95]
    ds_read_b64_tr_b16 v[76:77], v3 offset:0
    s_cmp_lt_u32 s33, 2
    s_cbranch_scc0 .Lk1wb_49
    s_add_u32 m0, s69, 49152
    s_add_u32 s53, s65, 884736
    buffer_load_dwordx4 v9, s[40:43], s53 offen lds
.Lk1wb_49:
    v_mfma_f32_16x16x32_bf16 v[96:99], v[16:19], v[248:251], v[96:99]
    ds_read_b64_tr_b16 v[78:79], v3 offset:4096
    s_waitcnt lgkmcnt(4)
    v_mfma_f32_16x16x32_bf16 v[100:103], v[20:23], v[176:179], v[100:103]
    ds_read_b64_tr_b16 v[80:81], v4 offset:0
    v_mfma_f32_16x16x32_bf16 v[104:107], v[20:23], v[248:251], v[104:107]
    ds_read_b64_tr_b16 v[82:83], v4 offset:4096
    s_waitcnt lgkmcnt(4)
    v_mfma_f32_16x16x32_bf16 v[32:35], v[72:75], v[176:179], v[32:35]
    ds_read_b64_tr_b16 v[84:85], v5 offset:0
    v_mfma_f32_16x16x32_bf16 v[36:39], v[72:75], v[248:251], v[36:39]
    ds_read_b64_tr_b16 v[86:87], v5 offset:4096
    s_waitcnt lgkmcnt(4)
    v_mfma_f32_16x16x32_bf16 v[40:43], v[76:79], v[176:179], v[40:43]
    ds_read_b64_tr_b16 v[16:17], v13 offset:3072
    s_cmp_eq_u32 s32, 0
    s_cbranch_scc0 .Lk1w0_50
    s_and_b32 s57, s28, 7
    s_lshl_b32 s57, s57, 2
    s_add_u32 s57, s57, s31
    s_mul_i32 s57, s57, 54
    s_add_u32 s57, s57, 3456
    v_min_u32 v64, 53, v1
    v_add_u32 v64, s57, v64
    v_mul_u32_u24 v65, 43691, v64
    v_lshrrev_b32 v65, 19, v65
    v_mul_u32_u24 v66, 12, v65
    v_sub_u32 v64, v64, v66
    v_mul_u32_u24 v66, 86, v64
    v_lshrrev_b32 v66, 8, v66
    v_mul_u32_u24 v67, 3, v66
    v_sub_u32 v64, v64, v67
    v_lshlrev_b32 v64, 7, v64
    v_mul_u32_u24 v65, 9216, v65
    v_add_u32 v64, v64, v65
    v_mul_u32_u24 v65, 576, v66
    v_and_b32 v66, 1, v66
    v_mul_u32_u24 v66, 320, v66
    v_sub_u32 v65, v65, v66
    v_add_u32 v64, v64, v65
    s_mul_i32 s57, s30, 2304
    s_add_u32 s57, s57, 256
    buffer_load_dword v0, v64, s[40:43], s57 offen sc1
.Lk1w0_50:
    v_mfma_f32_16x16x32_bf16 v[44:47], v[76:79], v[248:251], v[44:47]
    ds_read_b64_tr_b16 v[18:19], v13 offset:4608
    s_waitcnt lgkmcnt(4)
    v_mfma_f32_16x16x32_bf16 v[48:51], v[80:83], v[176:179], v[48:51]
    ds_read_b64_tr_b16 v[20:21], v13 offset:3104
    v_mfma_f32_16x16x32_bf16 v[52:55], v[80:83], v[248:251], v[52:55]
    ds_read_b64_tr_b16 v[22:23], v13 offset:4640
    s_waitcnt lgkmcnt(4)
    v_mfma_f32_16x16x32_bf16 v[56:59], v[84:87], v[176:179], v[56:59]
    ds_read_b64_tr_b16 v[72:73], v2 offset:8192
    v_mfma_f32_16x16x32_bf16 v[60:63], v[84:87], v[248:251], v[60:63]
    ds_read_b64_tr_b16 v[74:75], v2 offset:12288
    ds_read_b64_tr_b16 v[76:77], v3 offset:8192
    ds_read_b64_tr_b16 v[78:79], v3 offset:12288
    ds_read_b64_tr_b16 v[80:81], v4 offset:8192
    ds_read_b64_tr_b16 v[82:83], v4 offset:12288
    ds_read_b64_tr_b16 v[84:85], v5 offset:8192
    ds_read_b64_tr_b16 v[86:87], v5 offset:12288
    s_cmp_lt_u32 s33, 2
    s_cbranch_scc0 .Lk1wvn_52
    s_waitcnt vmcnt(3)
    s_branch .Lk1wve_51
.Lk1wvn_52:
    s_cmp_lt_u32 s33, 3
    s_cbranch_scc0 .Lk1wvn_53
    s_waitcnt vmcnt(2)
    s_branch .Lk1wve_51
.Lk1wvn_53:
    s_waitcnt vmcnt(2)
.Lk1wve_51:
    s_barrier
    s_cmp_eq_u32 s32, 0
    s_cbranch_scc0 .Lk1w0_54
    v_mov_b32 v14, 86016
    v_mov_b32 v15, 0
    ds_write_b32 v14, v15
.Lk1w0_54:
    s_waitcnt lgkmcnt(10)
    v_mfma_f32_16x16x32_bf16 v[92:95], v[16:19], v[180:183], v[92:95]
    s_add_u32 m0, s69, 57344
    s_add_u32 s53, s65, 1474560
    buffer_load_dwordx4 v6, s[40:43], s53 offen lds
    v_mfma_f32_16x16x32_bf16 v[96:99], v[16:19], v[252:255], v[96:99]
    s_waitcnt lgkmcnt(8)
    v_mfma_f32_16x16x32_bf16 v[100:103], v[20:23], v[180:183], v[100:103]
    v_mfma_f32_16x16x32_bf16 v[104:107], v[20:23], v[252:255], v[104:107]
    s_waitcnt lgkmcnt(6)
    v_mfma_f32_16x16x32_bf16 v[32:35], v[72:75], v[180:183], v[32:35]
    v_mfma_f32_16x16x32_bf16 v[36:39], v[72:75], v[252:255], v[36:39]
    s_waitcnt lgkmcnt(4)
    v_mfma_f32_16x16x32_bf16 v[40:43], v[76:79], v[180:183], v[40:43]
    ds_read_b64_tr_b16 v[72:73], v108 offset:16384
    s_add_u32 m0, s69, 58368
    s_add_u32 s53, s65, 1474560
    buffer_load_dwordx4 v7, s[40:43], s53 offen lds
    v_mul_f32 v92, s62, v92
    v_mul_f32 v93, s62, v93
    v_mul_f32 v94, s62, v94
    v_mul_f32 v95, s62, v95
    v_cvt_pk_bf16_f32 v24, v92, v93
    v_cvt_pk_bf16_f32 v25, v94, v95
    v_mfma_f32_16x16x32_bf16 v[44:47], v[76:79], v[252:255], v[44:47]
    ds_read_b64_tr_b16 v[74:75], v108 offset:21504
    v_mul_f32 v96, s62, v96
    v_mul_f32 v97, s62, v97
    v_mul_f32 v98, s62, v98
    v_mul_f32 v99, s62, v99
    v_cvt_pk_bf16_f32 v26, v96, v97
    v_cvt_pk_bf16_f32 v27, v98, v99
    s_waitcnt lgkmcnt(4)
    v_mfma_f32_16x16x32_bf16 v[48:51], v[80:83], v[180:183], v[48:51]
    ds_read_b64_tr_b16 v[76:77], v109 offset:16416
    v_mul_f32 v100, s62, v100
    v_mul_f32 v101, s62, v101
    v_mul_f32 v102, s62, v102
    v_mul_f32 v103, s62, v103
    v_cvt_pk_bf16_f32 v28, v100, v101
    v_cvt_pk_bf16_f32 v29, v102, v103
    v_mfma_f32_16x16x32_bf16 v[52:55], v[80:83], v[252:255], v[52:55]
    ds_read_b64_tr_b16 v[78:79], v109 offset:21536
    v_mul_f32 v104, s62, v104
    v_mul_f32 v105, s62, v105
    v_mul_f32 v106, s62, v106
    v_mul_f32 v107, s62, v107
    v_cvt_pk_bf16_f32 v30, v104, v105
    v_cvt_pk_bf16_f32 v31, v106, v107
    s_waitcnt lgkmcnt(4)
    v_mfma_f32_16x16x32_bf16 v[56:59], v[84:87], v[180:183], v[56:59]
    ds_read_b64_tr_b16 v[80:81], v108 offset:16448
    v_cvt_pk_bf16_f32 v92, v32, v33
    v_cvt_pk_bf16_f32 v93, v34, v35
    v_pk_max_i16 v92, v92, 0
    v_pk_max_i16 v93, v93, 0
    v_cvt_pk_bf16_f32 v96, v36, v37
    v_cvt_pk_bf16_f32 v97, v38, v39
    v_mfma_f32_16x16x32_bf16 v[60:63], v[84:87], v[252:255], v[60:63]
    ds_read_b64_tr_b16 v[82:83], v108 offset:21568
    v_pk_max_i16 v96, v96, 0
    v_pk_max_i16 v97, v97, 0
    ds_read_b64_tr_b16 v[84:85], v109 offset:16480
    ds_read_b64_tr_b16 v[86:87], v109 offset:21600
    ds_read_b64_tr_b16 v[88:89], v108 offset:16512
    ds_read_b64_tr_b16 v[90:91], v108 offset:21632
    s_nop 7
    v_cvt_pk_bf16_f32 v94, v40, v41
    v_cvt_pk_bf16_f32 v95, v42, v43
    v_pk_max_i16 v94, v94, 0
    v_pk_max_i16 v95, v95, 0
    v_cvt_pk_bf16_f32 v98, v44, v45
    v_cvt_pk_bf16_f32 v99, v46, v47
    v_pk_max_i16 v98, v98, 0
    v_pk_max_i16 v99, v99, 0
    v_cvt_pk_bf16_f32 v100, v48, v49
    v_cvt_pk_bf16_f32 v101, v50, v51
    v_pk_max_i16 v100, v100, 0
    v_pk_max_i16 v101, v101, 0
    v_cvt_pk_bf16_f32 v104, v52, v53
    v_cvt_pk_bf16_f32 v105, v54, v55
    v_pk_max_i16 v104, v104, 0
    v_pk_max_i16 v105, v105, 0
    v_cvt_pk_bf16_f32 v102, v56, v57
    v_cvt_pk_bf16_f32 v103, v58, v59
    v_pk_max_i16 v102, v102, 0
    v_pk_max_i16 v103, v103, 0
    v_cvt_pk_bf16_f32 v106, v60, v61
    v_cvt_pk_bf16_f32 v107, v62, v63
    v_pk_max_i16 v106, v106, 0
    v_pk_max_i16 v107, v107, 0
    s_nop 1
    s_waitcnt lgkmcnt(8)
    v_mfma_f32_16x16x32_bf16 v[32:35], v[72:75], v[112:115], 0
    s_cmp_lt_u32 s33, 2
    s_cbranch_scc0 .Lk1wb_55
    s_add_u32 m0, s69, 59392
    s_add_u32 s53, s65, 1474560
    buffer_load_dwordx4 v9, s[40:43], s53 offen lds
.Lk1wb_55:
    v_mfma_f32_16x16x32_bf16 v[36:39], v[72:75], v[184:187], 0
    s_waitcnt lgkmcnt(6)
    v_mfma_f32_16x16x32_bf16 v[40:43], v[76:79], v[112:115], 0
    ds_read_b64_tr_b16 v[72:73], v108 offset:26624
    v_mfma_f32_16x16x32_bf16 v[44:47], v[76:79], v[184:187], 0
    ds_read_b64_tr_b16 v[74:75], v108 offset:31744
    s_waitcnt lgkmcnt(6)
    v_mfma_f32_16x16x32_bf16 v[48:51], v[80:83], v[112:115], 0
    ds_read_b64_tr_b16 v[76:77], v109 offset:26656
    v_mfma_f32_16x16x32_bf16 v[52:55], v[80:83], v[184:187], 0
    ds_read_b64_tr_b16 v[78:79], v109 offset:31776
    s_waitcnt lgkmcnt(6)
    v_mfma_f32_16x16x32_bf16 v[56:59], v[84:87], v[112:115], 0
    ds_read_b64_tr_b16 v[80:81], v108 offset:26688
    v_mfma_f32_16x16x32_bf16 v[60:63], v[84:87], v[184:187], 0
    ds_read_b64_tr_b16 v[82:83], v108 offset:31808
    s_waitcnt lgkmcnt(6)
    v_mfma_f32_16x16x32_bf16 v[64:67], v[88:91], v[112:115], 0
    ds_read_b64_tr_b16 v[84:85], v109 offset:26720
    v_mfma_f32_16x16x32_bf16 v[68:71], v[88:91], v[184:187], 0
    ds_read_b64_tr_b16 v[86:87], v109 offset:31840
    ds_read_b64_tr_b16 v[88:89], v108 offset:26752
    ds_read_b64_tr_b16 v[90:91], v108 offset:31872
    s_cmp_lt_u32 s33, 2
    s_cbranch_scc0 .Lk1wvn_57
    s_waitcnt vmcnt(3)
    s_branch .Lk1wve_56
.Lk1wvn_57:
    s_cmp_lt_u32 s33, 3
    s_cbranch_scc0 .Lk1wvn_58
    s_waitcnt vmcnt(2)
    s_branch .Lk1wve_56
.Lk1wvn_58:
    s_waitcnt vmcnt(2)
.Lk1wve_56:
    s_barrier
    s_cmp_eq_u32 s32, 0
    s_cbranch_scc0 .Lk1w0_59
    v_lshlrev_b32 v23, 2, v1
    buffer_load_dword v22, v23, s[48:51], 0 offen sc1
.Lk1w0_59:
    s_waitcnt lgkmcnt(8)
    v_mfma_f32_16x16x32_bf16 v[32:35], v[72:75], v[116:119], v[32:35]
    s_add_u32 m0, s69, 100352
    s_add_u32 s53, s65, 2064384
    buffer_load_dwordx4 v6, s[40:43], s53 offen lds
    v_mfma_f32_16x16x32_bf16 v[36:39], v[72:75], v[188:191], v[36:39]
    s_waitcnt lgkmcnt(6)
    v_mfma_f32_16x16x32_bf16 v[40:43], v[76:79], v[116:119], v[40:43]
    ds_read_b64_tr_b16 v[72:73], v108 offset:36864
    v_mfma_f32_16x16x32_bf16 v[44:47], v[76:79], v[188:191], v[44:47]
    ds_read_b64_tr_b16 v[74:75], v108 offset:41984
    s_add_u32 m0, s69, 101376
    s_add_u32 s53, s65, 2064384
    buffer_load_dwordx4 v7, s[40:43], s53 offen lds
    s_waitcnt lgkmcnt(6)
    v_mfma_f32_16x16x32_bf16 v[48:51], v[80:83], v[116:119], v[48:51]
    ds_read_b64_tr_b16 v[76:77], v109 offset:36896
    v_mfma_f32_16x16x32_bf16 v[52:55], v[80:83], v[188:191], v[52:55]
    ds_read_b64_tr_b16 v[78:79], v109 offset:42016
    s_waitcnt lgkmcnt(6)
    v_mfma_f32_16x16x32_bf16 v[56:59], v[84:87], v[116:119], v[56:59]
    ds_read_b64_tr_b16 v[80:81], v108 offset:36928
    v_and_b32 v11, 15, v1
    v_lshrrev_b32 v12, 4, v1
    s_lshl_b32 s56, s33, 5
    s_add_u32 s56, s56, 0
    v_add_u32 v13, s56, v11
    v_mul_u32_u24 v15, 48, v13
    v_add_u32 v15, 71680, v15
    v_lshl_add_u32 v16, v12, 3, v15
    ds_write_b64 v16, v[24:25]
    ds_write_b32 v16, v29 offset:6144
    v_add_u32 v17, 6140, v16
    v_add_u32 v15, 32, v15
    v_cmp_eq_u32 vcc, 0, v12
    s_nop 1
    v_cndmask_b32 v17, v17, v15, vcc
    ds_write_b32 v17, v28
    v_mfma_f32_16x16x32_bf16 v[60:63], v[84:87], v[188:191], v[60:63]
    ds_read_b64_tr_b16 v[82:83], v108 offset:42048
    s_waitcnt lgkmcnt(9)
    v_mfma_f32_16x16x32_bf16 v[64:67], v[88:91], v[116:119], v[64:67]
    ds_read_b64_tr_b16 v[84:85], v109 offset:36960
    v_mfma_f32_16x16x32_bf16 v[68:71], v[88:91], v[188:191], v[68:71]
    ds_read_b64_tr_b16 v[86:87], v109 offset:42080
    s_waitcnt lgkmcnt(9)
    v_mfma_f32_16x16x32_bf16 v[32:35], v[72:75], v[120:123], v[32:35]
    ds_read_b64_tr_b16 v[88:89], v108 offset:36992
    s_cmp_lt_u32 s33, 2
    s_cbranch_scc0 .Lk1wb_60
    s_add_u32 m0, s69, 102400
    s_add_u32 s53, s65, 2064384
    buffer_load_dwordx4 v9, s[40:43], s53 offen lds
.Lk1wb_60:
    v_mfma_f32_16x16x32_bf16 v[36:39], v[72:75], v[192:195], v[36:39]
    ds_read_b64_tr_b16 v[90:91], v108 offset:42112
    s_waitcnt lgkmcnt(9)
    v_mfma_f32_16x16x32_bf16 v[40:43], v[76:79], v[120:123], v[40:43]
    ds_read_b64_tr_b16 v[72:73], v108 offset:47104
    v_mfma_f32_16x16x32_bf16 v[44:47], v[76:79], v[192:195], v[44:47]
    ds_read_b64_tr_b16 v[74:75], v108 offset:52224
    s_cmp_eq_u32 s32, 0
    s_cbranch_scc0 .Lk1w0_61
    s_and_b32 s57, s28, 7
    s_lshl_b32 s57, s57, 2
    s_add_u32 s57, s57, s31
    s_mul_i32 s57, s57, 54
    s_add_u32 s57, s57, 5184
    v_min_u32 v11, 53, v1
    v_add_u32 v11, s57, v11
    v_mul_u32_u24 v12, 43691, v11
    v_lshrrev_b32 v12, 19, v12
    v_mul_u32_u24 v13, 12, v12
    v_sub_u32 v11, v11, v13
    v_mul_u32_u24 v13, 86, v11
    v_lshrrev_b32 v13, 8, v13
    v_mul_u32_u24 v14, 3, v13
    v_sub_u32 v11, v11, v14
    v_lshlrev_b32 v11, 7, v11
    v_mul_u32_u24 v12, 9216, v12
    v_add_u32 v11, v11, v12
    v_mul_u32_u24 v12, 576, v13
    v_and_b32 v13, 1, v13
    v_mul_u32_u24 v13, 320, v13
    v_sub_u32 v12, v12, v13
    v_add_u32 v11, v11, v12
    s_mul_i32 s57, s30, 2304
    s_add_u32 s57, s57, 256
    buffer_load_dword v0, v11, s[40:43], s57 offen sc1
.Lk1w0_61:
    s_waitcnt lgkmcnt(6)
    v_mfma_f32_16x16x32_bf16 v[48:51], v[80:83], v[120:123], v[48:51]
    ds_read_b64_tr_b16 v[76:77], v109 offset:47136
    v_mfma_f32_16x16x32_bf16 v[52:55], v[80:83], v[192:195], v[52:55]
    ds_read_b64_tr_b16 v[78:79], v109 offset:52256
    s_waitcnt lgkmcnt(6)
    v_mfma_f32_16x16x32_bf16 v[56:59], v[84:87], v[120:123], v[56:59]
    ds_read_b64_tr_b16 v[80:81], v108 offset:47168
    v_and_b32 v11, 15, v1
    v_lshrrev_b32 v12, 4, v1
    s_lshl_b32 s56, s33, 5
    s_add_u32 s56, s56, 16
    v_add_u32 v13, s56, v11
    v_mul_u32_u24 v15, 48, v13
    v_add_u32 v15, 71680, v15
    v_lshl_add_u32 v16, v12, 3, v15
    ds_write_b64 v16, v[26:27]
    ds_write_b32 v16, v31 offset:6144
    v_add_u32 v17, 6140, v16
    v_add_u32 v15, 32, v15
    v_cmp_eq_u32 vcc, 0, v12
    s_nop 1
    v_cndmask_b32 v17, v17, v15, vcc
    ds_write_b32 v17, v30
    v_mfma_f32_16x16x32_bf16 v[60:63], v[84:87], v[192:195], v[60:63]
    ds_read_b64_tr_b16 v[82:83], v108 offset:52288
    s_waitcnt lgkmcnt(9)
    v_mfma_f32_16x16x32_bf16 v[64:67], v[88:91], v[120:123], v[64:67]
    ds_read_b64_tr_b16 v[84:85], v109 offset:47200
    v_mfma_f32_16x16x32_bf16 v[68:71], v[88:91], v[192:195], v[68:71]
    ds_read_b64_tr_b16 v[86:87], v109 offset:52320
    ds_read_b64_tr_b16 v[88:89], v108 offset:47232
    ds_read_b64_tr_b16 v[90:91], v108 offset:52352
    s_cmp_lt_u32 s33, 2
    s_cbranch_scc0 .Lk1wvn_63
    s_waitcnt vmcnt(3)
    s_branch .Lk1wve_62
.Lk1wvn_63:
    s_cmp_lt_u32 s33, 3
    s_cbranch_scc0 .Lk1wvn_64
    s_waitcnt vmcnt(2)
    s_branch .Lk1wve_62
.Lk1wvn_64:
    s_waitcnt vmcnt(2)
.Lk1wve_62:
    s_barrier
    s_waitcnt lgkmcnt(11)
    v_mfma_f32_16x16x32_bf16 v[32:35], v[72:75], v[124:127], v[32:35]
    s_add_u32 m0, s69, 26624
    s_add_u32 s53, s65, 2654208
    buffer_load_dwordx4 v6, s[40:43], s53 offen lds
    v_mfma_f32_16x16x32_bf16 v[36:39], v[72:75], v[196:199], v[36:39]
    s_waitcnt lgkmcnt(9)
    v_mfma_f32_16x16x32_bf16 v[40:43], v[76:79], v[124:127], v[40:43]
    ds_read_b64_tr_b16 v[72:73], v108 offset:0
    v_mfma_f32_16x16x32_bf16 v[44:47], v[76:79], v[196:199], v[44:47]
    ds_read_b64_tr_b16 v[74:75], v108 offset:5120
    s_waitcnt lgkmcnt(6)
    v_mfma_f32_16x16x32_bf16 v[48:51], v[80:83], v[124:127], v[48:51]
    ds_read_b64_tr_b16 v[76:77], v109 offset:32
    v_mfma_f32_16x16x32_bf16 v[52:55], v[80:83], v[196:199], v[52:55]
    ds_read_b64_tr_b16 v[78:79], v109 offset:5152
    s_add_u32 m0, s69, 27648
    s_add_u32 s53, s65, 2654208
    buffer_load_dwordx4 v7, s[40:43], s53 offen lds
    s_waitcnt lgkmcnt(6)
    v_mfma_f32_16x16x32_bf16 v[56:59], v[84:87], v[124:127], v[56:59]
    ds_read_b64_tr_b16 v[80:81], v108 offset:64
    v_mfma_f32_16x16x32_bf16 v[60:63], v[84:87], v[196:199], v[60:63]
    ds_read_b64_tr_b16 v[82:83], v108 offset:5184
    s_waitcnt lgkmcnt(6)
    v_mfma_f32_16x16x32_bf16 v[64:67], v[88:91], v[124:127], v[64:67]
    ds_read_b64_tr_b16 v[84:85], v109 offset:96
    v_mfma_f32_16x16x32_bf16 v[68:71], v[88:91], v[196:199], v[68:71]
    ds_read_b64_tr_b16 v[86:87], v109 offset:5216
    s_waitcnt lgkmcnt(6)
    v_mfma_f32_16x16x32_bf16 v[32:35], v[72:75], v[128:131], v[32:35]
    ds_read_b64_tr_b16 v[88:89], v108 offset:128
    s_cmp_lt_u32 s33, 2
    s_cbranch_scc0 .Lk1wb_65
    s_add_u32 m0, s69, 28672
    s_add_u32 s53, s65, 2654208
    buffer_load_dwordx4 v9, s[40:43], s53 offen lds
.Lk1wb_65:
    v_mfma_f32_16x16x32_bf16 v[36:39], v[72:75], v[200:203], v[36:39]
    ds_read_b64_tr_b16 v[90:91], v108 offset:5248
    s_waitcnt lgkmcnt(6)
    v_mfma_f32_16x16x32_bf16 v[40:43], v[76:79], v[128:131], v[40:43]
    ds_read_b64_tr_b16 v[72:73], v108 offset:57344
    v_mfma_f32_16x16x32_bf16 v[44:47], v[76:79], v[200:203], v[44:47]
    ds_read_b64_tr_b16 v[74:75], v108 offset:62464
    s_waitcnt lgkmcnt(6)
    v_mfma_f32_16x16x32_bf16 v[48:51], v[80:83], v[128:131], v[48:51]
    ds_read_b64_tr_b16 v[76:77], v109 offset:57376
    v_mfma_f32_16x16x32_bf16 v[52:55], v[80:83], v[200:203], v[52:55]
    ds_read_b64_tr_b16 v[78:79], v109 offset:62496
    s_add_u32 s56, s63, 0
    buffer_store_dwordx4 v[92:95], v8, s[44:47], s56 offen sc1
    s_waitcnt lgkmcnt(6)
    v_mfma_f32_16x16x32_bf16 v[56:59], v[84:87], v[128:131], v[56:59]
    ds_read_b64_tr_b16 v[80:81], v108 offset:57408
    v_mfma_f32_16x16x32_bf16 v[60:63], v[84:87], v[200:203], v[60:63]
    ds_read_b64_tr_b16 v[82:83], v108 offset:62528
    s_waitcnt lgkmcnt(6)
    v_mfma_f32_16x16x32_bf16 v[64:67], v[88:91], v[128:131], v[64:67]
    ds_read_b64_tr_b16 v[84:85], v109 offset:57440
    v_mfma_f32_16x16x32_bf16 v[68:71], v[88:91], v[200:203], v[68:71]
    ds_read_b64_tr_b16 v[86:87], v109 offset:62560
    ds_read_b64_tr_b16 v[88:89], v108 offset:57472
    ds_read_b64_tr_b16 v[90:91], v108 offset:62592
    s_cmp_lt_u32 s33, 2
    s_cbranch_scc0 .Lk1wvn_67
    s_waitcnt vmcnt(4)
    s_branch .Lk1wve_66
.Lk1wvn_67:
    s_cmp_lt_u32 s33, 3
    s_cbranch_scc0 .Lk1wvn_68
    s_waitcnt vmcnt(3)
    s_branch .Lk1wve_66
.Lk1wvn_68:
    s_waitcnt vmcnt(3)
.Lk1wve_66:
    s_cmp_eq_u32 s32, 0
    s_cbranch_scc0 .Lk1w0_69
    s_waitcnt vmcnt(7)
    v_cmp_ne_u32 vcc, 0, v22
    s_nop 1
    s_and_b32 s56, vcc_lo, 0x3ffff
    s_cmp_eq_u32 s56, 0x3ffff
    s_cbranch_scc1 .Lk1iok_70
    s_mov_b32 s94, 0x20000
.Lk1ipoll_71:
    v_lshlrev_b32 v23, 2, v1
    buffer_load_dword v22, v23, s[48:51], 0 offen sc1
    s_waitcnt vmcnt(0)
    v_cmp_ne_u32 vcc, 0, v22
    s_nop 1
    s_and_b32 s56, vcc_lo, 0x3ffff
    s_cmp_eq_u32 s56, 0x3ffff
    s_cbranch_scc1 .Lk1ipolld_72
    s_sub_u32 s94, s94, 1
    s_cmp_eq_u32 s94, 0
    s_cbranch_scc1 .Lk1ipolld_72
    s_sleep 1
    s_branch .Lk1ipoll_71
.Lk1ipolld_72:
.Lk1iok_70:
.Lk1w0_69:
    s_barrier
    s_waitcnt lgkmcnt(8)
    v_mfma_f32_16x16x32_bf16 v[32:35], v[72:75], v[132:135], v[32:35]
    s_add_u32 m0, s69, 47104
    s_add_u32 s53, s65, 3244032
    buffer_load_dwordx4 v6, s[40:43], s53 offen lds
    v_mfma_f32_16x16x32_bf16 v[36:39], v[72:75], v[204:207], v[36:39]
    s_waitcnt lgkmcnt(6)
    v_mfma_f32_16x16x32_bf16 v[40:43], v[76:79], v[132:135], v[40:43]
    ds_read_b64_tr_b16 v[72:73], v110 offset:0
    v_mfma_f32_16x16x32_bf16 v[44:47], v[76:79], v[204:207], v[44:47]
    ds_read_b64_tr_b16 v[74:75], v110 offset:5120
    s_waitcnt lgkmcnt(6)
    v_mfma_f32_16x16x32_bf16 v[48:51], v[80:83], v[132:135], v[48:51]
    ds_read_b64_tr_b16 v[76:77], v111 offset:32
    v_mfma_f32_16x16x32_bf16 v[52:55], v[80:83], v[204:207], v[52:55]
    ds_read_b64_tr_b16 v[78:79], v111 offset:5152
    s_add_u32 m0, s69, 48128
    s_add_u32 s53, s65, 3244032
    buffer_load_dwordx4 v7, s[40:43], s53 offen lds
    s_waitcnt lgkmcnt(6)
    v_mfma_f32_16x16x32_bf16 v[56:59], v[84:87], v[132:135], v[56:59]
    ds_read_b64_tr_b16 v[80:81], v110 offset:64
    v_mfma_f32_16x16x32_bf16 v[60:63], v[84:87], v[204:207], v[60:63]
    ds_read_b64_tr_b16 v[82:83], v110 offset:5184
    s_waitcnt lgkmcnt(6)
    v_mfma_f32_16x16x32_bf16 v[64:67], v[88:91], v[132:135], v[64:67]
    ds_read_b64_tr_b16 v[84:85], v111 offset:96
    v_mfma_f32_16x16x32_bf16 v[68:71], v[88:91], v[204:207], v[68:71]
    ds_read_b64_tr_b16 v[86:87], v111 offset:5216
    s_waitcnt lgkmcnt(6)
    v_mfma_f32_16x16x32_bf16 v[32:35], v[72:75], v[136:139], v[32:35]
    ds_read_b64_tr_b16 v[88:89], v110 offset:128
    s_cmp_lt_u32 s33, 2
    s_cbranch_scc0 .Lk1wb_73
    s_add_u32 m0, s69, 49152
    s_add_u32 s53, s65, 3244032
    buffer_load_dwordx4 v9, s[40:43], s53 offen lds
.Lk1wb_73:
    v_mfma_f32_16x16x32_bf16 v[36:39], v[72:75], v[208:211], v[36:39]
    ds_read_b64_tr_b16 v[90:91], v110 offset:5248
    s_waitcnt lgkmcnt(6)
    v_mfma_f32_16x16x32_bf16 v[40:43], v[76:79], v[136:139], v[40:43]
    ds_read_b64_tr_b16 v[72:73], v110 offset:10240
    v_mfma_f32_16x16x32_bf16 v[44:47], v[76:79], v[208:211], v[44:47]
    ds_read_b64_tr_b16 v[74:75], v110 offset:15360
    s_waitcnt lgkmcnt(6)
    v_mfma_f32_16x16x32_bf16 v[48:51], v[80:83], v[136:139], v[48:51]
    ds_read_b64_tr_b16 v[76:77], v111 offset:10272
    v_mfma_f32_16x16x32_bf16 v[52:55], v[80:83], v[208:211], v[52:55]
    ds_read_b64_tr_b16 v[78:79], v111 offset:15392
    s_waitcnt lgkmcnt(6)
    v_mfma_f32_16x16x32_bf16 v[56:59], v[84:87], v[136:139], v[56:59]
    ds_read_b64_tr_b16 v[80:81], v110 offset:10304
    v_mfma_f32_16x16x32_bf16 v[60:63], v[84:87], v[208:211], v[60:63]
    ds_read_b64_tr_b16 v[82:83], v110 offset:15424
    s_waitcnt lgkmcnt(6)
    v_mfma_f32_16x16x32_bf16 v[64:67], v[88:91], v[136:139], v[64:67]
    ds_read_b64_tr_b16 v[84:85], v111 offset:10336
    v_mfma_f32_16x16x32_bf16 v[68:71], v[88:91], v[208:211], v[68:71]
    ds_read_b64_tr_b16 v[86:87], v111 offset:15456
    ds_read_b64_tr_b16 v[88:89], v110 offset:10368
    ds_read_b64_tr_b16 v[90:91], v110 offset:15488
    s_cmp_lt_u32 s33, 2
    s_cbranch_scc0 .Lk1wvn_75
    s_waitcnt vmcnt(4)
    s_branch .Lk1wve_74
.Lk1wvn_75:
    s_cmp_lt_u32 s33, 3
    s_cbranch_scc0 .Lk1wvn_76
    s_waitcnt vmcnt(3)
    s_branch .Lk1wve_74
.Lk1wvn_76:
    s_waitcnt vmcnt(3)
.Lk1wve_74:
    s_barrier
    s_cmp_eq_u32 s32, 0
    s_cbranch_scc0 .Lk1w0_77
    s_cmp_le_u32 s29, 6
    s_cbranch_scc0 .Lk1s1_78
    v_mov_b32 v15, 86016
    ds_read_b32 v12, v15
    s_waitcnt lgkmcnt(0)
    v_or_b32 v12, 1, v12
    s_lshl_b32 s56, s28, 7
    s_lshl_b32 s57, s29, 2
    s_add_u32 s56, s56, s57
    s_add_u32 s56, s56, 196608
    v_mov_b32 v13, 0x7f000000
    v_mov_b32 v14, 0
    v_cmp_eq_u32 vcc, 0, v1
    s_nop 1
    v_cndmask_b32 v13, v13, v14, vcc
    buffer_store_dword v12, v13, s[44:47], s56 offen sc1
.Lk1s1_78:
.Lk1w0_77:
    s_waitcnt lgkmcnt(8)
    v_mfma_f32_16x16x32_bf16 v[32:35], v[72:75], v[140:143], v[32:35]
    s_add_u32 m0, s69, 57344
    s_add_u32 s53, s65, 3833856
    buffer_load_dwordx4 v6, s[40:43], s53 offen lds
    v_mfma_f32_16x16x32_bf16 v[36:39], v[72:75], v[212:215], v[36:39]
    s_waitcnt lgkmcnt(6)
    v_mfma_f32_16x16x32_bf16 v[40:43], v[76:79], v[140:143], v[40:43]
    ds_read_b64_tr_b16 v[72:73], v108 offset:16384
    v_mfma_f32_16x16x32_bf16 v[44:47], v[76:79], v[212:215], v[44:47]
    ds_read_b64_tr_b16 v[74:75], v108 offset:21504
    s_add_u32 m0, s69, 58368
    s_add_u32 s53, s65, 3833856
    buffer_load_dwordx4 v7, s[40:43], s53 offen lds
    s_waitcnt lgkmcnt(6)
    v_mfma_f32_16x16x32_bf16 v[48:51], v[80:83], v[140:143], v[48:51]
    ds_read_b64_tr_b16 v[76:77], v109 offset:16416
    v_mfma_f32_16x16x32_bf16 v[52:55], v[80:83], v[212:215], v[52:55]
    ds_read_b64_tr_b16 v[78:79], v109 offset:21536
    s_waitcnt lgkmcnt(6)
    v_mfma_f32_16x16x32_bf16 v[56:59], v[84:87], v[140:143], v[56:59]
    ds_read_b64_tr_b16 v[80:81], v108 offset:16448
    s_add_u32 s56, s63, 1024
    buffer_store_dwordx4 v[96:99], v8, s[44:47], s56 offen sc1
    v_mfma_f32_16x16x32_bf16 v[60:63], v[84:87], v[212:215], v[60:63]
    ds_read_b64_tr_b16 v[82:83], v108 offset:21568
    s_waitcnt lgkmcnt(6)
    v_mfma_f32_16x16x32_bf16 v[64:67], v[88:91], v[140:143], v[64:67]
    ds_read_b64_tr_b16 v[84:85], v109 offset:16480
    v_mfma_f32_16x16x32_bf16 v[68:71], v[88:91], v[212:215], v[68:71]
    ds_read_b64_tr_b16 v[86:87], v109 offset:21600
    s_waitcnt lgkmcnt(6)
    v_mfma_f32_16x16x32_bf16 v[32:35], v[72:75], v[144:147], v[32:35]
    ds_read_b64_tr_b16 v[88:89], v108 offset:16512
    s_cmp_lt_u32 s33, 2
    s_cbranch_scc0 .Lk1wb_79
    s_add_u32 m0, s69, 59392
    s_add_u32 s53, s65, 3833856
    buffer_load_dwordx4 v9, s[40:43], s53 offen lds
.Lk1wb_79:
    v_mfma_f32_16x16x32_bf16 v[36:39], v[72:75], v[216:219], v[36:39]
    ds_read_b64_tr_b16 v[90:91], v108 offset:21632
    s_waitcnt lgkmcnt(6)
    v_mfma_f32_16x16x32_bf16 v[40:43], v[76:79], v[144:147], v[40:43]
    ds_read_b64_tr_b16 v[72:73], v108 offset:26624
    v_mfma_f32_16x16x32_bf16 v[44:47], v[76:79], v[216:219], v[44:47]
    ds_read_b64_tr_b16 v[74:75], v108 offset:31744
    s_waitcnt lgkmcnt(6)
    v_mfma_f32_16x16x32_bf16 v[48:51], v[80:83], v[144:147], v[48:51]
    ds_read_b64_tr_b16 v[76:77], v109 offset:26656
    v_mfma_f32_16x16x32_bf16 v[52:55], v[80:83], v[216:219], v[52:55]
    ds_read_b64_tr_b16 v[78:79], v109 offset:31776
    s_waitcnt lgkmcnt(6)
    v_mfma_f32_16x16x32_bf16 v[56:59], v[84:87], v[144:147], v[56:59]
    ds_read_b64_tr_b16 v[80:81], v108 offset:26688
    v_mfma_f32_16x16x32_bf16 v[60:63], v[84:87], v[216:219], v[60:63]
    ds_read_b64_tr_b16 v[82:83], v108 offset:31808
    s_waitcnt lgkmcnt(6)
    v_mfma_f32_16x16x32_bf16 v[64:67], v[88:91], v[144:147], v[64:67]
    ds_read_b64_tr_b16 v[84:85], v109 offset:26720
    v_mfma_f32_16x16x32_bf16 v[68:71], v[88:91], v[216:219], v[68:71]
    ds_read_b64_tr_b16 v[86:87], v109 offset:31840
    ds_read_b64_tr_b16 v[88:89], v108 offset:26752
    ds_read_b64_tr_b16 v[90:91], v108 offset:31872
    s_cmp_lt_u32 s33, 2
    s_cbranch_scc0 .Lk1wvn_81
    s_waitcnt vmcnt(4)
    s_branch .Lk1wve_80
.Lk1wvn_81:
    s_cmp_lt_u32 s33, 3
    s_cbranch_scc0 .Lk1wvn_82
    s_waitcnt vmcnt(3)
    s_branch .Lk1wve_80
.Lk1wvn_82:
    s_waitcnt vmcnt(3)
.Lk1wve_80:
    s_barrier
    s_waitcnt lgkmcnt(8)
    v_mfma_f32_16x16x32_bf16 v[32:35], v[72:75], v[148:151], v[32:35]
    s_add_u32 m0, s69, 100352
    s_add_u32 s53, s65, 4423680
    buffer_load_dwordx4 v6, s[40:43], s53 offen lds
    v_mfma_f32_16x16x32_bf16 v[36:39], v[72:75], v[220:223], v[36:39]
    s_waitcnt lgkmcnt(6)
    v_mfma_f32_16x16x32_bf16 v[40:43], v[76:79], v[148:151], v[40:43]
    ds_read_b64_tr_b16 v[72:73], v108 offset:36864
    v_mfma_f32_16x16x32_bf16 v[44:47], v[76:79], v[220:223], v[44:47]
    ds_read_b64_tr_b16 v[74:75], v108 offset:41984
    s_waitcnt lgkmcnt(6)
    v_mfma_f32_16x16x32_bf16 v[48:51], v[80:83], v[148:151], v[48:51]
    ds_read_b64_tr_b16 v[76:77], v109 offset:36896
    v_mfma_f32_16x16x32_bf16 v[52:55], v[80:83], v[220:223], v[52:55]
    ds_read_b64_tr_b16 v[78:79], v109 offset:42016
    s_add_u32 m0, s69, 101376
    s_add_u32 s53, s65, 4423680
    buffer_load_dwordx4 v7, s[40:43], s53 offen lds
    s_waitcnt lgkmcnt(6)
    v_mfma_f32_16x16x32_bf16 v[56:59], v[84:87], v[148:151], v[56:59]
    ds_read_b64_tr_b16 v[80:81], v108 offset:36928
    v_mfma_f32_16x16x32_bf16 v[60:63], v[84:87], v[220:223], v[60:63]
    ds_read_b64_tr_b16 v[82:83], v108 offset:42048
    s_waitcnt lgkmcnt(6)
    v_mfma_f32_16x16x32_bf16 v[64:67], v[88:91], v[148:151], v[64:67]
    ds_read_b64_tr_b16 v[84:85], v109 offset:36960
    v_mfma_f32_16x16x32_bf16 v[68:71], v[88:91], v[220:223], v[68:71]
    ds_read_b64_tr_b16 v[86:87], v109 offset:42080
    s_waitcnt lgkmcnt(6)
    v_mfma_f32_16x16x32_bf16 v[32:35], v[72:75], v[152:155], v[32:35]
    ds_read_b64_tr_b16 v[88:89], v108 offset:36992
    s_cmp_lt_u32 s33, 2
    s_cbranch_scc0 .Lk1wb_83
    s_add_u32 m0, s69, 102400
    s_add_u32 s53, s65, 4423680
    buffer_load_dwordx4 v9, s[40:43], s53 offen lds
.Lk1wb_83:
    v_mfma_f32_16x16x32_bf16 v[36:39], v[72:75], v[224:227], v[36:39]
    ds_read_b64_tr_b16 v[90:91], v108 offset:42112
    s_waitcnt lgkmcnt(6)
    v_mfma_f32_16x16x32_bf16 v[40:43], v[76:79], v[152:155], v[40:43]
    ds_read_b64_tr_b16 v[72:73], v108 offset:47104
    v_mfma_f32_16x16x32_bf16 v[44:47], v[76:79], v[224:227], v[44:47]
    ds_read_b64_tr_b16 v[74:75], v108 offset:52224
    s_waitcnt lgkmcnt(6)
    v_mfma_f32_16x16x32_bf16 v[48:51], v[80:83], v[152:155], v[48:51]
    ds_read_b64_tr_b16 v[76:77], v109 offset:47136
    v_mfma_f32_16x16x32_bf16 v[52:55], v[80:83], v[224:227], v[52:55]
    ds_read_b64_tr_b16 v[78:79], v109 offset:52256
    s_add_u32 s56, s63, 8192
    buffer_store_dwordx4 v[100:103], v8, s[44:47], s56 offen sc1
    s_waitcnt lgkmcnt(6)
    v_mfma_f32_16x16x32_bf16 v[56:59], v[84:87], v[152:155], v[56:59]
    ds_read_b64_tr_b16 v[80:81], v108 offset:47168
    v_mfma_f32_16x16x32_bf16 v[60:63], v[84:87], v[224:227], v[60:63]
    ds_read_b64_tr_b16 v[82:83], v108 offset:52288
    s_waitcnt lgkmcnt(6)
    v_mfma_f32_16x16x32_bf16 v[64:67], v[88:91], v[152:155], v[64:67]
    ds_read_b64_tr_b16 v[84:85], v109 offset:47200
    v_mfma_f32_16x16x32_bf16 v[68:71], v[88:91], v[224:227], v[68:71]
    ds_read_b64_tr_b16 v[86:87], v109 offset:52320
    ds_read_b64_tr_b16 v[88:89], v108 offset:47232
    ds_read_b64_tr_b16 v[90:91], v108 offset:52352
    s_waitcnt vmcnt(4)
    s_barrier
    s_waitcnt lgkmcnt(8)
    v_mfma_f32_16x16x32_bf16 v[32:35], v[72:75], v[156:159], v[32:35]
    s_add_u32 m0, s69, 26624
    s_add_u32 s53, s65, 5013504
    buffer_load_dwordx4 v6, s[40:43], s53 offen lds
    v_mfma_f32_16x16x32_bf16 v[36:39], v[72:75], v[228:231], v[36:39]
    s_waitcnt lgkmcnt(6)
    v_mfma_f32_16x16x32_bf16 v[40:43], v[76:79], v[156:159], v[40:43]
    ds_read_b64_tr_b16 v[72:73], v108 offset:0
    v_mfma_f32_16x16x32_bf16 v[44:47], v[76:79], v[228:231], v[44:47]
    ds_read_b64_tr_b16 v[74:75], v108 offset:5120
    s_waitcnt lgkmcnt(6)
    v_mfma_f32_16x16x32_bf16 v[48:51], v[80:83], v[156:159], v[48:51]
    ds_read_b64_tr_b16 v[76:77], v109 offset:32
    v_mfma_f32_16x16x32_bf16 v[52:55], v[80:83], v[228:231], v[52:55]
    ds_read_b64_tr_b16 v[78:79], v109 offset:5152
    s_add_u32 m0, s69, 27648
    s_add_u32 s53, s65, 5013504
    buffer_load_dwordx4 v7, s[40:43], s53 offen lds
    s_waitcnt lgkmcnt(6)
    v_mfma_f32_16x16x32_bf16 v[56:59], v[84:87], v[156:159], v[56:59]
    ds_read_b64_tr_b16 v[80:81], v108 offset:64
    v_mfma_f32_16x16x32_bf16 v[60:63], v[84:87], v[228:231], v[60:63]
    ds_read_b64_tr_b16 v[82:83], v108 offset:5184
    s_waitcnt lgkmcnt(6)
    v_mfma_f32_16x16x32_bf16 v[64:67], v[88:91], v[156:159], v[64:67]
    ds_read_b64_tr_b16 v[84:85], v109 offset:96
    v_mfma_f32_16x16x32_bf16 v[68:71], v[88:91], v[228:231], v[68:71]
    ds_read_b64_tr_b16 v[86:87], v109 offset:5216
    s_waitcnt lgkmcnt(6)
    v_mfma_f32_16x16x32_bf16 v[32:35], v[72:75], v[160:163], v[32:35]
    ds_read_b64_tr_b16 v[88:89], v108 offset:128
    s_cmp_lt_u32 s33, 2
    s_cbranch_scc0 .Lk1wb_84
    s_add_u32 m0, s69, 28672
    s_add_u32 s53, s65, 5013504
    buffer_load_dwordx4 v9, s[40:43], s53 offen lds
.Lk1wb_84:
    v_mfma_f32_16x16x32_bf16 v[36:39], v[72:75], v[232:235], v[36:39]
    ds_read_b64_tr_b16 v[90:91], v108 offset:5248
    s_waitcnt lgkmcnt(6)
    v_mfma_f32_16x16x32_bf16 v[40:43], v[76:79], v[160:163], v[40:43]
    ds_read_b64_tr_b16 v[72:73], v108 offset:57344
    v_mfma_f32_16x16x32_bf16 v[44:47], v[76:79], v[232:235], v[44:47]
    ds_read_b64_tr_b16 v[74:75], v108 offset:62464
    s_waitcnt lgkmcnt(6)
    v_mfma_f32_16x16x32_bf16 v[48:51], v[80:83], v[160:163], v[48:51]
    ds_read_b64_tr_b16 v[76:77], v109 offset:57376
    v_mfma_f32_16x16x32_bf16 v[52:55], v[80:83], v[232:235], v[52:55]
    ds_read_b64_tr_b16 v[78:79], v109 offset:62496
    s_waitcnt lgkmcnt(6)
    v_mfma_f32_16x16x32_bf16 v[56:59], v[84:87], v[160:163], v[56:59]
    ds_read_b64_tr_b16 v[80:81], v108 offset:57408
    v_mfma_f32_16x16x32_bf16 v[60:63], v[84:87], v[232:235], v[60:63]
    ds_read_b64_tr_b16 v[82:83], v108 offset:62528
    s_waitcnt lgkmcnt(6)
    v_mfma_f32_16x16x32_bf16 v[64:67], v[88:91], v[160:163], v[64:67]
    ds_read_b64_tr_b16 v[84:85], v109 offset:57440
    v_mfma_f32_16x16x32_bf16 v[68:71], v[88:91], v[232:235], v[68:71]
    ds_read_b64_tr_b16 v[86:87], v109 offset:62560
    ds_read_b64_tr_b16 v[88:89], v108 offset:57472
    ds_read_b64_tr_b16 v[90:91], v108 offset:62592
    s_cmp_lt_u32 s33, 2
    s_cbranch_scc0 .Lk1wvn_86
    s_waitcnt vmcnt(4)
    s_branch .Lk1wve_85
.Lk1wvn_86:
    s_cmp_lt_u32 s33, 3
    s_cbranch_scc0 .Lk1wvn_87
    s_waitcnt vmcnt(3)
    s_branch .Lk1wve_85
.Lk1wvn_87:
    s_waitcnt vmcnt(3)
.Lk1wve_85:
    s_barrier
    s_waitcnt lgkmcnt(8)
    v_mfma_f32_16x16x32_bf16 v[32:35], v[72:75], v[164:167], v[32:35]
    s_add_u32 s56, s63, 9216
    buffer_store_dwordx4 v[104:107], v8, s[44:47], s56 offen sc1
    v_mfma_f32_16x16x32_bf16 v[36:39], v[72:75], v[236:239], v[36:39]
    s_waitcnt lgkmcnt(6)
    v_mfma_f32_16x16x32_bf16 v[40:43], v[76:79], v[164:167], v[40:43]
    ds_read_b64_tr_b16 v[72:73], v110 offset:0
    v_mfma_f32_16x16x32_bf16 v[44:47], v[76:79], v[236:239], v[44:47]
    ds_read_b64_tr_b16 v[74:75], v110 offset:5120
    s_waitcnt lgkmcnt(6)
    v_mfma_f32_16x16x32_bf16 v[48:51], v[80:83], v[164:167], v[48:51]
    ds_read_b64_tr_b16 v[76:77], v111 offset:32
    v_mfma_f32_16x16x32_bf16 v[52:55], v[80:83], v[236:239], v[52:55]
    ds_read_b64_tr_b16 v[78:79], v111 offset:5152
    s_waitcnt lgkmcnt(6)
    v_mfma_f32_16x16x32_bf16 v[56:59], v[84:87], v[164:167], v[56:59]
    ds_read_b64_tr_b16 v[80:81], v110 offset:64
    v_mfma_f32_16x16x32_bf16 v[60:63], v[84:87], v[236:239], v[60:63]
    ds_read_b64_tr_b16 v[82:83], v110 offset:5184
    s_waitcnt lgkmcnt(6)
    v_mfma_f32_16x16x32_bf16 v[64:67], v[88:91], v[164:167], v[64:67]
    ds_read_b64_tr_b16 v[84:85], v111 offset:96
    v_mfma_f32_16x16x32_bf16 v[68:71], v[88:91], v[236:239], v[68:71]
    ds_read_b64_tr_b16 v[86:87], v111 offset:5216
    s_waitcnt lgkmcnt(6)
    v_mfma_f32_16x16x32_bf16 v[32:35], v[72:75], v[168:171], v[32:35]
    ds_read_b64_tr_b16 v[88:89], v110 offset:128
    v_mfma_f32_16x16x32_bf16 v[36:39], v[72:75], v[240:243], v[36:39]
    ds_read_b64_tr_b16 v[90:91], v110 offset:5248
    s_waitcnt lgkmcnt(6)
    v_mfma_f32_16x16x32_bf16 v[40:43], v[76:79], v[168:171], v[40:43]
    ds_read_b64_tr_b16 v[72:73], v110 offset:10240
    v_mfma_f32_16x16x32_bf16 v[44:47], v[76:79], v[240:243], v[44:47]
    ds_read_b64_tr_b16 v[74:75], v110 offset:15360
    s_waitcnt lgkmcnt(6)
    v_mfma_f32_16x16x32_bf16 v[48:51], v[80:83], v[168:171], v[48:51]
    ds_read_b64_tr_b16 v[76:77], v111 offset:10272
    v_mfma_f32_16x16x32_bf16 v[52:55], v[80:83], v[240:243], v[52:55]
    ds_read_b64_tr_b16 v[78:79], v111 offset:15392
    s_waitcnt lgkmcnt(6)
    v_mfma_f32_16x16x32_bf16 v[56:59], v[84:87], v[168:171], v[56:59]
    ds_read_b64_tr_b16 v[80:81], v110 offset:10304
    v_mfma_f32_16x16x32_bf16 v[60:63], v[84:87], v[240:243], v[60:63]
    ds_read_b64_tr_b16 v[82:83], v110 offset:15424
    s_waitcnt lgkmcnt(6)
    v_mfma_f32_16x16x32_bf16 v[64:67], v[88:91], v[168:171], v[64:67]
    ds_read_b64_tr_b16 v[84:85], v111 offset:10336
    v_mfma_f32_16x16x32_bf16 v[68:71], v[88:91], v[240:243], v[68:71]
    ds_read_b64_tr_b16 v[86:87], v111 offset:15456
    ds_read_b64_tr_b16 v[88:89], v110 offset:10368
    ds_read_b64_tr_b16 v[90:91], v110 offset:15488
    s_waitcnt vmcnt(1)
    s_barrier
    s_cmp_eq_u32 s32, 0
    s_cbranch_scc0 .Lk1w0_88
    v_lshrrev_b32 v16, 3, v1
    v_lshlrev_b32 v16, 7, v16
    v_and_b32 v17, 7, v1
    v_lshl_add_u32 v16, v17, 2, v16
    s_mov_b32 s52, 196608
    buffer_load_dword v18, v16, s[44:47], s52 offen sc1
    buffer_load_dword v19, v16, s[44:47], s52 offen offset:1024 sc1
.Lk1w0_88:
    s_waitcnt lgkmcnt(8)
    v_mfma_f32_16x16x32_bf16 v[32:35], v[72:75], v[172:175], v[32:35]
    v_mfma_f32_16x16x32_bf16 v[36:39], v[72:75], v[244:247], v[36:39]
    s_waitcnt lgkmcnt(6)
    v_mfma_f32_16x16x32_bf16 v[40:43], v[76:79], v[172:175], v[40:43]
    ds_read_b64_tr_b16 v[72:73], v108 offset:16384
    v_mfma_f32_16x16x32_bf16 v[44:47], v[76:79], v[244:247], v[44:47]
    ds_read_b64_tr_b16 v[74:75], v108 offset:21504
    s_waitcnt lgkmcnt(6)
    v_mfma_f32_16x16x32_bf16 v[48:51], v[80:83], v[172:175], v[48:51]
    ds_read_b64_tr_b16 v[76:77], v109 offset:16416
    v_mfma_f32_16x16x32_bf16 v[52:55], v[80:83], v[244:247], v[52:55]
    ds_read_b64_tr_b16 v[78:79], v109 offset:21536
    s_waitcnt lgkmcnt(6)
    v_mfma_f32_16x16x32_bf16 v[56:59], v[84:87], v[172:175], v[56:59]
    ds_read_b64_tr_b16 v[80:81], v108 offset:16448
    v_mfma_f32_16x16x32_bf16 v[60:63], v[84:87], v[244:247], v[60:63]
    ds_read_b64_tr_b16 v[82:83], v108 offset:21568
    s_waitcnt lgkmcnt(6)
    v_mfma_f32_16x16x32_bf16 v[64:67], v[88:91], v[172:175], v[64:67]
    ds_read_b64_tr_b16 v[84:85], v109 offset:16480
    v_mfma_f32_16x16x32_bf16 v[68:71], v[88:91], v[244:247], v[68:71]
    ds_read_b64_tr_b16 v[86:87], v109 offset:21600
    s_waitcnt lgkmcnt(6)
    v_mfma_f32_16x16x32_bf16 v[32:35], v[72:75], v[176:179], v[32:35]
    ds_read_b64_tr_b16 v[88:89], v108 offset:16512
    v_mfma_f32_16x16x32_bf16 v[36:39], v[72:75], v[248:251], v[36:39]
    ds_read_b64_tr_b16 v[90:91], v108 offset:21632
    s_waitcnt lgkmcnt(6)
    v_mfma_f32_16x16x32_bf16 v[40:43], v[76:79], v[176:179], v[40:43]
    ds_read_b64_tr_b16 v[72:73], v108 offset:26624
    v_mfma_f32_16x16x32_bf16 v[44:47], v[76:79], v[248:251], v[44:47]
    ds_read_b64_tr_b16 v[74:75], v108 offset:31744
    s_waitcnt lgkmcnt(6)
    v_mfma_f32_16x16x32_bf16 v[48:51], v[80:83], v[176:179], v[48:51]
    ds_read_b64_tr_b16 v[76:77], v109 offset:26656
    v_mfma_f32_16x16x32_bf16 v[52:55], v[80:83], v[248:251], v[52:55]
    ds_read_b64_tr_b16 v[78:79], v109 offset:31776
    s_waitcnt lgkmcnt(6)
    v_mfma_f32_16x16x32_bf16 v[56:59], v[84:87], v[176:179], v[56:59]
    ds_read_b64_tr_b16 v[80:81], v108 offset:26688
    v_mfma_f32_16x16x32_bf16 v[60:63], v[84:87], v[248:251], v[60:63]
    ds_read_b64_tr_b16 v[82:83], v108 offset:31808
    s_waitcnt lgkmcnt(6)
    v_mfma_f32_16x16x32_bf16 v[64:67], v[88:91], v[176:179], v[64:67]
    ds_read_b64_tr_b16 v[84:85], v109 offset:26720
    v_mfma_f32_16x16x32_bf16 v[68:71], v[88:91], v[248:251], v[68:71]
    ds_read_b64_tr_b16 v[86:87], v109 offset:31840
    ds_read_b64_tr_b16 v[88:89], v108 offset:26752
    ds_read_b64_tr_b16 v[90:91], v108 offset:31872
    s_waitcnt lgkmcnt(8)
    v_mfma_f32_16x16x32_bf16 v[32:35], v[72:75], v[180:183], v[32:35]
    v_mfma_f32_16x16x32_bf16 v[36:39], v[72:75], v[252:255], v[36:39]
    s_waitcnt lgkmcnt(6)
    v_mfma_f32_16x16x32_bf16 v[40:43], v[76:79], v[180:183], v[40:43]
    v_mfma_f32_16x16x32_bf16 v[44:47], v[76:79], v[252:255], v[44:47]
    s_waitcnt lgkmcnt(4)
    v_mfma_f32_16x16x32_bf16 v[48:51], v[80:83], v[180:183], v[48:51]
    v_mfma_f32_16x16x32_bf16 v[52:55], v[80:83], v[252:255], v[52:55]
    s_waitcnt lgkmcnt(2)
    v_mfma_f32_16x16x32_bf16 v[56:59], v[84:87], v[180:183], v[56:59]
    v_cvt_pk_bf16_f32 v144, v32, v33
    v_cvt_pk_bf16_f32 v145, v34, v35
    v_pk_max_i16 v144, v144, 0
    v_pk_max_i16 v145, v145, 0
    v_cvt_pk_bf16_f32 v148, v36, v37
    v_cvt_pk_bf16_f32 v149, v38, v39
    v_mfma_f32_16x16x32_bf16 v[60:63], v[84:87], v[252:255], v[60:63]
    v_pk_max_i16 v148, v148, 0
    v_pk_max_i16 v149, v149, 0
    s_waitcnt lgkmcnt(0)
    v_mfma_f32_16x16x32_bf16 v[64:67], v[88:91], v[180:183], v[64:67]
    v_cvt_pk_bf16_f32 v146, v40, v41
    v_cvt_pk_bf16_f32 v147, v42, v43
    v_pk_max_i16 v146, v146, 0
    v_pk_max_i16 v147, v147, 0
    v_cvt_pk_bf16_f32 v150, v44, v45
    v_cvt_pk_bf16_f32 v151, v46, v47
    v_mfma_f32_16x16x32_bf16 v[68:71], v[88:91], v[252:255], v[68:71]
    v_pk_max_i16 v150, v150, 0
    v_pk_max_i16 v151, v151, 0
    s_nop 7
    v_cvt_pk_bf16_f32 v152, v48, v49
    v_cvt_pk_bf16_f32 v153, v50, v51
    v_pk_max_i16 v152, v152, 0
    v_pk_max_i16 v153, v153, 0
    v_cvt_pk_bf16_f32 v156, v52, v53
    v_cvt_pk_bf16_f32 v157, v54, v55
    v_pk_max_i16 v156, v156, 0
    v_pk_max_i16 v157, v157, 0
    v_cvt_pk_bf16_f32 v154, v56, v57
    v_cvt_pk_bf16_f32 v155, v58, v59
    v_pk_max_i16 v154, v154, 0
    v_pk_max_i16 v155, v155, 0
    v_cvt_pk_bf16_f32 v158, v60, v61
    v_cvt_pk_bf16_f32 v159, v62, v63
    v_pk_max_i16 v158, v158, 0
    v_pk_max_i16 v159, v159, 0
    v_cvt_pk_bf16_f32 v164, v64, v65
    v_cvt_pk_bf16_f32 v165, v66, v67
    v_pk_max_i16 v164, v164, 0
    v_pk_max_i16 v165, v165, 0
    v_cvt_pk_bf16_f32 v166, v68, v69
    v_cvt_pk_bf16_f32 v167, v70, v71
    v_pk_max_i16 v166, v166, 0
    v_pk_max_i16 v167, v167, 0
    s_nop 1
    s_setprio 0
    s_branch .Lk1aend_9
.Lk1cg1_8:
    s_mov_b32 s62, 0x3eae1a93
    v_lshrrev_b32 v15, 4, v1
    v_mov_b32 v14, 1.0
    v_cmp_eq_u32 vcc, 1, v15
    v_mov_b32 v15, s62
    s_nop 0
    v_cndmask_b32 v14, v14, v15, vcc
    s_cmp_lt_u32 s33, 2
    s_cbranch_scc0 .Lk1wvn_90
    s_waitcnt vmcnt(5)
    s_branch .Lk1wve_89
.Lk1wvn_90:
    s_cmp_lt_u32 s33, 3
    s_cbranch_scc0 .Lk1wvn_91
    s_waitcnt vmcnt(5)
    s_branch .Lk1wve_89
.Lk1wvn_91:
    s_waitcnt vmcnt(4)
.Lk1wve_89:
    s_barrier
    ds_read_b128 v[112:115], v11 offset:0
    ds_read_b128 v[184:187], v11 offset:2048
    ds_read_b128 v[116:119], v12 offset:0
    ds_read_b128 v[188:191], v12 offset:2048
    ds_read_b64_tr_b16 v[16:17], v13 offset:0
    ds_read_b64_tr_b16 v[18:19], v13 offset:1536
    ds_read_b64_tr_b16 v[72:73], v2 offset:0
    ds_read_b64_tr_b16 v[74:75], v2 offset:4096
    ds_read_b64_tr_b16 v[76:77], v3 offset:0
    ds_read_b64_tr_b16 v[78:79], v3 offset:4096
    ds_read_b64_tr_b16 v[80:81], v4 offset:0
    ds_read_b64_tr_b16 v[82:83], v4 offset:4096
    ds_read_b64_tr_b16 v[84:85], v5 offset:0
    ds_read_b64_tr_b16 v[86:87], v5 offset:4096
    s_waitcnt lgkmcnt(8)
    v_mfma_f32_16x16x32_bf16 v[92:95], v[16:19], v[112:115], 0
    s_add_u32 m0, s66, 122880
    s_add_u32 s53, s64, 1179648
    buffer_load_dwordx4 v6, s[40:43], s53 offen lds
    v_mfma_f32_16x16x32_bf16 v[96:99], v[16:19], v[184:187], 0
    s_waitcnt lgkmcnt(6)
    v_mfma_f32_16x16x32_bf16 v[32:35], v[72:75], v[112:115], 0
    ds_read_b64_tr_b16 v[16:17], v13 offset:3072
    s_add_u32 m0, s66, 123904
    s_add_u32 s53, s64, 1179648
    buffer_load_dwordx4 v7, s[40:43], s53 offen lds
    v_mfma_f32_16x16x32_bf16 v[36:39], v[72:75], v[184:187], 0
    ds_read_b64_tr_b16 v[18:19], v13 offset:4608
    s_waitcnt lgkmcnt(6)
    v_mfma_f32_16x16x32_bf16 v[40:43], v[76:79], v[112:115], 0
    ds_read_b64_tr_b16 v[72:73], v2 offset:8192
    s_cmp_lt_u32 s33, 3
    s_cbranch_scc0 .Lk1we_92
    s_add_u32 m0, s68, 77824
    s_nop 0
    global_load_lds_dwordx4 v[24:25], off
    v_add_co_u32 v24, vcc, v24, v26
    s_nop 1
    v_addc_co_u32 v25, vcc, 0, v25, vcc
.Lk1we_92:
    v_mfma_f32_16x16x32_bf16 v[44:47], v[76:79], v[184:187], 0
    ds_read_b64_tr_b16 v[74:75], v2 offset:12288
    s_waitcnt lgkmcnt(6)
    v_mfma_f32_16x16x32_bf16 v[48:51], v[80:83], v[112:115], 0
    ds_read_b64_tr_b16 v[76:77], v3 offset:8192
    s_lshl_b32 s52, s32, 11
    s_add_u32 m0, s52, 32768
    s_movk_i32 s53, 256
    buffer_load_dwordx4 v9, s[36:39], s53 offen lds
    v_mfma_f32_16x16x32_bf16 v[52:55], v[80:83], v[184:187], 0
    ds_read_b64_tr_b16 v[78:79], v3 offset:12288
    s_waitcnt lgkmcnt(6)
    v_mfma_f32_16x16x32_bf16 v[56:59], v[84:87], v[112:115], 0
    ds_read_b64_tr_b16 v[80:81], v4 offset:8192
    s_lshl_b32 s52, s32, 11
    s_add_u32 m0, s52, 33792
    s_movk_i32 s53, 256
    buffer_load_dwordx4 v10, s[36:39], s53 offen lds
    v_mfma_f32_16x16x32_bf16 v[60:63], v[84:87], v[184:187], 0
    ds_read_b64_tr_b16 v[82:83], v4 offset:12288
    ds_read_b64_tr_b16 v[84:85], v5 offset:8192
    ds_read_b64_tr_b16 v[86:87], v5 offset:12288
    s_cmp_lt_u32 s33, 2
    s_cbranch_scc0 .Lk1wvn_94
    s_waitcnt vmcnt(5)
    s_branch .Lk1wve_93
.Lk1wvn_94:
    s_cmp_lt_u32 s33, 3
    s_cbranch_scc0 .Lk1wvn_95
    s_waitcnt vmcnt(5)
    s_branch .Lk1wve_93
.Lk1wvn_95:
    s_waitcnt vmcnt(4)
.Lk1wve_93:
    s_barrier
    s_waitcnt lgkmcnt(8)
    v_mfma_f32_16x16x32_bf16 v[92:95], v[16:19], v[116:119], v[92:95]
    s_add_u32 m0, s66, 139264
    s_add_u32 s53, s64, 1769472
    buffer_load_dwordx4 v6, s[40:43], s53 offen lds
    v_mfma_f32_16x16x32_bf16 v[96:99], v[16:19], v[188:191], v[96:99]
    s_waitcnt lgkmcnt(6)
    v_mfma_f32_16x16x32_bf16 v[32:35], v[72:75], v[116:119], v[32:35]
    ds_read_b64_tr_b16 v[16:17], v13 offset:6144
    v_mfma_f32_16x16x32_bf16 v[36:39], v[72:75], v[188:191], v[36:39]
    ds_read_b64_tr_b16 v[18:19], v13 offset:7680
    s_add_u32 m0, s66, 140288
    s_add_u32 s53, s64, 1769472
    buffer_load_dwordx4 v7, s[40:43], s53 offen lds
    s_waitcnt lgkmcnt(6)
    v_mfma_f32_16x16x32_bf16 v[40:43], v[76:79], v[116:119], v[40:43]
    ds_read_b128 v[120:123], v11 offset:16384
    v_mfma_f32_16x16x32_bf16 v[44:47], v[76:79], v[188:191], v[44:47]
    ds_read_b128 v[192:195], v11 offset:18432
    s_waitcnt lgkmcnt(6)
    v_mfma_f32_16x16x32_bf16 v[48:51], v[80:83], v[116:119], v[48:51]
    ds_read_b128 v[124:127], v12 offset:16384
    s_cmp_lt_u32 s33, 3
    s_cbranch_scc0 .Lk1we_96
    s_add_u32 m0, s68, 83968
    s_nop 0
    global_load_lds_dwordx4 v[24:25], off
    v_add_co_u32 v24, vcc, v24, v26
    s_nop 1
    v_addc_co_u32 v25, vcc, 0, v25, vcc
.Lk1we_96:
    v_mfma_f32_16x16x32_bf16 v[52:55], v[80:83], v[188:191], v[52:55]
    ds_read_b128 v[196:199], v12 offset:18432
    s_waitcnt lgkmcnt(6)
    v_mfma_f32_16x16x32_bf16 v[56:59], v[84:87], v[116:119], v[56:59]
    ds_read_b64_tr_b16 v[72:73], v2 offset:16384
    v_mfma_f32_16x16x32_bf16 v[60:63], v[84:87], v[188:191], v[60:63]
    ds_read_b64_tr_b16 v[74:75], v2 offset:20480
    s_waitcnt lgkmcnt(2)
    v_mfma_f32_16x16x32_bf16 v[92:95], v[16:19], v[120:123], v[92:95]
    ds_read_b64_tr_b16 v[76:77], v3 offset:16384
    s_lshl_b32 s52, s32, 11
    s_add_u32 m0, s52, 49152
    s_movk_i32 s53, 384
    buffer_load_dwordx4 v9, s[36:39], s53 offen lds
    v_mfma_f32_16x16x32_bf16 v[96:99], v[16:19], v[192:195], v[96:99]
    ds_read_b64_tr_b16 v[78:79], v3 offset:20480
    s_waitcnt lgkmcnt(2)
    v_mfma_f32_16x16x32_bf16 v[32:35], v[72:75], v[120:123], v[32:35]
    ds_read_b64_tr_b16 v[80:81], v4 offset:16384
    v_mfma_f32_16x16x32_bf16 v[36:39], v[72:75], v[192:195], v[36:39]
    ds_read_b64_tr_b16 v[82:83], v4 offset:20480
    s_waitcnt lgkmcnt(2)
    v_mfma_f32_16x16x32_bf16 v[40:43], v[76:79], v[120:123], v[40:43]
    ds_read_b64_tr_b16 v[84:85], v5 offset:16384
    v_mfma_f32_16x16x32_bf16 v[44:47], v[76:79], v[192:195], v[44:47]
    ds_read_b64_tr_b16 v[86:87], v5 offset:20480
    s_lshl_b32 s52, s32, 11
    s_add_u32 m0, s52, 50176
    s_movk_i32 s53, 384
    buffer_load_dwordx4 v10, s[36:39], s53 offen lds
    s_waitcnt lgkmcnt(2)
    v_mfma_f32_16x16x32_bf16 v[48:51], v[80:83], v[120:123], v[48:51]
    ds_read_b64_tr_b16 v[16:17], v13 offset:9216
    v_mfma_f32_16x16x32_bf16 v[52:55], v[80:83], v[192:195], v[52:55]
    ds_read_b64_tr_b16 v[18:19], v13 offset:10752
    s_waitcnt lgkmcnt(2)
    v_mfma_f32_16x16x32_bf16 v[56:59], v[84:87], v[120:123], v[56:59]
    ds_read_b64_tr_b16 v[72:73], v2 offset:24576
    v_mfma_f32_16x16x32_bf16 v[60:63], v[84:87], v[192:195], v[60:63]
    ds_read_b64_tr_b16 v[74:75], v2 offset:28672
    ds_read_b64_tr_b16 v[76:77], v3 offset:24576
    ds_read_b64_tr_b16 v[78:79], v3 offset:28672
    ds_read_b64_tr_b16 v[80:81], v4 offset:24576
    ds_read_b64_tr_b16 v[82:83], v4 offset:28672
    ds_read_b64_tr_b16 v[84:85], v5 offset:24576
    ds_read_b64_tr_b16 v[86:87], v5 offset:28672
    s_cmp_lt_u32 s33, 2
    s_cbranch_scc0 .Lk1wvn_98
    s_waitcnt vmcnt(5)
    s_branch .Lk1wve_97
.Lk1wvn_98:
    s_cmp_lt_u32 s33, 3
    s_cbranch_scc0 .Lk1wvn_99
    s_waitcnt vmcnt(5)
    s_branch .Lk1wve_97
.Lk1wvn_99:
    s_waitcnt vmcnt(4)
.Lk1wve_97:
    s_barrier
    s_waitcnt lgkmcnt(8)
    v_mfma_f32_16x16x32_bf16 v[92:95], v[16:19], v[124:127], v[92:95]
    s_add_u32 m0, s66, 90112
    s_add_u32 s53, s64, 2359296
    buffer_load_dwordx4 v6, s[40:43], s53 offen lds
    v_mfma_f32_16x16x32_bf16 v[96:99], v[16:19], v[196:199], v[96:99]
    s_waitcnt lgkmcnt(6)
    v_mfma_f32_16x16x32_bf16 v[32:35], v[72:75], v[124:127], v[32:35]
    ds_read_b64_tr_b16 v[16:17], v13 offset:12288
    v_mfma_f32_16x16x32_bf16 v[36:39], v[72:75], v[196:199], v[36:39]
    ds_read_b64_tr_b16 v[18:19], v13 offset:13824
    s_add_u32 m0, s66, 91136
    s_add_u32 s53, s64, 2359296
    buffer_load_dwordx4 v7, s[40:43], s53 offen lds
    s_waitcnt lgkmcnt(6)
    v_mfma_f32_16x16x32_bf16 v[40:43], v[76:79], v[124:127], v[40:43]
    ds_read_b128 v[128:131], v11 offset:32768
    v_mfma_f32_16x16x32_bf16 v[44:47], v[76:79], v[196:199], v[44:47]
    ds_read_b128 v[200:203], v11 offset:34816
    s_waitcnt lgkmcnt(6)
    v_mfma_f32_16x16x32_bf16 v[48:51], v[80:83], v[124:127], v[48:51]
    ds_read_b128 v[132:135], v12 offset:32768
    s_cmp_lt_u32 s33, 3
    s_cbranch_scc0 .Lk1we_100
    s_add_u32 m0, s68, 65536
    s_nop 0
    global_load_lds_dwordx4 v[24:25], off
    v_add_co_u32 v24, vcc, v24, v26
    s_nop 1
    v_addc_co_u32 v25, vcc, 0, v25, vcc
.Lk1we_100:
    v_mfma_f32_16x16x32_bf16 v[52:55], v[80:83], v[196:199], v[52:55]
    ds_read_b128 v[204:207], v12 offset:34816
    s_waitcnt lgkmcnt(6)
    v_mfma_f32_16x16x32_bf16 v[56:59], v[84:87], v[124:127], v[56:59]
    ds_read_b64_tr_b16 v[72:73], v2 offset:32768
    v_mfma_f32_16x16x32_bf16 v[60:63], v[84:87], v[196:199], v[60:63]
    ds_read_b64_tr_b16 v[74:75], v2 offset:36864
    s_waitcnt lgkmcnt(2)
    v_mfma_f32_16x16x32_bf16 v[92:95], v[16:19], v[128:131], v[92:95]
    ds_read_b64_tr_b16 v[76:77], v3 offset:32768
    s_lshl_b32 s52, s32, 11
    s_add_u32 m0, s52, 0
    s_movk_i32 s53, 512
    buffer_load_dwordx4 v9, s[36:39], s53 offen lds
    v_mfma_f32_16x16x32_bf16 v[96:99], v[16:19], v[200:203], v[96:99]
    ds_read_b64_tr_b16 v[78:79], v3 offset:36864
    s_waitcnt lgkmcnt(2)
    v_mfma_f32_16x16x32_bf16 v[32:35], v[72:75], v[128:131], v[32:35]
    ds_read_b64_tr_b16 v[80:81], v4 offset:32768
    v_mfma_f32_16x16x32_bf16 v[36:39], v[72:75], v[200:203], v[36:39]
    ds_read_b64_tr_b16 v[82:83], v4 offset:36864
    s_waitcnt lgkmcnt(2)
    v_mfma_f32_16x16x32_bf16 v[40:43], v[76:79], v[128:131], v[40:43]
    ds_read_b64_tr_b16 v[84:85], v5 offset:32768
    v_mfma_f32_16x16x32_bf16 v[44:47], v[76:79], v[200:203], v[44:47]
    ds_read_b64_tr_b16 v[86:87], v5 offset:36864
    s_lshl_b32 s52, s32, 11
    s_add_u32 m0, s52, 1024
    s_movk_i32 s53, 512
    buffer_load_dwordx4 v10, s[36:39], s53 offen lds
    s_waitcnt lgkmcnt(2)
    v_mfma_f32_16x16x32_bf16 v[48:51], v[80:83], v[128:131], v[48:51]
    ds_read_b64_tr_b16 v[16:17], v13 offset:15360
    v_mfma_f32_16x16x32_bf16 v[52:55], v[80:83], v[200:203], v[52:55]
    ds_read_b64_tr_b16 v[18:19], v13 offset:16896
    s_waitcnt lgkmcnt(2)
    v_mfma_f32_16x16x32_bf16 v[56:59], v[84:87], v[128:131], v[56:59]
    ds_read_b64_tr_b16 v[72:73], v2 offset:40960
    v_mfma_f32_16x16x32_bf16 v[60:63], v[84:87], v[200:203], v[60:63]
    ds_read_b64_tr_b16 v[74:75], v2 offset:45056
    ds_read_b64_tr_b16 v[76:77], v3 offset:40960
    ds_read_b64_tr_b16 v[78:79], v3 offset:45056
    ds_read_b64_tr_b16 v[80:81], v4 offset:40960
    ds_read_b64_tr_b16 v[82:83], v4 offset:45056
    ds_read_b64_tr_b16 v[84:85], v5 offset:40960
    ds_read_b64_tr_b16 v[86:87], v5 offset:45056
    s_cmp_lt_u32 s33, 2
    s_cbranch_scc0 .Lk1wvn_102
    s_waitcnt vmcnt(5)
    s_branch .Lk1wve_101
.Lk1wvn_102:
    s_cmp_lt_u32 s33, 3
    s_cbranch_scc0 .Lk1wvn_103
    s_waitcnt vmcnt(5)
    s_branch .Lk1wve_101
.Lk1wvn_103:
    s_waitcnt vmcnt(4)
.Lk1wve_101:
    s_barrier
    s_waitcnt lgkmcnt(8)
    v_mfma_f32_16x16x32_bf16 v[92:95], v[16:19], v[132:135], v[92:95]
    s_add_u32 m0, s66, 106496
    s_add_u32 s53, s64, 2949120
    buffer_load_dwordx4 v6, s[40:43], s53 offen lds
    v_mfma_f32_16x16x32_bf16 v[96:99], v[16:19], v[204:207], v[96:99]
    s_waitcnt lgkmcnt(6)
    v_mfma_f32_16x16x32_bf16 v[32:35], v[72:75], v[132:135], v[32:35]
    ds_read_b64_tr_b16 v[16:17], v13 offset:18432
    v_mfma_f32_16x16x32_bf16 v[36:39], v[72:75], v[204:207], v[36:39]
    ds_read_b64_tr_b16 v[18:19], v13 offset:19968
    s_add_u32 m0, s66, 107520
    s_add_u32 s53, s64, 2949120
    buffer_load_dwordx4 v7, s[40:43], s53 offen lds
    s_waitcnt lgkmcnt(6)
    v_mfma_f32_16x16x32_bf16 v[40:43], v[76:79], v[132:135], v[40:43]
    ds_read_b128 v[136:139], v11 offset:49152
    v_mfma_f32_16x16x32_bf16 v[44:47], v[76:79], v[204:207], v[44:47]
    ds_read_b128 v[208:211], v11 offset:51200
    s_waitcnt lgkmcnt(6)
    v_mfma_f32_16x16x32_bf16 v[48:51], v[80:83], v[132:135], v[48:51]
    ds_read_b128 v[140:143], v12 offset:49152
    s_cmp_lt_u32 s33, 3
    s_cbranch_scc0 .Lk1we_104
    s_add_u32 m0, s68, 71680
    s_nop 0
    global_load_lds_dwordx4 v[24:25], off
    v_add_co_u32 v24, vcc, v24, v26
    s_nop 1
    v_addc_co_u32 v25, vcc, 0, v25, vcc
.Lk1we_104:
    v_mfma_f32_16x16x32_bf16 v[52:55], v[80:83], v[204:207], v[52:55]
    ds_read_b128 v[212:215], v12 offset:51200
    s_waitcnt lgkmcnt(6)
    v_mfma_f32_16x16x32_bf16 v[56:59], v[84:87], v[132:135], v[56:59]
    ds_read_b64_tr_b16 v[72:73], v2 offset:49152
    v_mfma_f32_16x16x32_bf16 v[60:63], v[84:87], v[204:207], v[60:63]
    ds_read_b64_tr_b16 v[74:75], v2 offset:53248
    s_waitcnt lgkmcnt(2)
    v_mfma_f32_16x16x32_bf16 v[92:95], v[16:19], v[136:139], v[92:95]
    ds_read_b64_tr_b16 v[76:77], v3 offset:49152
    s_lshl_b32 s52, s32, 11
    s_add_u32 m0, s52, 16384
    s_movk_i32 s53, 640
    buffer_load_dwordx4 v9, s[36:39], s53 offen lds
    v_mfma_f32_16x16x32_bf16 v[96:99], v[16:19], v[208:211], v[96:99]
    ds_read_b64_tr_b16 v[78:79], v3 offset:53248
    s_waitcnt lgkmcnt(2)
    v_mfma_f32_16x16x32_bf16 v[32:35], v[72:75], v[136:139], v[32:35]
    ds_read_b64_tr_b16 v[80:81], v4 offset:49152
    v_mfma_f32_16x16x32_bf16 v[36:39], v[72:75], v[208:211], v[36:39]
    ds_read_b64_tr_b16 v[82:83], v4 offset:53248
    s_waitcnt lgkmcnt(2)
    v_mfma_f32_16x16x32_bf16 v[40:43], v[76:79], v[136:139], v[40:43]
    ds_read_b64_tr_b16 v[84:85], v5 offset:49152
    v_mfma_f32_16x16x32_bf16 v[44:47], v[76:79], v[208:211], v[44:47]
    ds_read_b64_tr_b16 v[86:87], v5 offset:53248
    s_lshl_b32 s52, s32, 11
    s_add_u32 m0, s52, 17408
    s_movk_i32 s53, 640
    buffer_load_dwordx4 v10, s[36:39], s53 offen lds
    s_waitcnt lgkmcnt(2)
    v_mfma_f32_16x16x32_bf16 v[48:51], v[80:83], v[136:139], v[48:51]
    ds_read_b64_tr_b16 v[16:17], v13 offset:21504
    v_mfma_f32_16x16x32_bf16 v[52:55], v[80:83], v[208:211], v[52:55]
    ds_read_b64_tr_b16 v[18:19], v13 offset:23040
    s_waitcnt lgkmcnt(2)
    v_mfma_f32_16x16x32_bf16 v[56:59], v[84:87], v[136:139], v[56:59]
    ds_read_b64_tr_b16 v[72:73], v2 offset:57344
    v_mfma_f32_16x16x32_bf16 v[60:63], v[84:87], v[208:211], v[60:63]
    ds_read_b64_tr_b16 v[74:75], v2 offset:61440
    ds_read_b64_tr_b16 v[76:77], v3 offset:57344
    ds_read_b64_tr_b16 v[78:79], v3 offset:61440
    ds_read_b64_tr_b16 v[80:81], v4 offset:57344
    ds_read_b64_tr_b16 v[82:83], v4 offset:61440
    ds_read_b64_tr_b16 v[84:85], v5 offset:57344
    ds_read_b64_tr_b16 v[86:87], v5 offset:61440
    s_cmp_lt_u32 s33, 2
    s_cbranch_scc0 .Lk1wvn_106
    s_waitcnt vmcnt(5)
    s_branch .Lk1wve_105
.Lk1wvn_106:
    s_cmp_lt_u32 s33, 3
    s_cbranch_scc0 .Lk1wvn_107
    s_waitcnt vmcnt(5)
    s_branch .Lk1wve_105
.Lk1wvn_107:
    s_waitcnt vmcnt(4)
.Lk1wve_105:
    s_barrier
    s_waitcnt lgkmcnt(8)
    v_mfma_f32_16x16x32_bf16 v[92:95], v[16:19], v[140:143], v[92:95]
    s_add_u32 m0, s66, 122880
    s_add_u32 s53, s64, 3538944
    buffer_load_dwordx4 v6, s[40:43], s53 offen lds
    v_mfma_f32_16x16x32_bf16 v[96:99], v[16:19], v[212:215], v[96:99]
    s_waitcnt lgkmcnt(6)
    v_mfma_f32_16x16x32_bf16 v[32:35], v[72:75], v[140:143], v[32:35]
    ds_read_b64_tr_b16 v[16:17], v13 offset:0
    v_mfma_f32_16x16x32_bf16 v[36:39], v[72:75], v[212:215], v[36:39]
    ds_read_b64_tr_b16 v[18:19], v13 offset:1536
    s_add_u32 m0, s66, 123904
    s_add_u32 s53, s64, 3538944
    buffer_load_dwordx4 v7, s[40:43], s53 offen lds
    s_waitcnt lgkmcnt(6)
    v_mfma_f32_16x16x32_bf16 v[40:43], v[76:79], v[140:143], v[40:43]
    ds_read_b128 v[144:147], v11 offset:0
    v_mfma_f32_16x16x32_bf16 v[44:47], v[76:79], v[212:215], v[44:47]
    ds_read_b128 v[216:219], v11 offset:2048
    s_waitcnt lgkmcnt(6)
    v_mfma_f32_16x16x32_bf16 v[48:51], v[80:83], v[140:143], v[48:51]
    ds_read_b128 v[148:151], v12 offset:0
    s_cmp_lt_u32 s33, 3
    s_cbranch_scc0 .Lk1we_108
    s_add_u32 m0, s68, 77824
    s_nop 0
    global_load_lds_dwordx4 v[24:25], off
    v_add_co_u32 v24, vcc, v24, v26
    s_nop 1
    v_addc_co_u32 v25, vcc, 0, v25, vcc
.Lk1we_108:
    v_mfma_f32_16x16x32_bf16 v[52:55], v[80:83], v[212:215], v[52:55]
    ds_read_b128 v[220:223], v12 offset:2048
    s_waitcnt lgkmcnt(6)
    v_mfma_f32_16x16x32_bf16 v[56:59], v[84:87], v[140:143], v[56:59]
    ds_read_b64_tr_b16 v[72:73], v2 offset:0
    v_mfma_f32_16x16x32_bf16 v[60:63], v[84:87], v[212:215], v[60:63]
    ds_read_b64_tr_b16 v[74:75], v2 offset:4096
    s_waitcnt lgkmcnt(2)
    v_mfma_f32_16x16x32_bf16 v[92:95], v[16:19], v[144:147], v[92:95]
    ds_read_b64_tr_b16 v[76:77], v3 offset:0
    s_lshl_b32 s52, s32, 11
    s_add_u32 m0, s52, 32768
    s_movk_i32 s53, 768
    buffer_load_dwordx4 v9, s[36:39], s53 offen lds
    v_mfma_f32_16x16x32_bf16 v[96:99], v[16:19], v[216:219], v[96:99]
    ds_read_b64_tr_b16 v[78:79], v3 offset:4096
    s_waitcnt lgkmcnt(2)
    v_mfma_f32_16x16x32_bf16 v[32:35], v[72:75], v[144:147], v[32:35]
    ds_read_b64_tr_b16 v[80:81], v4 offset:0
    v_mfma_f32_16x16x32_bf16 v[36:39], v[72:75], v[216:219], v[36:39]
    ds_read_b64_tr_b16 v[82:83], v4 offset:4096
    s_waitcnt lgkmcnt(2)
    v_mfma_f32_16x16x32_bf16 v[40:43], v[76:79], v[144:147], v[40:43]
    ds_read_b64_tr_b16 v[84:85], v5 offset:0
    v_mfma_f32_16x16x32_bf16 v[44:47], v[76:79], v[216:219], v[44:47]
    ds_read_b64_tr_b16 v[86:87], v5 offset:4096
    s_lshl_b32 s52, s32, 11
    s_add_u32 m0, s52, 33792
    s_movk_i32 s53, 768
    buffer_load_dwordx4 v10, s[36:39], s53 offen lds
    s_waitcnt lgkmcnt(2)
    v_mfma_f32_16x16x32_bf16 v[48:51], v[80:83], v[144:147], v[48:51]
    ds_read_b64_tr_b16 v[16:17], v13 offset:3072
    v_mfma_f32_16x16x32_bf16 v[52:55], v[80:83], v[216:219], v[52:55]
    ds_read_b64_tr_b16 v[18:19], v13 offset:4608
    s_waitcnt lgkmcnt(2)
    v_mfma_f32_16x16x32_bf16 v[56:59], v[84:87], v[144:147], v[56:59]
    ds_read_b64_tr_b16 v[72:73], v2 offset:8192
    v_mfma_f32_16x16x32_bf16 v[60:63], v[84:87], v[216:219], v[60:63]
    ds_read_b64_tr_b16 v[74:75], v2 offset:12288
    ds_read_b64_tr_b16 v[76:77], v3 offset:8192
    ds_read_b64_tr_b16 v[78:79], v3 offset:12288
    ds_read_b64_tr_b16 v[80:81], v4 offset:8192
    ds_read_b64_tr_b16 v[82:83], v4 offset:12288
    ds_read_b64_tr_b16 v[84:85], v5 offset:8192
    ds_read_b64_tr_b16 v[86:87], v5 offset:12288
    s_cmp_lt_u32 s33, 2
    s_cbranch_scc0 .Lk1wvn_110
    s_waitcnt vmcnt(5)
    s_branch .Lk1wve_109
.Lk1wvn_110:
    s_cmp_lt_u32 s33, 3
    s_cbranch_scc0 .Lk1wvn_111
    s_waitcnt vmcnt(5)
    s_branch .Lk1wve_109
.Lk1wvn_111:
    s_waitcnt vmcnt(4)
.Lk1wve_109:
    s_barrier
    s_waitcnt lgkmcnt(8)
    v_mfma_f32_16x16x32_bf16 v[92:95], v[16:19], v[148:151], v[92:95]
    s_add_u32 m0, s66, 139264
    s_add_u32 s53, s64, 4128768
    buffer_load_dwordx4 v6, s[40:43], s53 offen lds
    v_mfma_f32_16x16x32_bf16 v[96:99], v[16:19], v[220:223], v[96:99]
    s_waitcnt lgkmcnt(6)
    v_mfma_f32_16x16x32_bf16 v[32:35], v[72:75], v[148:151], v[32:35]
    ds_read_b64_tr_b16 v[16:17], v13 offset:6144
    v_mfma_f32_16x16x32_bf16 v[36:39], v[72:75], v[220:223], v[36:39]
    ds_read_b64_tr_b16 v[18:19], v13 offset:7680
    s_add_u32 m0, s66, 140288
    s_add_u32 s53, s64, 4128768
    buffer_load_dwordx4 v7, s[40:43], s53 offen lds
    s_waitcnt lgkmcnt(6)
    v_mfma_f32_16x16x32_bf16 v[40:43], v[76:79], v[148:151], v[40:43]
    ds_read_b128 v[152:155], v11 offset:16384
    v_mfma_f32_16x16x32_bf16 v[44:47], v[76:79], v[220:223], v[44:47]
    ds_read_b128 v[224:227], v11 offset:18432
    s_waitcnt lgkmcnt(6)
    v_mfma_f32_16x16x32_bf16 v[48:51], v[80:83], v[148:151], v[48:51]
    ds_read_b128 v[156:159], v12 offset:16384
    s_cmp_lt_u32 s33, 3
    s_cbranch_scc0 .Lk1we_112
    s_add_u32 m0, s68, 83968
    s_nop 0
    global_load_lds_dwordx4 v[24:25], off
    v_add_co_u32 v24, vcc, v24, v26
    s_nop 1
    v_addc_co_u32 v25, vcc, 0, v25, vcc
.Lk1we_112:
    v_mfma_f32_16x16x32_bf16 v[52:55], v[80:83], v[220:223], v[52:55]
    ds_read_b128 v[228:231], v12 offset:18432
    s_waitcnt lgkmcnt(6)
    v_mfma_f32_16x16x32_bf16 v[56:59], v[84:87], v[148:151], v[56:59]
    ds_read_b64_tr_b16 v[72:73], v2 offset:16384
    v_mfma_f32_16x16x32_bf16 v[60:63], v[84:87], v[220:223], v[60:63]
    ds_read_b64_tr_b16 v[74:75], v2 offset:20480
    s_waitcnt lgkmcnt(2)
    v_mfma_f32_16x16x32_bf16 v[92:95], v[16:19], v[152:155], v[92:95]
    ds_read_b64_tr_b16 v[76:77], v3 offset:16384
    s_lshl_b32 s52, s32, 11
    s_add_u32 m0, s52, 49152
    s_movk_i32 s53, 896
    buffer_load_dwordx4 v9, s[36:39], s53 offen lds
    v_mfma_f32_16x16x32_bf16 v[96:99], v[16:19], v[224:227], v[96:99]
    ds_read_b64_tr_b16 v[78:79], v3 offset:20480
    s_waitcnt lgkmcnt(2)
    v_mfma_f32_16x16x32_bf16 v[32:35], v[72:75], v[152:155], v[32:35]
    ds_read_b64_tr_b16 v[80:81], v4 offset:16384
    v_mfma_f32_16x16x32_bf16 v[36:39], v[72:75], v[224:227], v[36:39]
    ds_read_b64_tr_b16 v[82:83], v4 offset:20480
    s_waitcnt lgkmcnt(2)
    v_mfma_f32_16x16x32_bf16 v[40:43], v[76:79], v[152:155], v[40:43]
    ds_read_b64_tr_b16 v[84:85], v5 offset:16384
    v_mfma_f32_16x16x32_bf16 v[44:47], v[76:79], v[224:227], v[44:47]
    ds_read_b64_tr_b16 v[86:87], v5 offset:20480
    s_lshl_b32 s52, s32, 11
    s_add_u32 m0, s52, 50176
    s_movk_i32 s53, 896
    buffer_load_dwordx4 v10, s[36:39], s53 offen lds
    s_waitcnt lgkmcnt(2)
    v_mfma_f32_16x16x32_bf16 v[48:51], v[80:83], v[152:155], v[48:51]
    ds_read_b64_tr_b16 v[16:17], v13 offset:9216
    v_mfma_f32_16x16x32_bf16 v[52:55], v[80:83], v[224:227], v[52:55]
    ds_read_b64_tr_b16 v[18:19], v13 offset:10752
    s_waitcnt lgkmcnt(2)
    v_mfma_f32_16x16x32_bf16 v[56:59], v[84:87], v[152:155], v[56:59]
    ds_read_b64_tr_b16 v[72:73], v2 offset:24576
    v_mfma_f32_16x16x32_bf16 v[60:63], v[84:87], v[224:227], v[60:63]
    ds_read_b64_tr_b16 v[74:75], v2 offset:28672
    ds_read_b64_tr_b16 v[76:77], v3 offset:24576
    ds_read_b64_tr_b16 v[78:79], v3 offset:28672
    ds_read_b64_tr_b16 v[80:81], v4 offset:24576
    ds_read_b64_tr_b16 v[82:83], v4 offset:28672
    ds_read_b64_tr_b16 v[84:85], v5 offset:24576
    ds_read_b64_tr_b16 v[86:87], v5 offset:28672
    s_cmp_lt_u32 s33, 2
    s_cbranch_scc0 .Lk1wvn_114
    s_waitcnt vmcnt(5)
    s_branch .Lk1wve_113
.Lk1wvn_114:
    s_cmp_lt_u32 s33, 3
    s_cbranch_scc0 .Lk1wvn_115
    s_waitcnt vmcnt(5)
    s_branch .Lk1wve_113
.Lk1wvn_115:
    s_waitcnt vmcnt(4)
.Lk1wve_113:
    s_barrier
    s_waitcnt lgkmcnt(8)
    v_mfma_f32_16x16x32_bf16 v[92:95], v[16:19], v[156:159], v[92:95]
    s_add_u32 m0, s66, 90112
    s_add_u32 s53, s64, 4718592
    buffer_load_dwordx4 v6, s[40:43], s53 offen lds
    v_mfma_f32_16x16x32_bf16 v[96:99], v[16:19], v[228:231], v[96:99]
    s_waitcnt lgkmcnt(6)
    v_mfma_f32_16x16x32_bf16 v[32:35], v[72:75], v[156:159], v[32:35]
    ds_read_b64_tr_b16 v[16:17], v13 offset:12288
    v_mfma_f32_16x16x32_bf16 v[36:39], v[72:75], v[228:231], v[36:39]
    ds_read_b64_tr_b16 v[18:19], v13 offset:13824
    s_add_u32 m0, s66, 91136
    s_add_u32 s53, s64, 4718592
    buffer_load_dwordx4 v7, s[40:43], s53 offen lds
    s_waitcnt lgkmcnt(6)
    v_mfma_f32_16x16x32_bf16 v[40:43], v[76:79], v[156:159], v[40:43]
    ds_read_b128 v[160:163], v11 offset:32768
    v_mfma_f32_16x16x32_bf16 v[44:47], v[76:79], v[228:231], v[44:47]
    ds_read_b128 v[232:235], v11 offset:34816
    s_waitcnt lgkmcnt(6)
    v_mfma_f32_16x16x32_bf16 v[48:51], v[80:83], v[156:159], v[48:51]
    ds_read_b128 v[164:167], v12 offset:32768
    s_cmp_lt_u32 s33, 3
    s_cbranch_scc0 .Lk1we_116
    s_add_u32 m0, s68, 65536
    s_nop 0
    global_load_lds_dwordx4 v[24:25], off
    v_add_co_u32 v24, vcc, v24, v26
    s_nop 1
    v_addc_co_u32 v25, vcc, 0, v25, vcc
.Lk1we_116:
    v_mfma_f32_16x16x32_bf16 v[52:55], v[80:83], v[228:231], v[52:55]
    ds_read_b128 v[236:239], v12 offset:34816
    s_waitcnt lgkmcnt(6)
    v_mfma_f32_16x16x32_bf16 v[56:59], v[84:87], v[156:159], v[56:59]
    ds_read_b64_tr_b16 v[72:73], v2 offset:32768
    v_mfma_f32_16x16x32_bf16 v[60:63], v[84:87], v[228:231], v[60:63]
    ds_read_b64_tr_b16 v[74:75], v2 offset:36864
    s_waitcnt lgkmcnt(2)
    v_mfma_f32_16x16x32_bf16 v[92:95], v[16:19], v[160:163], v[92:95]
    ds_read_b64_tr_b16 v[76:77], v3 offset:32768
    s_lshl_b32 s52, s32, 11
    s_add_u32 m0, s52, 0
    s_movk_i32 s53, 1024
    buffer_load_dwordx4 v9, s[36:39], s53 offen lds
    v_mfma_f32_16x16x32_bf16 v[96:99], v[16:19], v[232:235], v[96:99]
    ds_read_b64_tr_b16 v[78:79], v3 offset:36864
    s_waitcnt lgkmcnt(2)
    v_mfma_f32_16x16x32_bf16 v[32:35], v[72:75], v[160:163], v[32:35]
    ds_read_b64_tr_b16 v[80:81], v4 offset:32768
    v_mfma_f32_16x16x32_bf16 v[36:39], v[72:75], v[232:235], v[36:39]
    ds_read_b64_tr_b16 v[82:83], v4 offset:36864
    s_waitcnt lgkmcnt(2)
    v_mfma_f32_16x16x32_bf16 v[40:43], v[76:79], v[160:163], v[40:43]
    ds_read_b64_tr_b16 v[84:85], v5 offset:32768
    v_mfma_f32_16x16x32_bf16 v[44:47], v[76:79], v[232:235], v[44:47]
    ds_read_b64_tr_b16 v[86:87], v5 offset:36864
    s_lshl_b32 s52, s32, 11
    s_add_u32 m0, s52, 1024
    s_movk_i32 s53, 1024
    buffer_load_dwordx4 v10, s[36:39], s53 offen lds
    s_waitcnt lgkmcnt(2)
    v_mfma_f32_16x16x32_bf16 v[48:51], v[80:83], v[160:163], v[48:51]
    ds_read_b64_tr_b16 v[16:17], v13 offset:15360
    v_mfma_f32_16x16x32_bf16 v[52:55], v[80:83], v[232:235], v[52:55]
    ds_read_b64_tr_b16 v[18:19], v13 offset:16896
    s_waitcnt lgkmcnt(2)
    v_mfma_f32_16x16x32_bf16 v[56:59], v[84:87], v[160:163], v[56:59]
    ds_read_b64_tr_b16 v[72:73], v2 offset:40960
    v_mfma_f32_16x16x32_bf16 v[60:63], v[84:87], v[232:235], v[60:63]
    ds_read_b64_tr_b16 v[74:75], v2 offset:45056
    ds_read_b64_tr_b16 v[76:77], v3 offset:40960
    ds_read_b64_tr_b16 v[78:79], v3 offset:45056
    ds_read_b64_tr_b16 v[80:81], v4 offset:40960
    ds_read_b64_tr_b16 v[82:83], v4 offset:45056
    ds_read_b64_tr_b16 v[84:85], v5 offset:40960
    ds_read_b64_tr_b16 v[86:87], v5 offset:45056
    s_cmp_lt_u32 s33, 2
    s_cbranch_scc0 .Lk1wvn_118
    s_waitcnt vmcnt(5)
    s_branch .Lk1wve_117
.Lk1wvn_118:
    s_cmp_lt_u32 s33, 3
    s_cbranch_scc0 .Lk1wvn_119
    s_waitcnt vmcnt(5)
    s_branch .Lk1wve_117
.Lk1wvn_119:
    s_waitcnt vmcnt(4)
.Lk1wve_117:
    s_barrier
    s_waitcnt lgkmcnt(8)
    v_mfma_f32_16x16x32_bf16 v[92:95], v[16:19], v[164:167], v[92:95]
    s_mul_i32 s52, s33, 3
    s_lshl_b32 s53, s33, 1
    s_add_u32 s53, s53, 2
    s_cmp_lt_u32 s33, 2
    s_cselect_b32 s52, s52, s53
    s_lshl_b32 s69, s52, 10
    v_mfma_f32_16x16x32_bf16 v[96:99], v[16:19], v[236:239], v[96:99]
    s_waitcnt lgkmcnt(6)
    v_mfma_f32_16x16x32_bf16 v[32:35], v[72:75], v[164:167], v[32:35]
    ds_read_b64_tr_b16 v[16:17], v13 offset:18432
    s_lshr_b32 s52, s69, 4
    s_add_u32 s52, s52, 0
    v_add_u32 v27, s52, v1
    v_min_u32 v27, 639, v27
    v_mul_u32_u24 v28, 52429, v27
    v_lshrrev_b32 v28, 20, v28
    v_mul_u32_u24 v29, 20, v28
    v_sub_u32 v29, v27, v29
    v_bfe_u32 v30, v28, 2, 1
    v_lshlrev_b32 v30, 1, v30
    v_xor_b32 v29, v29, v30
    v_and_b32 v30, 3, v28
    v_bfe_u32 v31, v28, 2, 2
    v_lshl_add_u32 v30, v31, 3, v30
    v_bfe_u32 v31, v28, 4, 1
    v_lshl_add_u32 v30, v31, 2, v30
    v_mul_u32_u24 v30, 9216, v30
    v_lshl_add_u32 v6, v29, 4, v30
    v_mfma_f32_16x16x32_bf16 v[36:39], v[72:75], v[236:239], v[36:39]
    ds_read_b64_tr_b16 v[18:19], v13 offset:19968
    s_waitcnt lgkmcnt(6)
    v_mfma_f32_16x16x32_bf16 v[40:43], v[76:79], v[164:167], v[40:43]
    ds_read_b128 v[168:171], v11 offset:49152
    v_mfma_f32_16x16x32_bf16 v[44:47], v[76:79], v[236:239], v[44:47]
    ds_read_b128 v[240:243], v11 offset:51200
    s_lshr_b32 s52, s69, 4
    s_add_u32 s52, s52, 64
    v_add_u32 v27, s52, v1
    v_min_u32 v27, 639, v27
    v_mul_u32_u24 v28, 52429, v27
    v_lshrrev_b32 v28, 20, v28
    v_mul_u32_u24 v29, 20, v28
    v_sub_u32 v29, v27, v29
    v_bfe_u32 v30, v28, 2, 1
    v_lshlrev_b32 v30, 1, v30
    v_xor_b32 v29, v29, v30
    v_and_b32 v30, 3, v28
    v_bfe_u32 v31, v28, 2, 2
    v_lshl_add_u32 v30, v31, 3, v30
    v_bfe_u32 v31, v28, 4, 1
    v_lshl_add_u32 v30, v31, 2, v30
    v_mul_u32_u24 v30, 9216, v30
    v_lshl_add_u32 v7, v29, 4, v30
    s_waitcnt lgkmcnt(6)
    v_mfma_f32_16x16x32_bf16 v[48:51], v[80:83], v[164:167], v[48:51]
    ds_read_b128 v[172:175], v12 offset:49152
    v_mfma_f32_16x16x32_bf16 v[52:55], v[80:83], v[236:239], v[52:55]
    ds_read_b128 v[244:247], v12 offset:51200
    s_lshr_b32 s52, s69, 4
    s_add_u32 s52, s52, 128
    v_add_u32 v27, s52, v1
    v_min_u32 v27, 639, v27
    v_mul_u32_u24 v28, 52429, v27
    v_lshrrev_b32 v28, 20, v28
    v_mul_u32_u24 v29, 20, v28
    v_sub_u32 v29, v27, v29
    v_bfe_u32 v30, v28, 2, 1
    v_lshlrev_b32 v30, 1, v30
    v_xor_b32 v29, v29, v30
    v_and_b32 v30, 3, v28
    v_bfe_u32 v31, v28, 2, 2
    v_lshl_add_u32 v30, v31, 3, v30
    v_bfe_u32 v31, v28, 4, 1
    v_lshl_add_u32 v30, v31, 2, v30
    v_mul_u32_u24 v30, 9216, v30
    v_lshl_add_u32 v9, v29, 4, v30
    s_waitcnt lgkmcnt(6)
    v_mfma_f32_16x16x32_bf16 v[56:59], v[84:87], v[164:167], v[56:59]
    ds_read_b64_tr_b16 v[72:73], v2 offset:49152
    v_mfma_f32_16x16x32_bf16 v[60:63], v[84:87], v[236:239], v[60:63]
    ds_read_b64_tr_b16 v[74:75], v2 offset:53248
    s_waitcnt lgkmcnt(2)
    v_mfma_f32_16x16x32_bf16 v[92:95], v[16:19], v[168:171], v[92:95]
    ds_read_b64_tr_b16 v[76:77], v3 offset:49152
    s_add_u32 m0, s69, 16384
    s_add_u32 s53, s65, 0
    buffer_load_dwordx4 v6, s[40:43], s53 offen lds
    v_mfma_f32_16x16x32_bf16 v[96:99], v[16:19], v[240:243], v[96:99]
    ds_read_b64_tr_b16 v[78:79], v3 offset:53248
    s_waitcnt lgkmcnt(2)
    v_mfma_f32_16x16x32_bf16 v[32:35], v[72:75], v[168:171], v[32:35]
    ds_read_b64_tr_b16 v[80:81], v4 offset:49152
    v_mfma_f32_16x16x32_bf16 v[36:39], v[72:75], v[240:243], v[36:39]
    ds_read_b64_tr_b16 v[82:83], v4 offset:53248
    s_add_u32 m0, s69, 17408
    s_add_u32 s53, s65, 0
    buffer_load_dwordx4 v7, s[40:43], s53 offen lds
    s_waitcnt lgkmcnt(2)
    v_mfma_f32_16x16x32_bf16 v[40:43], v[76:79], v[168:171], v[40:43]
    ds_read_b64_tr_b16 v[84:85], v5 offset:49152
    v_mfma_f32_16x16x32_bf16 v[44:47], v[76:79], v[240:243], v[44:47]
    ds_read_b64_tr_b16 v[86:87], v5 offset:53248
    s_waitcnt lgkmcnt(2)
    v_mfma_f32_16x16x32_bf16 v[48:51], v[80:83], v[168:171], v[48:51]
    ds_read_b64_tr_b16 v[16:17], v13 offset:21504
    s_cmp_lt_u32 s33, 2
    s_cbranch_scc0 .Lk1wb_120
    s_add_u32 m0, s69, 18432
    s_add_u32 s53, s65, 0
    buffer_load_dwordx4 v9, s[40:43], s53 offen lds
.Lk1wb_120:
    v_mfma_f32_16x16x32_bf16 v[52:55], v[80:83], v[240:243], v[52:55]
    ds_read_b64_tr_b16 v[18:19], v13 offset:23040
    s_waitcnt lgkmcnt(2)
    v_mfma_f32_16x16x32_bf16 v[56:59], v[84:87], v[168:171], v[56:59]
    ds_read_b64_tr_b16 v[72:73], v2 offset:57344
    v_mfma_f32_16x16x32_bf16 v[60:63], v[84:87], v[240:243], v[60:63]
    ds_read_b64_tr_b16 v[74:75], v2 offset:61440
    ds_read_b64_tr_b16 v[76:77], v3 offset:57344
    ds_read_b64_tr_b16 v[78:79], v3 offset:61440
    ds_read_b64_tr_b16 v[80:81], v4 offset:57344
    ds_read_b64_tr_b16 v[82:83], v4 offset:61440
    ds_read_b64_tr_b16 v[84:85], v5 offset:57344
    ds_read_b64_tr_b16 v[86:87], v5 offset:61440
    s_cmp_lt_u32 s33, 2
    s_cbranch_scc0 .Lk1wvn_122
    s_waitcnt vmcnt(3)
    s_branch .Lk1wve_121
.Lk1wvn_122:
    s_cmp_lt_u32 s33, 3
    s_cbranch_scc0 .Lk1wvn_123
    s_waitcnt vmcnt(2)
    s_branch .Lk1wve_121
.Lk1wvn_123:
    s_waitcnt vmcnt(2)
.Lk1wve_121:
    s_barrier
    s_waitcnt lgkmcnt(8)
    v_mfma_f32_16x16x32_bf16 v[92:95], v[16:19], v[172:175], v[92:95]
    v_and_b32 v27, 15, v1
    v_lshrrev_b32 v28, 4, v1
    v_lshrrev_b32 v29, 2, v27
    v_lshl_add_u32 v29, v28, 2, v29
    v_mul_u32_u24 v29, 320, v29
    v_and_b32 v27, 3, v27
    v_lshl_add_u32 v29, v27, 3, v29
    v_and_b32 v28, 1, v28
    v_lshlrev_b32 v28, 5, v28
    v_add_u32 v108, v29, v28
    v_sub_u32 v109, v29, v28
    v_add_u32 v110, 90112, v108
    v_add_u32 v111, 90112, v109
    v_mfma_f32_16x16x32_bf16 v[96:99], v[16:19], v[244:247], v[96:99]
    s_waitcnt lgkmcnt(6)
    v_mfma_f32_16x16x32_bf16 v[32:35], v[72:75], v[172:175], v[32:35]
    ds_read_b64_tr_b16 v[16:17], v13 offset:0
    v_mfma_f32_16x16x32_bf16 v[36:39], v[72:75], v[244:247], v[36:39]
    ds_read_b64_tr_b16 v[18:19], v13 offset:1536
    s_waitcnt lgkmcnt(6)
    v_mfma_f32_16x16x32_bf16 v[40:43], v[76:79], v[172:175], v[40:43]
    ds_read_b128 v[176:179], v11 offset:0
    v_mfma_f32_16x16x32_bf16 v[44:47], v[76:79], v[244:247], v[44:47]
    ds_read_b128 v[248:251], v11 offset:2048
    s_add_u32 m0, s69, 36864
    s_add_u32 s53, s65, 589824
    buffer_load_dwordx4 v6, s[40:43], s53 offen lds
    s_waitcnt lgkmcnt(6)
    v_mfma_f32_16x16x32_bf16 v[48:51], v[80:83], v[172:175], v[48:51]
    ds_read_b128 v[180:183], v12 offset:0
    v_mfma_f32_16x16x32_bf16 v[52:55], v[80:83], v[244:247], v[52:55]
    ds_read_b128 v[252:255], v12 offset:2048
    s_waitcnt lgkmcnt(6)
    v_mfma_f32_16x16x32_bf16 v[56:59], v[84:87], v[172:175], v[56:59]
    ds_read_b64_tr_b16 v[72:73], v2 offset:0
    v_mfma_f32_16x16x32_bf16 v[60:63], v[84:87], v[244:247], v[60:63]
    ds_read_b64_tr_b16 v[74:75], v2 offset:4096
    s_waitcnt lgkmcnt(2)
    v_mfma_f32_16x16x32_bf16 v[92:95], v[16:19], v[176:179], v[92:95]
    ds_read_b64_tr_b16 v[76:77], v3 offset:0
    s_add_u32 m0, s69, 37888
    s_add_u32 s53, s65, 589824
    buffer_load_dwordx4 v7, s[40:43], s53 offen lds
    v_mfma_f32_16x16x32_bf16 v[96:99], v[16:19], v[248:251], v[96:99]
    ds_read_b64_tr_b16 v[78:79], v3 offset:4096
    s_waitcnt lgkmcnt(2)
    v_mfma_f32_16x16x32_bf16 v[32:35], v[72:75], v[176:179], v[32:35]
    ds_read_b64_tr_b16 v[80:81], v4 offset:0
    v_mfma_f32_16x16x32_bf16 v[36:39], v[72:75], v[248:251], v[36:39]
    ds_read_b64_tr_b16 v[82:83], v4 offset:4096
    s_waitcnt lgkmcnt(2)
    v_mfma_f32_16x16x32_bf16 v[40:43], v[76:79], v[176:179], v[40:43]
    ds_read_b64_tr_b16 v[84:85], v5 offset:0
    v_mfma_f32_16x16x32_bf16 v[44:47], v[76:79], v[248:251], v[44:47]
    ds_read_b64_tr_b16 v[86:87], v5 offset:4096
    s_cmp_lt_u32 s33, 2
    s_cbranch_scc0 .Lk1wb_124
    s_add_u32 m0, s69, 38912
    s_add_u32 s53, s65, 589824
    buffer_load_dwordx4 v9, s[40:43], s53 offen lds
.Lk1wb_124:
    s_waitcnt lgkmcnt(2)
    v_mfma_f32_16x16x32_bf16 v[48:51], v[80:83], v[176:179], v[48:51]
    ds_read_b64_tr_b16 v[16:17], v13 offset:3072
    v_mfma_f32_16x16x32_bf16 v[52:55], v[80:83], v[248:251], v[52:55]
    ds_read_b64_tr_b16 v[18:19], v13 offset:4608
    s_waitcnt lgkmcnt(2)
    v_mfma_f32_16x16x32_bf16 v[56:59], v[84:87], v[176:179], v[56:59]
    ds_read_b64_tr_b16 v[72:73], v2 offset:8192
    v_mfma_f32_16x16x32_bf16 v[60:63], v[84:87], v[248:251], v[60:63]
    ds_read_b64_tr_b16 v[74:75], v2 offset:12288
    ds_read_b64_tr_b16 v[76:77], v3 offset:8192
    ds_read_b64_tr_b16 v[78:79], v3 offset:12288
    ds_read_b64_tr_b16 v[80:81], v4 offset:8192
    ds_read_b64_tr_b16 v[82:83], v4 offset:12288
    ds_read_b64_tr_b16 v[84:85], v5 offset:8192
    ds_read_b64_tr_b16 v[86:87], v5 offset:12288
    s_cmp_lt_u32 s33, 2
    s_cbranch_scc0 .Lk1wvn_126
    s_waitcnt vmcnt(3)
    s_branch .Lk1wve_125
.Lk1wvn_126:
    s_cmp_lt_u32 s33, 3
    s_cbranch_scc0 .Lk1wvn_127
    s_waitcnt vmcnt(2)
    s_branch .Lk1wve_125
.Lk1wvn_127:
    s_waitcnt vmcnt(2)
.Lk1wve_125:
    s_barrier
    s_waitcnt lgkmcnt(8)
    v_mfma_f32_16x16x32_bf16 v[92:95], v[16:19], v[180:183], v[92:95]
    s_add_u32 m0, s69, 0
    s_add_u32 s53, s65, 1179648
    buffer_load_dwordx4 v6, s[40:43], s53 offen lds
    v_mfma_f32_16x16x32_bf16 v[96:99], v[16:19], v[252:255], v[96:99]
    s_waitcnt lgkmcnt(6)
    v_mfma_f32_16x16x32_bf16 v[32:35], v[72:75], v[180:183], v[32:35]
    v_mfma_f32_16x16x32_bf16 v[36:39], v[72:75], v[252:255], v[36:39]
    s_waitcnt lgkmcnt(4)
    v_mfma_f32_16x16x32_bf16 v[40:43], v[76:79], v[180:183], v[40:43]
    ds_read_b64_tr_b16 v[72:73], v109 offset:16544
    v_mfma_f32_16x16x32_bf16 v[44:47], v[76:79], v[252:255], v[44:47]
    ds_read_b64_tr_b16 v[74:75], v109 offset:21664
    s_add_u32 m0, s69, 1024
    s_add_u32 s53, s65, 1179648
    buffer_load_dwordx4 v7, s[40:43], s53 offen lds
    s_waitcnt lgkmcnt(4)
    v_mfma_f32_16x16x32_bf16 v[48:51], v[80:83], v[180:183], v[48:51]
    ds_read_b64_tr_b16 v[76:77], v108 offset:16576
    v_mov_b32 v2, v92
    v_mul_f32 v92, v14, v92
    v_mul_f32 v93, v14, v93
    v_mul_f32 v94, v14, v94
    v_mul_f32 v95, v14, v95
    v_cvt_pk_bf16_f32 v24, v92, v93
    v_mfma_f32_16x16x32_bf16 v[52:55], v[80:83], v[252:255], v[52:55]
    ds_read_b64_tr_b16 v[78:79], v108 offset:21696
    v_cvt_pk_bf16_f32 v25, v94, v95
    v_mov_b32 v3, v96
    v_mul_f32 v96, v14, v96
    v_mul_f32 v97, v14, v97
    v_mul_f32 v98, v14, v98
    v_mul_f32 v99, v14, v99
    s_waitcnt lgkmcnt(4)
    v_mfma_f32_16x16x32_bf16 v[56:59], v[84:87], v[180:183], v[56:59]
    ds_read_b64_tr_b16 v[80:81], v109 offset:16608
    v_cvt_pk_bf16_f32 v26, v96, v97
    v_cvt_pk_bf16_f32 v27, v98, v99
    v_mfma_f32_16x16x32_bf16 v[60:63], v[84:87], v[252:255], v[60:63]
    ds_read_b64_tr_b16 v[82:83], v109 offset:21728
    v_cvt_pk_bf16_f32 v92, v32, v33
    v_cvt_pk_bf16_f32 v93, v34, v35
    v_pk_max_i16 v92, v92, 0
    v_pk_max_i16 v93, v93, 0
    v_cvt_pk_bf16_f32 v96, v36, v37
    v_cvt_pk_bf16_f32 v97, v38, v39
    ds_read_b64_tr_b16 v[84:85], v108 offset:16640
    ds_read_b64_tr_b16 v[86:87], v108 offset:21760
    ds_read_b64_tr_b16 v[88:89], v109 offset:16672
    ds_read_b64_tr_b16 v[90:91], v109 offset:21792
    s_nop 7
    v_pk_max_i16 v96, v96, 0
    v_pk_max_i16 v97, v97, 0
    v_cvt_pk_bf16_f32 v94, v40, v41
    v_cvt_pk_bf16_f32 v95, v42, v43
    v_pk_max_i16 v94, v94, 0
    v_pk_max_i16 v95, v95, 0
    v_cvt_pk_bf16_f32 v98, v44, v45
    v_cvt_pk_bf16_f32 v99, v46, v47
    v_pk_max_i16 v98, v98, 0
    v_pk_max_i16 v99, v99, 0
    v_cvt_pk_bf16_f32 v100, v48, v49
    v_cvt_pk_bf16_f32 v101, v50, v51
    v_pk_max_i16 v100, v100, 0
    v_pk_max_i16 v101, v101, 0
    v_cvt_pk_bf16_f32 v104, v52, v53
    v_cvt_pk_bf16_f32 v105, v54, v55
    v_pk_max_i16 v104, v104, 0
    v_pk_max_i16 v105, v105, 0
    v_cvt_pk_bf16_f32 v102, v56, v57
    v_cvt_pk_bf16_f32 v103, v58, v59
    v_pk_max_i16 v102, v102, 0
    v_pk_max_i16 v103, v103, 0
    v_cvt_pk_bf16_f32 v106, v60, v61
    v_cvt_pk_bf16_f32 v107, v62, v63
    v_pk_max_i16 v106, v106, 0
    v_pk_max_i16 v107, v107, 0
    s_nop 1
    s_waitcnt lgkmcnt(8)
    v_mfma_f32_16x16x32_bf16 v[32:35], v[72:75], v[112:115], 0
    s_cmp_lt_u32 s33, 2
    s_cbranch_scc0 .Lk1wb_128
    s_add_u32 m0, s69, 2048
    s_add_u32 s53, s65, 1179648
    buffer_load_dwordx4 v9, s[40:43], s53 offen lds
.Lk1wb_128:
    v_mfma_f32_16x16x32_bf16 v[36:39], v[72:75], v[184:187], 0
    s_waitcnt lgkmcnt(6)
    v_mfma_f32_16x16x32_bf16 v[40:43], v[76:79], v[112:115], 0
    ds_read_b64_tr_b16 v[72:73], v109 offset:26784
    v_mfma_f32_16x16x32_bf16 v[44:47], v[76:79], v[184:187], 0
    ds_read_b64_tr_b16 v[74:75], v109 offset:31904
    s_waitcnt lgkmcnt(6)
    v_mfma_f32_16x16x32_bf16 v[48:51], v[80:83], v[112:115], 0
    ds_read_b64_tr_b16 v[76:77], v108 offset:26816
    v_mfma_f32_16x16x32_bf16 v[52:55], v[80:83], v[184:187], 0
    ds_read_b64_tr_b16 v[78:79], v108 offset:31936
    s_waitcnt lgkmcnt(6)
    v_mfma_f32_16x16x32_bf16 v[56:59], v[84:87], v[112:115], 0
    ds_read_b64_tr_b16 v[80:81], v109 offset:26848
    v_mfma_f32_16x16x32_bf16 v[60:63], v[84:87], v[184:187], 0
    ds_read_b64_tr_b16 v[82:83], v109 offset:31968
    s_waitcnt lgkmcnt(6)
    v_mfma_f32_16x16x32_bf16 v[64:67], v[88:91], v[112:115], 0
    ds_read_b64_tr_b16 v[84:85], v108 offset:26880
    v_mfma_f32_16x16x32_bf16 v[68:71], v[88:91], v[184:187], 0
    ds_read_b64_tr_b16 v[86:87], v108 offset:32000
    ds_read_b64_tr_b16 v[88:89], v109 offset:26912
    ds_read_b64_tr_b16 v[90:91], v109 offset:32032
    s_cmp_lt_u32 s33, 2
    s_cbranch_scc0 .Lk1wvn_130
    s_waitcnt vmcnt(3)
    s_branch .Lk1wve_129
.Lk1wvn_130:
    s_cmp_lt_u32 s33, 3
    s_cbranch_scc0 .Lk1wvn_131
    s_waitcnt vmcnt(2)
    s_branch .Lk1wve_129
.Lk1wvn_131:
    s_waitcnt vmcnt(2)
.Lk1wve_129:
    s_barrier
    s_waitcnt lgkmcnt(8)
    v_mfma_f32_16x16x32_bf16 v[32:35], v[72:75], v[116:119], v[32:35]
    s_add_u32 m0, s69, 90112
    s_add_u32 s53, s65, 1769472
    buffer_load_dwordx4 v6, s[40:43], s53 offen lds
    v_mfma_f32_16x16x32_bf16 v[36:39], v[72:75], v[188:191], v[36:39]
    s_waitcnt lgkmcnt(6)
    v_mfma_f32_16x16x32_bf16 v[40:43], v[76:79], v[116:119], v[40:43]
    ds_read_b64_tr_b16 v[72:73], v109 offset:37024
    v_mfma_f32_16x16x32_bf16 v[44:47], v[76:79], v[188:191], v[44:47]
    ds_read_b64_tr_b16 v[74:75], v109 offset:42144
    s_add_u32 m0, s69, 91136
    s_add_u32 s53, s65, 1769472
    buffer_load_dwordx4 v7, s[40:43], s53 offen lds
    s_waitcnt lgkmcnt(6)
    v_mfma_f32_16x16x32_bf16 v[48:51], v[80:83], v[116:119], v[48:51]
    ds_read_b64_tr_b16 v[76:77], v108 offset:37056
    v_mfma_f32_16x16x32_bf16 v[52:55], v[80:83], v[188:191], v[52:55]
    ds_read_b64_tr_b16 v[78:79], v108 offset:42176
    s_waitcnt lgkmcnt(6)
    v_mfma_f32_16x16x32_bf16 v[56:59], v[84:87], v[116:119], v[56:59]
    ds_read_b64_tr_b16 v[80:81], v109 offset:37088
    v_and_b32 v11, 15, v1
    v_lshrrev_b32 v12, 4, v1
    s_lshl_b32 s56, s33, 5
    s_add_u32 s56, s56, 0
    v_add_u32 v13, s56, v11
    v_mul_u32_u24 v15, 48, v13
    v_add_u32 v15, 77852, v15
    v_cmp_eq_u32 vcc, 1, v12
    s_nop 1
    s_and_saveexec_b64 s[58:59], vcc
    ds_write_b32 v15, v24
    ds_write_b32 v15, v25 offset:4
    s_mov_b64 exec, s[58:59]
    v_mov_b32 v18, 0x7f000000
    s_cmp_ge_u32 s29, 6
    s_cbranch_scc1 .Lk1gate_136
    s_lshl_b32 s56, s28, 7
    v_add_u32 v14, s56, v13
    s_cmp_ge_u32 s29, 2
    s_cbranch_scc1 .Lk1k2_133
    v_lshrrev_b32 v15, 5, v14
    v_lshlrev_b32 v15, 10, v15
    v_and_b32 v16, 31, v14
    v_lshl_add_u32 v15, v16, 4, v15
    v_lshl_add_u32 v15, v12, 3, v15
    s_lshl_b32 s57, s29, 9
    s_sub_u32 s57, s57, 16
    v_add_u32 v15, s57, v15
    v_cmp_le_u32 vcc, 2, v12
    v_mov_b32 v19, 0
    v_dot2_f32_bf16 v19, v24, v24, v19
    v_cndmask_b32 v15, v18, v15, vcc
    v_dot2_f32_bf16 v19, v25, v25, v19
    buffer_store_dwordx2 v[24:25], v15, s[44:47], 0 offen sc1
    s_nop 1
    v_mov_b32 v20, v19
    s_nop 1
    v_permlane16_swap_b32 v19, v20
    s_nop 1
    v_add_f32 v19, v19, v20
    s_branch .Lk1km_137
.Lk1k2_133:
    s_cmp_ge_u32 s29, 3
    s_cbranch_scc1 .Lk1v_134
    v_lshlrev_b32 v15, 2, v14
    v_add_u32 v15, 65536, v15
    v_cmp_eq_u32 vcc, 3, v12
    v_mov_b32 v19, 0
    v_dot2_f32_bf16 v19, v25, v25, v19
    v_cndmask_b32 v15, v18, v15, vcc
    buffer_store_dword v25, v15, s[44:47], 0 offen sc1
.Lk1km_137:
    v_mov_b32 v20, 0
    v_cndmask_b32 v21, v20, v19, vcc
    s_branch .Lk1kvend_132
.Lk1v_134:
    s_lshl_b32 s57, s28, 3
    s_lshl_b32 s58, s33, 1
    s_add_u32 s57, s57, s58
    s_add_u32 s57, s57, 0
    s_mul_i32 s57, s57, 672
    s_add_u32 s57, s57, 73728
    s_lshl_b32 s58, s33, 9
    s_add_u32 s58, s58, 83968
    v_bfe_u32 v15, v11, 2, 1
    v_lshlrev_b32 v15, 7, v15
    v_lshrrev_b32 v16, 3, v11
    v_lshl_add_u32 v15, v16, 3, v15
    v_and_b32 v16, 3, v11
    v_lshl_add_u32 v15, v16, 1, v15
    v_add_u32 v16, -2, v12
    v_lshl_add_u32 v15, v16, 6, v15
    v_add_u32 v15, s58, v15
    v_cmp_le_u32 vcc, 2, v12
    s_nop 1
    s_and_saveexec_b64 s[54:55], vcc
    ds_write_b16 v15, v24
    ds_write_b16_d16_hi v15, v24 offset:16
    ds_write_b16 v15, v25 offset:32
    ds_write_b16_d16_hi v15, v25 offset:48
    s_mov_b64 exec, s[54:55]
    v_lshlrev_b32 v16, 4, v1
    v_and_b32 v16, 0xff, v16
    v_add_u32 v16, s58, v16
    ds_read_b128 v[20:23], v16
    v_bfe_u32 v15, v1, 3, 1
    v_mul_u32_u24 v15, 336, v15
    v_and_b32 v16, 7, v1
    s_cmp_eq_u32 s29, 5
    s_cbranch_scc1 .Lk1v2_135
    s_sub_u32 s58, s29, 3
    s_lshl_b32 s58, s58, 7
    v_lshl_add_u32 v15, v16, 4, v15
    v_add_u32 v15, s58, v15
    v_mov_b32 v16, 0x7f000000
    v_cmp_gt_u32 vcc, 16, v1
    s_nop 1
    v_cndmask_b32 v15, v16, v15, vcc
    s_waitcnt lgkmcnt(0)
    buffer_store_dwordx4 v[20:23], v15, s[44:47], s57 offen sc1
    s_nop 1
    s_branch .Lk1kvend_132
.Lk1v2_135:
    s_waitcnt lgkmcnt(0)
    v_cmp_eq_u32 vcc, 0, v16
    v_mov_b32 v17, 0x3f803f80
    v_mov_b32 v14, 0
    v_cndmask_b32 v17, v14, v17, vcc
    v_cmp_gt_u32 vcc, 6, v16
    s_nop 1
    v_cndmask_b32 v20, v20, v17, vcc
    v_cndmask_b32 v21, v21, v17, vcc
    v_cndmask_b32 v22, v22, v17, vcc
    v_cndmask_b32 v23, v23, v17, vcc
    v_add_u32 v17, 10, v16
    v_add_u32 v14, 18, v16
    v_cndmask_b32 v17, v17, v14, vcc
    v_lshl_add_u32 v15, v17, 4, v15
    v_cmp_gt_u32 vcc, 21, v17
    v_cmp_gt_u32 s[54:55], 16, v1
    v_mov_b32 v16, 0x7f000000
    s_and_b64 vcc, vcc, s[54:55]
    s_nop 0
    v_cndmask_b32 v15, v16, v15, vcc
    buffer_store_dwordx4 v[20:23], v15, s[44:47], s57 offen sc1
    s_nop 1
    s_branch .Lk1kvend_132
.Lk1gate_136:
    s_cmp_eq_u32 s29, 6
    s_cbranch_scc0 .Lk1kvend_132
    v_mov_b32 v19, 0x42700000
    v_med3_f32 v2, v2, v19, -v19
    v_mul_f32 v2, 0x3fb8aa3b, v2
    v_exp_f32 v2, v2
    s_lshl_b32 s56, s28, 9
    v_add_f32 v19, 1.0, v2
    v_rcp_f32 v19, v19
    s_add_u32 s56, s56, 163840
    v_lshlrev_b32 v15, 2, v13
    v_cmp_eq_u32 vcc, 2, v12
    s_nop 1
    v_cndmask_b32 v15, v18, v15, vcc
    buffer_store_dword v2, v15, s[44:47], s56 offen sc1
    s_add_u32 s56, s56, 8192
    buffer_store_dword v19, v15, s[44:47], s56 offen sc1
.Lk1kvend_132:
    v_mfma_f32_16x16x32_bf16 v[60:63], v[84:87], v[188:191], v[60:63]
    ds_read_b64_tr_b16 v[82:83], v109 offset:42208
    s_waitcnt lgkmcnt(8)
    v_mfma_f32_16x16x32_bf16 v[64:67], v[88:91], v[116:119], v[64:67]
    ds_read_b64_tr_b16 v[84:85], v108 offset:37120
    v_mfma_f32_16x16x32_bf16 v[68:71], v[88:91], v[188:191], v[68:71]
    ds_read_b64_tr_b16 v[86:87], v108 offset:42240
    s_waitcnt lgkmcnt(8)
    v_mfma_f32_16x16x32_bf16 v[32:35], v[72:75], v[120:123], v[32:35]
    ds_read_b64_tr_b16 v[88:89], v109 offset:37152
    s_cmp_lt_u32 s33, 2
    s_cbranch_scc0 .Lk1wb_138
    s_add_u32 m0, s69, 92160
    s_add_u32 s53, s65, 1769472
    buffer_load_dwordx4 v9, s[40:43], s53 offen lds
.Lk1wb_138:
    v_mfma_f32_16x16x32_bf16 v[36:39], v[72:75], v[192:195], v[36:39]
    ds_read_b64_tr_b16 v[90:91], v109 offset:42272
    s_waitcnt lgkmcnt(8)
    v_mfma_f32_16x16x32_bf16 v[40:43], v[76:79], v[120:123], v[40:43]
    ds_read_b64_tr_b16 v[72:73], v109 offset:47264
    v_mfma_f32_16x16x32_bf16 v[44:47], v[76:79], v[192:195], v[44:47]
    ds_read_b64_tr_b16 v[74:75], v109 offset:52384
    s_waitcnt lgkmcnt(6)
    v_mfma_f32_16x16x32_bf16 v[48:51], v[80:83], v[120:123], v[48:51]
    ds_read_b64_tr_b16 v[76:77], v108 offset:47296
    v_mfma_f32_16x16x32_bf16 v[52:55], v[80:83], v[192:195], v[52:55]
    ds_read_b64_tr_b16 v[78:79], v108 offset:52416
    v_and_b32 v11, 15, v1
    v_lshrrev_b32 v12, 4, v1
    s_lshl_b32 s56, s33, 5
    s_add_u32 s56, s56, 16
    v_add_u32 v13, s56, v11
    v_mul_u32_u24 v15, 48, v13
    v_add_u32 v15, 77852, v15
    v_cmp_eq_u32 vcc, 1, v12
    s_nop 1
    s_and_saveexec_b64 s[58:59], vcc
    ds_write_b32 v15, v26
    ds_write_b32 v15, v27 offset:4
    s_mov_b64 exec, s[58:59]
    v_mov_b32 v18, 0x7f000000
    s_cmp_ge_u32 s29, 6
    s_cbranch_scc1 .Lk1gate_143
    s_lshl_b32 s56, s28, 7
    v_add_u32 v14, s56, v13
    s_cmp_ge_u32 s29, 2
    s_cbranch_scc1 .Lk1k2_140
    v_lshrrev_b32 v15, 5, v14
    v_lshlrev_b32 v15, 10, v15
    v_and_b32 v16, 31, v14
    v_lshl_add_u32 v15, v16, 4, v15
    v_lshl_add_u32 v15, v12, 3, v15
    s_lshl_b32 s57, s29, 9
    s_sub_u32 s57, s57, 16
    v_add_u32 v15, s57, v15
    v_cmp_le_u32 vcc, 2, v12
    v_mov_b32 v19, 0
    v_dot2_f32_bf16 v19, v26, v26, v19
    v_cndmask_b32 v15, v18, v15, vcc
    v_dot2_f32_bf16 v19, v27, v27, v19
    buffer_store_dwordx2 v[26:27], v15, s[44:47], 0 offen sc1
    s_nop 1
    v_mov_b32 v20, v19
    s_nop 1
    v_permlane16_swap_b32 v19, v20
    s_nop 1
    v_add_f32 v19, v19, v20
    s_branch .Lk1km_144
.Lk1k2_140:
    s_cmp_ge_u32 s29, 3
    s_cbranch_scc1 .Lk1v_141
    v_lshlrev_b32 v15, 2, v14
    v_add_u32 v15, 65536, v15
    v_cmp_eq_u32 vcc, 3, v12
    v_mov_b32 v19, 0
    v_dot2_f32_bf16 v19, v27, v27, v19
    v_cndmask_b32 v15, v18, v15, vcc
    buffer_store_dword v27, v15, s[44:47], 0 offen sc1
.Lk1km_144:
    v_mov_b32 v20, 0
    v_cndmask_b32 v19, v20, v19, vcc
    v_max_f32 v21, v21, v19
    s_nop 1
    v_max_f32_dpp v21, v21, v21 row_ror:8 row_mask:0xf bank_mask:0xf
    s_nop 1
    v_max_f32_dpp v21, v21, v21 row_ror:4 row_mask:0xf bank_mask:0xf
    s_nop 1
    v_max_f32_dpp v21, v21, v21 row_ror:2 row_mask:0xf bank_mask:0xf
    s_nop 1
    v_max_f32_dpp v21, v21, v21 row_ror:1 row_mask:0xf bank_mask:0xf
    v_mov_b32 v20, 86016
    s_mov_b64 s[54:55], exec
    s_mov_b32 exec_lo, 0
    s_mov_b32 exec_hi, 0x00010001
    ds_max_u32 v20, v21
    s_mov_b64 exec, s[54:55]
    s_branch .Lk1kvend_139
.Lk1v_141:
    s_lshl_b32 s57, s28, 3
    s_lshl_b32 s58, s33, 1
    s_add_u32 s57, s57, s58
    s_add_u32 s57, s57, 1
    s_mul_i32 s57, s57, 672
    s_add_u32 s57, s57, 73728
    s_lshl_b32 s58, s33, 9
    s_add_u32 s58, s58, 84224
    v_bfe_u32 v15, v11, 2, 1
    v_lshlrev_b32 v15, 7, v15
    v_lshrrev_b32 v16, 3, v11
    v_lshl_add_u32 v15, v16, 3, v15
    v_and_b32 v16, 3, v11
    v_lshl_add_u32 v15, v16, 1, v15
    v_add_u32 v16, -2, v12
    v_lshl_add_u32 v15, v16, 6, v15
    v_add_u32 v15, s58, v15
    v_cmp_le_u32 vcc, 2, v12
    s_nop 1
    s_and_saveexec_b64 s[54:55], vcc
    ds_write_b16 v15, v26
    ds_write_b16_d16_hi v15, v26 offset:16
    ds_write_b16 v15, v27 offset:32
    ds_write_b16_d16_hi v15, v27 offset:48
    s_mov_b64 exec, s[54:55]
    v_lshlrev_b32 v16, 4, v1
    v_and_b32 v16, 0xff, v16
    v_add_u32 v16, s58, v16
    ds_read_b128 v[20:23], v16
    v_bfe_u32 v15, v1, 3, 1
    v_mul_u32_u24 v15, 336, v15
    v_and_b32 v16, 7, v1
    s_cmp_eq_u32 s29, 5
    s_cbranch_scc1 .Lk1v2_142
    s_sub_u32 s58, s29, 3
    s_lshl_b32 s58, s58, 7
    v_lshl_add_u32 v15, v16, 4, v15
    v_add_u32 v15, s58, v15
    v_mov_b32 v16, 0x7f000000
    v_cmp_gt_u32 vcc, 16, v1
    s_nop 1
    v_cndmask_b32 v15, v16, v15, vcc
    s_waitcnt lgkmcnt(0)
    buffer_store_dwordx4 v[20:23], v15, s[44:47], s57 offen sc1
    s_nop 1
    s_branch .Lk1kvend_139
.Lk1v2_142:
    s_waitcnt lgkmcnt(0)
    v_cmp_eq_u32 vcc, 0, v16
    v_mov_b32 v17, 0x3f803f80
    v_mov_b32 v14, 0
    v_cndmask_b32 v17, v14, v17, vcc
    v_cmp_gt_u32 vcc, 6, v16
    s_nop 1
    v_cndmask_b32 v20, v20, v17, vcc
    v_cndmask_b32 v21, v21, v17, vcc
    v_cndmask_b32 v22, v22, v17, vcc
    v_cndmask_b32 v23, v23, v17, vcc
    v_add_u32 v17, 10, v16
    v_add_u32 v14, 18, v16
    v_cndmask_b32 v17, v17, v14, vcc
    v_lshl_add_u32 v15, v17, 4, v15
    v_cmp_gt_u32 vcc, 21, v17
    v_cmp_gt_u32 s[54:55], 16, v1
    v_mov_b32 v16, 0x7f000000
    s_and_b64 vcc, vcc, s[54:55]
    s_nop 0
    v_cndmask_b32 v15, v16, v15, vcc
    buffer_store_dwordx4 v[20:23], v15, s[44:47], s57 offen sc1
    s_nop 1
    s_branch .Lk1kvend_139
.Lk1gate_143:
    s_cmp_eq_u32 s29, 6
    s_cbranch_scc0 .Lk1kvend_139
    v_mov_b32 v19, 0x42700000
    v_med3_f32 v3, v3, v19, -v19
    v_mul_f32 v3, 0x3fb8aa3b, v3
    v_exp_f32 v3, v3
    s_lshl_b32 s56, s28, 9
    v_add_f32 v19, 1.0, v3
    v_rcp_f32 v19, v19
    s_add_u32 s56, s56, 163840
    v_lshlrev_b32 v15, 2, v13
    v_cmp_eq_u32 vcc, 2, v12
    s_nop 1
    v_cndmask_b32 v15, v18, v15, vcc
    buffer_store_dword v3, v15, s[44:47], s56 offen sc1
    s_add_u32 s56, s56, 8192
    buffer_store_dword v19, v15, s[44:47], s56 offen sc1
.Lk1kvend_139:
    s_waitcnt lgkmcnt(8)
    v_mfma_f32_16x16x32_bf16 v[56:59], v[84:87], v[120:123], v[56:59]
    ds_read_b64_tr_b16 v[80:81], v109 offset:47328
    v_mfma_f32_16x16x32_bf16 v[60:63], v[84:87], v[192:195], v[60:63]
    ds_read_b64_tr_b16 v[82:83], v109 offset:52448
    s_waitcnt lgkmcnt(8)
    v_mfma_f32_16x16x32_bf16 v[64:67], v[88:91], v[120:123], v[64:67]
    ds_read_b64_tr_b16 v[84:85], v108 offset:47360
    v_mfma_f32_16x16x32_bf16 v[68:71], v[88:91], v[192:195], v[68:71]
    ds_read_b64_tr_b16 v[86:87], v108 offset:52480
    ds_read_b64_tr_b16 v[88:89], v109 offset:47392
    ds_read_b64_tr_b16 v[90:91], v109 offset:52512
    s_cmp_lt_u32 s33, 2
    s_cbranch_scc0 .Lk1wvn_146
    s_waitcnt vmcnt(3)
    s_branch .Lk1wve_145
.Lk1wvn_146:
    s_cmp_lt_u32 s33, 3
    s_cbranch_scc0 .Lk1wvn_147
    s_waitcnt vmcnt(2)
    s_branch .Lk1wve_145
.Lk1wvn_147:
    s_waitcnt vmcnt(2)
.Lk1wve_145:
    s_barrier
    s_waitcnt lgkmcnt(10)
    v_mfma_f32_16x16x32_bf16 v[32:35], v[72:75], v[124:127], v[32:35]
    s_add_u32 m0, s69, 16384
    s_add_u32 s53, s65, 2359296
    buffer_load_dwordx4 v6, s[40:43], s53 offen lds
    v_mfma_f32_16x16x32_bf16 v[36:39], v[72:75], v[196:199], v[36:39]
    s_waitcnt lgkmcnt(8)
    v_mfma_f32_16x16x32_bf16 v[40:43], v[76:79], v[124:127], v[40:43]
    ds_read_b64_tr_b16 v[72:73], v109 offset:160
    v_mfma_f32_16x16x32_bf16 v[44:47], v[76:79], v[196:199], v[44:47]
    ds_read_b64_tr_b16 v[74:75], v109 offset:5280
    s_waitcnt lgkmcnt(6)
    v_mfma_f32_16x16x32_bf16 v[48:51], v[80:83], v[124:127], v[48:51]
    ds_read_b64_tr_b16 v[76:77], v108 offset:192
    v_mfma_f32_16x16x32_bf16 v[52:55], v[80:83], v[196:199], v[52:55]
    ds_read_b64_tr_b16 v[78:79], v108 offset:5312
    s_add_u32 m0, s69, 17408
    s_add_u32 s53, s65, 2359296
    buffer_load_dwordx4 v7, s[40:43], s53 offen lds
    s_waitcnt lgkmcnt(6)
    v_mfma_f32_16x16x32_bf16 v[56:59], v[84:87], v[124:127], v[56:59]
    ds_read_b64_tr_b16 v[80:81], v109 offset:224
    v_mfma_f32_16x16x32_bf16 v[60:63], v[84:87], v[196:199], v[60:63]
    ds_read_b64_tr_b16 v[82:83], v109 offset:5344
    s_waitcnt lgkmcnt(6)
    v_mfma_f32_16x16x32_bf16 v[64:67], v[88:91], v[124:127], v[64:67]
    ds_read_b64_tr_b16 v[84:85], v108 offset:256
    v_mfma_f32_16x16x32_bf16 v[68:71], v[88:91], v[196:199], v[68:71]
    ds_read_b64_tr_b16 v[86:87], v108 offset:5376
    s_waitcnt lgkmcnt(6)
    v_mfma_f32_16x16x32_bf16 v[32:35], v[72:75], v[128:131], v[32:35]
    ds_read_b64_tr_b16 v[88:89], v109 offset:288
    s_cmp_lt_u32 s33, 2
    s_cbranch_scc0 .Lk1wb_148
    s_add_u32 m0, s69, 18432
    s_add_u32 s53, s65, 2359296
    buffer_load_dwordx4 v9, s[40:43], s53 offen lds
.Lk1wb_148:
    v_mfma_f32_16x16x32_bf16 v[36:39], v[72:75], v[200:203], v[36:39]
    ds_read_b64_tr_b16 v[90:91], v109 offset:5408
    s_waitcnt lgkmcnt(6)
    v_mfma_f32_16x16x32_bf16 v[40:43], v[76:79], v[128:131], v[40:43]
    ds_read_b64_tr_b16 v[72:73], v109 offset:57504
    v_mfma_f32_16x16x32_bf16 v[44:47], v[76:79], v[200:203], v[44:47]
    ds_read_b64_tr_b16 v[74:75], v109 offset:62624
    s_waitcnt lgkmcnt(6)
    v_mfma_f32_16x16x32_bf16 v[48:51], v[80:83], v[128:131], v[48:51]
    ds_read_b64_tr_b16 v[76:77], v108 offset:57536
    v_mfma_f32_16x16x32_bf16 v[52:55], v[80:83], v[200:203], v[52:55]
    ds_read_b64_tr_b16 v[78:79], v108 offset:62656
    s_add_u32 s56, s63, 16384
    buffer_store_dwordx4 v[92:95], v8, s[44:47], s56 offen sc1
    s_waitcnt lgkmcnt(6)
    v_mfma_f32_16x16x32_bf16 v[56:59], v[84:87], v[128:131], v[56:59]
    ds_read_b64_tr_b16 v[80:81], v109 offset:57568
    v_mfma_f32_16x16x32_bf16 v[60:63], v[84:87], v[200:203], v[60:63]
    ds_read_b64_tr_b16 v[82:83], v109 offset:62688
    s_waitcnt lgkmcnt(6)
    v_mfma_f32_16x16x32_bf16 v[64:67], v[88:91], v[128:131], v[64:67]
    ds_read_b64_tr_b16 v[84:85], v108 offset:57600
    v_mfma_f32_16x16x32_bf16 v[68:71], v[88:91], v[200:203], v[68:71]
    ds_read_b64_tr_b16 v[86:87], v108 offset:62720
    ds_read_b64_tr_b16 v[88:89], v109 offset:57632
    ds_read_b64_tr_b16 v[90:91], v109 offset:62752
    s_cmp_lt_u32 s33, 2
    s_cbranch_scc0 .Lk1wvn_150
    s_waitcnt vmcnt(4)
    s_branch .Lk1wve_149
.Lk1wvn_150:
    s_cmp_lt_u32 s33, 3
    s_cbranch_scc0 .Lk1wvn_151
    s_waitcnt vmcnt(3)
    s_branch .Lk1wve_149
.Lk1wvn_151:
    s_waitcnt vmcnt(3)
.Lk1wve_149:
    s_barrier
    s_waitcnt lgkmcnt(8)
    v_mfma_f32_16x16x32_bf16 v[32:35], v[72:75], v[132:135], v[32:35]
    s_add_u32 m0, s69, 36864
    s_add_u32 s53, s65, 2949120
    buffer_load_dwordx4 v6, s[40:43], s53 offen lds
    v_mfma_f32_16x16x32_bf16 v[36:39], v[72:75], v[204:207], v[36:39]
    s_waitcnt lgkmcnt(6)
    v_mfma_f32_16x16x32_bf16 v[40:43], v[76:79], v[132:135], v[40:43]
    ds_read_b64_tr_b16 v[72:73], v111 offset:160
    v_mfma_f32_16x16x32_bf16 v[44:47], v[76:79], v[204:207], v[44:47]
    ds_read_b64_tr_b16 v[74:75], v111 offset:5280
    s_waitcnt lgkmcnt(6)
    v_mfma_f32_16x16x32_bf16 v[48:51], v[80:83], v[132:135], v[48:51]
    ds_read_b64_tr_b16 v[76:77], v110 offset:192
    v_mfma_f32_16x16x32_bf16 v[52:55], v[80:83], v[204:207], v[52:55]
    ds_read_b64_tr_b16 v[78:79], v110 offset:5312
    s_add_u32 m0, s69, 37888
    s_add_u32 s53, s65, 2949120
    buffer_load_dwordx4 v7, s[40:43], s53 offen lds
    s_waitcnt lgkmcnt(6)
    v_mfma_f32_16x16x32_bf16 v[56:59], v[84:87], v[132:135], v[56:59]
    ds_read_b64_tr_b16 v[80:81], v111 offset:224
    v_mfma_f32_16x16x32_bf16 v[60:63], v[84:87], v[204:207], v[60:63]
    ds_read_b64_tr_b16 v[82:83], v111 offset:5344
    s_waitcnt lgkmcnt(6)
    v_mfma_f32_16x16x32_bf16 v[64:67], v[88:91], v[132:135], v[64:67]
    ds_read_b64_tr_b16 v[84:85], v110 offset:256
    v_mfma_f32_16x16x32_bf16 v[68:71], v[88:91], v[204:207], v[68:71]
    ds_read_b64_tr_b16 v[86:87], v110 offset:5376
    s_waitcnt lgkmcnt(6)
    v_mfma_f32_16x16x32_bf16 v[32:35], v[72:75], v[136:139], v[32:35]
    ds_read_b64_tr_b16 v[88:89], v111 offset:288
    s_cmp_lt_u32 s33, 2
    s_cbranch_scc0 .Lk1wb_152
    s_add_u32 m0, s69, 38912
    s_add_u32 s53, s65, 2949120
    buffer_load_dwordx4 v9, s[40:43], s53 offen lds
.Lk1wb_152:
    v_mfma_f32_16x16x32_bf16 v[36:39], v[72:75], v[208:211], v[36:39]
    ds_read_b64_tr_b16 v[90:91], v111 offset:5408
    s_waitcnt lgkmcnt(6)
    v_mfma_f32_16x16x32_bf16 v[40:43], v[76:79], v[136:139], v[40:43]
    ds_read_b64_tr_b16 v[72:73], v111 offset:10400
    v_mfma_f32_16x16x32_bf16 v[44:47], v[76:79], v[208:211], v[44:47]
    ds_read_b64_tr_b16 v[74:75], v111 offset:15520
    s_waitcnt lgkmcnt(6)
    v_mfma_f32_16x16x32_bf16 v[48:51], v[80:83], v[136:139], v[48:51]
    ds_read_b64_tr_b16 v[76:77], v110 offset:10432
    v_mfma_f32_16x16x32_bf16 v[52:55], v[80:83], v[208:211], v[52:55]
    ds_read_b64_tr_b16 v[78:79], v110 offset:15552
    s_waitcnt lgkmcnt(6)
    v_mfma_f32_16x16x32_bf16 v[56:59], v[84:87], v[136:139], v[56:59]
    ds_read_b64_tr_b16 v[80:81], v111 offset:10464
    v_mfma_f32_16x16x32_bf16 v[60:63], v[84:87], v[208:211], v[60:63]
    ds_read_b64_tr_b16 v[82:83], v111 offset:15584
    s_waitcnt lgkmcnt(6)
    v_mfma_f32_16x16x32_bf16 v[64:67], v[88:91], v[136:139], v[64:67]
    ds_read_b64_tr_b16 v[84:85], v110 offset:10496
    v_mfma_f32_16x16x32_bf16 v[68:71], v[88:91], v[208:211], v[68:71]
    ds_read_b64_tr_b16 v[86:87], v110 offset:15616
    ds_read_b64_tr_b16 v[88:89], v111 offset:10528
    ds_read_b64_tr_b16 v[90:91], v111 offset:15648
    s_cmp_lt_u32 s33, 2
    s_cbranch_scc0 .Lk1wvn_154
    s_waitcnt vmcnt(4)
    s_branch .Lk1wve_153
.Lk1wvn_154:
    s_cmp_lt_u32 s33, 3
    s_cbranch_scc0 .Lk1wvn_155
    s_waitcnt vmcnt(3)
    s_branch .Lk1wve_153
.Lk1wvn_155:
    s_waitcnt vmcnt(3)
.Lk1wve_153:
    s_cmp_lt_u32 s33, 2
    s_cbranch_scc0 .Lk1wvn_157
    s_waitcnt vmcnt(7)
    s_branch .Lk1wve_156
.Lk1wvn_157:
    s_cmp_lt_u32 s33, 3
    s_cbranch_scc0 .Lk1wvn_158
    s_waitcnt vmcnt(5)
    s_branch .Lk1wve_156
.Lk1wvn_158:
    s_waitcnt vmcnt(5)
.Lk1wve_156:
    s_waitcnt lgkmcnt(0)
    s_barrier
    v_mfma_f32_16x16x32_bf16 v[32:35], v[72:75], v[140:143], v[32:35]
    s_add_u32 m0, s69, 0
    s_add_u32 s53, s65, 3538944
    buffer_load_dwordx4 v6, s[40:43], s53 offen lds
    v_mfma_f32_16x16x32_bf16 v[36:39], v[72:75], v[212:215], v[36:39]
    v_mfma_f32_16x16x32_bf16 v[40:43], v[76:79], v[140:143], v[40:43]
    ds_read_b64_tr_b16 v[72:73], v109 offset:16544
    v_mfma_f32_16x16x32_bf16 v[44:47], v[76:79], v[212:215], v[44:47]
    ds_read_b64_tr_b16 v[74:75], v109 offset:21664
    s_add_u32 m0, s69, 1024
    s_add_u32 s53, s65, 3538944
    buffer_load_dwordx4 v7, s[40:43], s53 offen lds
    v_mfma_f32_16x16x32_bf16 v[48:51], v[80:83], v[140:143], v[48:51]
    ds_read_b64_tr_b16 v[76:77], v108 offset:16576
    v_mfma_f32_16x16x32_bf16 v[52:55], v[80:83], v[212:215], v[52:55]
    ds_read_b64_tr_b16 v[78:79], v108 offset:21696
    v_mfma_f32_16x16x32_bf16 v[56:59], v[84:87], v[140:143], v[56:59]
    ds_read_b64_tr_b16 v[80:81], v109 offset:16608
    s_add_u32 s56, s63, 17408
    buffer_store_dwordx4 v[96:99], v8, s[44:47], s56 offen sc1
    v_mfma_f32_16x16x32_bf16 v[60:63], v[84:87], v[212:215], v[60:63]
    ds_read_b64_tr_b16 v[82:83], v109 offset:21728
    v_mfma_f32_16x16x32_bf16 v[64:67], v[88:91], v[140:143], v[64:67]
    ds_read_b64_tr_b16 v[84:85], v108 offset:16640
    v_mfma_f32_16x16x32_bf16 v[68:71], v[88:91], v[212:215], v[68:71]
    ds_read_b64_tr_b16 v[86:87], v108 offset:21760
    s_waitcnt lgkmcnt(6)
    v_mfma_f32_16x16x32_bf16 v[32:35], v[72:75], v[144:147], v[32:35]
    ds_read_b64_tr_b16 v[88:89], v109 offset:16672
    s_cmp_lt_u32 s33, 2
    s_cbranch_scc0 .Lk1wb_159
    s_add_u32 m0, s69, 2048
    s_add_u32 s53, s65, 3538944
    buffer_load_dwordx4 v9, s[40:43], s53 offen lds
.Lk1wb_159:
    v_mfma_f32_16x16x32_bf16 v[36:39], v[72:75], v[216:219], v[36:39]
    ds_read_b64_tr_b16 v[90:91], v109 offset:21792
    s_waitcnt lgkmcnt(6)
    v_mfma_f32_16x16x32_bf16 v[40:43], v[76:79], v[144:147], v[40:43]
    ds_read_b64_tr_b16 v[72:73], v109 offset:26784
    v_mfma_f32_16x16x32_bf16 v[44:47], v[76:79], v[216:219], v[44:47]
    ds_read_b64_tr_b16 v[74:75], v109 offset:31904
    s_waitcnt lgkmcnt(6)
    v_mfma_f32_16x16x32_bf16 v[48:51], v[80:83], v[144:147], v[48:51]
    ds_read_b64_tr_b16 v[76:77], v108 offset:26816
    v_mfma_f32_16x16x32_bf16 v[52:55], v[80:83], v[216:219], v[52:55]
    ds_read_b64_tr_b16 v[78:79], v108 offset:31936
    s_waitcnt lgkmcnt(6)
    v_mfma_f32_16x16x32_bf16 v[56:59], v[84:87], v[144:147], v[56:59]
    ds_read_b64_tr_b16 v[80:81], v109 offset:26848
    v_mfma_f32_16x16x32_bf16 v[60:63], v[84:87], v[216:219], v[60:63]
    ds_read_b64_tr_b16 v[82:83], v109 offset:31968
    s_waitcnt lgkmcnt(6)
    v_mfma_f32_16x16x32_bf16 v[64:67], v[88:91], v[144:147], v[64:67]
    ds_read_b64_tr_b16 v[84:85], v108 offset:26880
    v_mfma_f32_16x16x32_bf16 v[68:71], v[88:91], v[216:219], v[68:71]
    ds_read_b64_tr_b16 v[86:87], v108 offset:32000
    ds_read_b64_tr_b16 v[88:89], v109 offset:26912
    ds_read_b64_tr_b16 v[90:91], v109 offset:32032
    s_cmp_lt_u32 s33, 2
    s_cbranch_scc0 .Lk1wvn_161
    s_waitcnt vmcnt(4)
    s_branch .Lk1wve_160
.Lk1wvn_161:
    s_cmp_lt_u32 s33, 3
    s_cbranch_scc0 .Lk1wvn_162
    s_waitcnt vmcnt(3)
    s_branch .Lk1wve_160
.Lk1wvn_162:
    s_waitcnt vmcnt(3)
.Lk1wve_160:
    s_barrier
    s_waitcnt lgkmcnt(8)
    v_mfma_f32_16x16x32_bf16 v[32:35], v[72:75], v[148:151], v[32:35]
    s_add_u32 m0, s69, 90112
    s_add_u32 s53, s65, 4128768
    buffer_load_dwordx4 v6, s[40:43], s53 offen lds
    v_mfma_f32_16x16x32_bf16 v[36:39], v[72:75], v[220:223], v[36:39]
    s_waitcnt lgkmcnt(6)
    v_mfma_f32_16x16x32_bf16 v[40:43], v[76:79], v[148:151], v[40:43]
    ds_read_b64_tr_b16 v[72:73], v109 offset:37024
    v_mfma_f32_16x16x32_bf16 v[44:47], v[76:79], v[220:223], v[44:47]
    ds_read_b64_tr_b16 v[74:75], v109 offset:42144
    s_waitcnt lgkmcnt(6)
    v_mfma_f32_16x16x32_bf16 v[48:51], v[80:83], v[148:151], v[48:51]
    ds_read_b64_tr_b16 v[76:77], v108 offset:37056
    v_mfma_f32_16x16x32_bf16 v[52:55], v[80:83], v[220:223], v[52:55]
    ds_read_b64_tr_b16 v[78:79], v108 offset:42176
    s_add_u32 m0, s69, 91136
    s_add_u32 s53, s65, 4128768
    buffer_load_dwordx4 v7, s[40:43], s53 offen lds
    s_waitcnt lgkmcnt(6)
    v_mfma_f32_16x16x32_bf16 v[56:59], v[84:87], v[148:151], v[56:59]
    ds_read_b64_tr_b16 v[80:81], v109 offset:37088
    v_mfma_f32_16x16x32_bf16 v[60:63], v[84:87], v[220:223], v[60:63]
    ds_read_b64_tr_b16 v[82:83], v109 offset:42208
    s_waitcnt lgkmcnt(6)
    v_mfma_f32_16x16x32_bf16 v[64:67], v[88:91], v[148:151], v[64:67]
    ds_read_b64_tr_b16 v[84:85], v108 offset:37120
    v_mfma_f32_16x16x32_bf16 v[68:71], v[88:91], v[220:223], v[68:71]
    ds_read_b64_tr_b16 v[86:87], v108 offset:42240
    s_waitcnt lgkmcnt(6)
    v_mfma_f32_16x16x32_bf16 v[32:35], v[72:75], v[152:155], v[32:35]
    ds_read_b64_tr_b16 v[88:89], v109 offset:37152
    s_cmp_lt_u32 s33, 2
    s_cbranch_scc0 .Lk1wb_163
    s_add_u32 m0, s69, 92160
    s_add_u32 s53, s65, 4128768
    buffer_load_dwordx4 v9, s[40:43], s53 offen lds
.Lk1wb_163:
    v_mfma_f32_16x16x32_bf16 v[36:39], v[72:75], v[224:227], v[36:39]
    ds_read_b64_tr_b16 v[90:91], v109 offset:42272
    s_waitcnt lgkmcnt(6)
    v_mfma_f32_16x16x32_bf16 v[40:43], v[76:79], v[152:155], v[40:43]
    ds_read_b64_tr_b16 v[72:73], v109 offset:47264
    v_mfma_f32_16x16x32_bf16 v[44:47], v[76:79], v[224:227], v[44:47]
    ds_read_b64_tr_b16 v[74:75], v109 offset:52384
    s_waitcnt lgkmcnt(6)
    v_mfma_f32_16x16x32_bf16 v[48:51], v[80:83], v[152:155], v[48:51]
    ds_read_b64_tr_b16 v[76:77], v108 offset:47296
    v_mfma_f32_16x16x32_bf16 v[52:55], v[80:83], v[224:227], v[52:55]
    ds_read_b64_tr_b16 v[78:79], v108 offset:52416
    s_add_u32 s56, s63, 24576
    buffer_store_dwordx4 v[100:103], v8, s[44:47], s56 offen sc1
    s_waitcnt lgkmcnt(6)
    v_mfma_f32_16x16x32_bf16 v[56:59], v[84:87], v[152:155], v[56:59]
    ds_read_b64_tr_b16 v[80:81], v109 offset:47328
    v_mfma_f32_16x16x32_bf16 v[60:63], v[84:87], v[224:227], v[60:63]
    ds_read_b64_tr_b16 v[82:83], v109 offset:52448
    s_waitcnt lgkmcnt(6)
    v_mfma_f32_16x16x32_bf16 v[64:67], v[88:91], v[152:155], v[64:67]
    ds_read_b64_tr_b16 v[84:85], v108 offset:47360
    v_mfma_f32_16x16x32_bf16 v[68:71], v[88:91], v[224:227], v[68:71]
    ds_read_b64_tr_b16 v[86:87], v108 offset:52480
    ds_read_b64_tr_b16 v[88:89], v109 offset:47392
    ds_read_b64_tr_b16 v[90:91], v109 offset:52512
    s_waitcnt vmcnt(4)
    s_barrier
    s_waitcnt lgkmcnt(8)
    v_mfma_f32_16x16x32_bf16 v[32:35], v[72:75], v[156:159], v[32:35]
    s_add_u32 m0, s69, 16384
    s_add_u32 s53, s65, 4718592
    buffer_load_dwordx4 v6, s[40:43], s53 offen lds
    v_mfma_f32_16x16x32_bf16 v[36:39], v[72:75], v[228:231], v[36:39]
    s_waitcnt lgkmcnt(6)
    v_mfma_f32_16x16x32_bf16 v[40:43], v[76:79], v[156:159], v[40:43]
    ds_read_b64_tr_b16 v[72:73], v109 offset:160
    v_mfma_f32_16x16x32_bf16 v[44:47], v[76:79], v[228:231], v[44:47]
    ds_read_b64_tr_b16 v[74:75], v109 offset:5280
    s_waitcnt lgkmcnt(6)
    v_mfma_f32_16x16x32_bf16 v[48:51], v[80:83], v[156:159], v[48:51]
    ds_read_b64_tr_b16 v[76:77], v108 offset:192
    v_mfma_f32_16x16x32_bf16 v[52:55], v[80:83], v[228:231], v[52:55]
    ds_read_b64_tr_b16 v[78:79], v108 offset:5312
    s_add_u32 m0, s69, 17408
    s_add_u32 s53, s65, 4718592
    buffer_load_dwordx4 v7, s[40:43], s53 offen lds
    s_waitcnt lgkmcnt(6)
    v_mfma_f32_16x16x32_bf16 v[56:59], v[84:87], v[156:159], v[56:59]
    ds_read_b64_tr_b16 v[80:81], v109 offset:224
    v_mfma_f32_16x16x32_bf16 v[60:63], v[84:87], v[228:231], v[60:63]
    ds_read_b64_tr_b16 v[82:83], v109 offset:5344
    s_waitcnt lgkmcnt(6)
    v_mfma_f32_16x16x32_bf16 v[64:67], v[88:91], v[156:159], v[64:67]
    ds_read_b64_tr_b16 v[84:85], v108 offset:256
    v_mfma_f32_16x16x32_bf16 v[68:71], v[88:91], v[228:231], v[68:71]
    ds_read_b64_tr_b16 v[86:87], v108 offset:5376
    s_waitcnt lgkmcnt(6)
    v_mfma_f32_16x16x32_bf16 v[32:35], v[72:75], v[160:163], v[32:35]
    ds_read_b64_tr_b16 v[88:89], v109 offset:288
    s_cmp_lt_u32 s33, 2
    s_cbranch_scc0 .Lk1wb_164
    s_add_u32 m0, s69, 18432
    s_add_u32 s53, s65, 4718592
    buffer_load_dwordx4 v9, s[40:43], s53 offen lds
.Lk1wb_164:
    v_mfma_f32_16x16x32_bf16 v[36:39], v[72:75], v[232:235], v[36:39]
    ds_read_b64_tr_b16 v[90:91], v109 offset:5408
    s_waitcnt lgkmcnt(6)
    v_mfma_f32_16x16x32_bf16 v[40:43], v[76:79], v[160:163], v[40:43]
    ds_read_b64_tr_b16 v[72:73], v109 offset:57504
    v_mfma_f32_16x16x32_bf16 v[44:47], v[76:79], v[232:235], v[44:47]
    ds_read_b64_tr_b16 v[74:75], v109 offset:62624
    s_waitcnt lgkmcnt(6)
    v_mfma_f32_16x16x32_bf16 v[48:51], v[80:83], v[160:163], v[48:51]
    ds_read_b64_tr_b16 v[76:77], v108 offset:57536
    v_mfma_f32_16x16x32_bf16 v[52:55], v[80:83], v[232:235], v[52:55]
    ds_read_b64_tr_b16 v[78:79], v108 offset:62656
    s_waitcnt lgkmcnt(6)
    v_mfma_f32_16x16x32_bf16 v[56:59], v[84:87], v[160:163], v[56:59]
    ds_read_b64_tr_b16 v[80:81], v109 offset:57568
    v_mfma_f32_16x16x32_bf16 v[60:63], v[84:87], v[232:235], v[60:63]
    ds_read_b64_tr_b16 v[82:83], v109 offset:62688
    s_waitcnt lgkmcnt(6)
    v_mfma_f32_16x16x32_bf16 v[64:67], v[88:91], v[160:163], v[64:67]
    ds_read_b64_tr_b16 v[84:85], v108 offset:57600
    v_mfma_f32_16x16x32_bf16 v[68:71], v[88:91], v[232:235], v[68:71]
    ds_read_b64_tr_b16 v[86:87], v108 offset:62720
    ds_read_b64_tr_b16 v[88:89], v109 offset:57632
    ds_read_b64_tr_b16 v[90:91], v109 offset:62752
    s_cmp_lt_u32 s33, 2
    s_cbranch_scc0 .Lk1wvn_166
    s_waitcnt vmcnt(4)
    s_branch .Lk1wve_165
.Lk1wvn_166:
    s_cmp_lt_u32 s33, 3
    s_cbranch_scc0 .Lk1wvn_167
    s_waitcnt vmcnt(3)
    s_branch .Lk1wve_165
.Lk1wvn_167:
    s_waitcnt vmcnt(3)
.Lk1wve_165:
    s_barrier
    s_waitcnt lgkmcnt(8)
    v_mfma_f32_16x16x32_bf16 v[32:35], v[72:75], v[164:167], v[32:35]
    s_add_u32 s56, s63, 25600
    buffer_store_dwordx4 v[104:107], v8, s[44:47], s56 offen sc1
    v_mfma_f32_16x16x32_bf16 v[36:39], v[72:75], v[236:239], v[36:39]
    s_waitcnt lgkmcnt(6)
    v_mfma_f32_16x16x32_bf16 v[40:43], v[76:79], v[164:167], v[40:43]
    ds_read_b64_tr_b16 v[72:73], v111 offset:160
    v_mfma_f32_16x16x32_bf16 v[44:47], v[76:79], v[236:239], v[44:47]
    ds_read_b64_tr_b16 v[74:75], v111 offset:5280
    s_waitcnt lgkmcnt(6)
    v_mfma_f32_16x16x32_bf16 v[48:51], v[80:83], v[164:167], v[48:51]
    ds_read_b64_tr_b16 v[76:77], v110 offset:192
    v_mfma_f32_16x16x32_bf16 v[52:55], v[80:83], v[236:239], v[52:55]
    ds_read_b64_tr_b16 v[78:79], v110 offset:5312
    s_waitcnt lgkmcnt(6)
    v_mfma_f32_16x16x32_bf16 v[56:59], v[84:87], v[164:167], v[56:59]
    ds_read_b64_tr_b16 v[80:81], v111 offset:224
    v_mfma_f32_16x16x32_bf16 v[60:63], v[84:87], v[236:239], v[60:63]
    ds_read_b64_tr_b16 v[82:83], v111 offset:5344
    s_waitcnt lgkmcnt(6)
    v_mfma_f32_16x16x32_bf16 v[64:67], v[88:91], v[164:167], v[64:67]
    ds_read_b64_tr_b16 v[84:85], v110 offset:256
    v_mfma_f32_16x16x32_bf16 v[68:71], v[88:91], v[236:239], v[68:71]
    ds_read_b64_tr_b16 v[86:87], v110 offset:5376
    s_waitcnt lgkmcnt(6)
    v_mfma_f32_16x16x32_bf16 v[32:35], v[72:75], v[168:171], v[32:35]
    ds_read_b64_tr_b16 v[88:89], v111 offset:288
    v_mfma_f32_16x16x32_bf16 v[36:39], v[72:75], v[240:243], v[36:39]
    ds_read_b64_tr_b16 v[90:91], v111 offset:5408
    s_waitcnt lgkmcnt(6)
    v_mfma_f32_16x16x32_bf16 v[40:43], v[76:79], v[168:171], v[40:43]
    ds_read_b64_tr_b16 v[72:73], v111 offset:10400
    v_mfma_f32_16x16x32_bf16 v[44:47], v[76:79], v[240:243], v[44:47]
    ds_read_b64_tr_b16 v[74:75], v111 offset:15520
    s_waitcnt lgkmcnt(6)
    v_mfma_f32_16x16x32_bf16 v[48:51], v[80:83], v[168:171], v[48:51]
    ds_read_b64_tr_b16 v[76:77], v110 offset:10432
    v_mfma_f32_16x16x32_bf16 v[52:55], v[80:83], v[240:243], v[52:55]
    ds_read_b64_tr_b16 v[78:79], v110 offset:15552
    s_waitcnt lgkmcnt(6)
    v_mfma_f32_16x16x32_bf16 v[56:59], v[84:87], v[168:171], v[56:59]
    ds_read_b64_tr_b16 v[80:81], v111 offset:10464
    v_mfma_f32_16x16x32_bf16 v[60:63], v[84:87], v[240:243], v[60:63]
    ds_read_b64_tr_b16 v[82:83], v111 offset:15584
    s_waitcnt lgkmcnt(6)
    v_mfma_f32_16x16x32_bf16 v[64:67], v[88:91], v[168:171], v[64:67]
    ds_read_b64_tr_b16 v[84:85], v110 offset:10496
    v_mfma_f32_16x16x32_bf16 v[68:71], v[88:91], v[240:243], v[68:71]
    ds_read_b64_tr_b16 v[86:87], v110 offset:15616
    ds_read_b64_tr_b16 v[88:89], v111 offset:10528
    ds_read_b64_tr_b16 v[90:91], v111 offset:15648
    s_waitcnt vmcnt(1)
    s_barrier
    s_waitcnt lgkmcnt(8)
    v_mfma_f32_16x16x32_bf16 v[32:35], v[72:75], v[172:175], v[32:35]
    v_mfma_f32_16x16x32_bf16 v[36:39], v[72:75], v[244:247], v[36:39]
    s_waitcnt lgkmcnt(6)
    v_mfma_f32_16x16x32_bf16 v[40:43], v[76:79], v[172:175], v[40:43]
    ds_read_b64_tr_b16 v[72:73], v109 offset:16544
    v_mfma_f32_16x16x32_bf16 v[44:47], v[76:79], v[244:247], v[44:47]
    ds_read_b64_tr_b16 v[74:75], v109 offset:21664
    s_waitcnt lgkmcnt(6)
    v_mfma_f32_16x16x32_bf16 v[48:51], v[80:83], v[172:175], v[48:51]
    ds_read_b64_tr_b16 v[76:77], v108 offset:16576
    v_mfma_f32_16x16x32_bf16 v[52:55], v[80:83], v[244:247], v[52:55]
    ds_read_b64_tr_b16 v[78:79], v108 offset:21696
    s_waitcnt lgkmcnt(6)
    v_mfma_f32_16x16x32_bf16 v[56:59], v[84:87], v[172:175], v[56:59]
    ds_read_b64_tr_b16 v[80:81], v109 offset:16608
    v_mfma_f32_16x16x32_bf16 v[60:63], v[84:87], v[244:247], v[60:63]
    ds_read_b64_tr_b16 v[82:83], v109 offset:21728
    s_waitcnt lgkmcnt(6)
    v_mfma_f32_16x16x32_bf16 v[64:67], v[88:91], v[172:175], v[64:67]
    ds_read_b64_tr_b16 v[84:85], v108 offset:16640
    v_mfma_f32_16x16x32_bf16 v[68:71], v[88:91], v[244:247], v[68:71]
    ds_read_b64_tr_b16 v[86:87], v108 offset:21760
    s_waitcnt lgkmcnt(6)
    v_mfma_f32_16x16x32_bf16 v[32:35], v[72:75], v[176:179], v[32:35]
    ds_read_b64_tr_b16 v[88:89], v109 offset:16672
    v_mfma_f32_16x16x32_bf16 v[36:39], v[72:75], v[248:251], v[36:39]
    ds_read_b64_tr_b16 v[90:91], v109 offset:21792
    s_waitcnt lgkmcnt(6)
    v_mfma_f32_16x16x32_bf16 v[40:43], v[76:79], v[176:179], v[40:43]
    ds_read_b64_tr_b16 v[72:73], v109 offset:26784
    v_mfma_f32_16x16x32_bf16 v[44:47], v[76:79], v[248:251], v[44:47]
    ds_read_b64_tr_b16 v[74:75], v109 offset:31904
    s_waitcnt lgkmcnt(6)
    v_mfma_f32_16x16x32_bf16 v[48:51], v[80:83], v[176:179], v[48:51]
    ds_read_b64_tr_b16 v[76:77], v108 offset:26816
    v_mfma_f32_16x16x32_bf16 v[52:55], v[80:83], v[248:251], v[52:55]
    ds_read_b64_tr_b16 v[78:79], v108 offset:31936
    s_waitcnt lgkmcnt(6)
    v_mfma_f32_16x16x32_bf16 v[56:59], v[84:87], v[176:179], v[56:59]
    ds_read_b64_tr_b16 v[80:81], v109 offset:26848
    v_mfma_f32_16x16x32_bf16 v[60:63], v[84:87], v[248:251], v[60:63]
    ds_read_b64_tr_b16 v[82:83], v109 offset:31968
    s_waitcnt lgkmcnt(6)
    v_mfma_f32_16x16x32_bf16 v[64:67], v[88:91], v[176:179], v[64:67]
    ds_read_b64_tr_b16 v[84:85], v108 offset:26880
    v_mfma_f32_16x16x32_bf16 v[68:71], v[88:91], v[248:251], v[68:71]
    ds_read_b64_tr_b16 v[86:87], v108 offset:32000
    ds_read_b64_tr_b16 v[88:89], v109 offset:26912
    ds_read_b64_tr_b16 v[90:91], v109 offset:32032
    s_waitcnt lgkmcnt(8)
    v_mfma_f32_16x16x32_bf16 v[32:35], v[72:75], v[180:183], v[32:35]
    v_mfma_f32_16x16x32_bf16 v[36:39], v[72:75], v[252:255], v[36:39]
    s_waitcnt lgkmcnt(6)
    v_mfma_f32_16x16x32_bf16 v[40:43], v[76:79], v[180:183], v[40:43]
    v_mfma_f32_16x16x32_bf16 v[44:47], v[76:79], v[252:255], v[44:47]
    s_waitcnt lgkmcnt(4)
    v_mfma_f32_16x16x32_bf16 v[48:51], v[80:83], v[180:183], v[48:51]
    v_mfma_f32_16x16x32_bf16 v[52:55], v[80:83], v[252:255], v[52:55]
    s_waitcnt lgkmcnt(2)
    v_mfma_f32_16x16x32_bf16 v[56:59], v[84:87], v[180:183], v[56:59]
    v_cvt_pk_bf16_f32 v164, v32, v33
    v_cvt_pk_bf16_f32 v165, v34, v35
    v_pk_max_i16 v164, v164, 0
    v_pk_max_i16 v165, v165, 0
    v_cvt_pk_bf16_f32 v166, v36, v37
    v_cvt_pk_bf16_f32 v167, v38, v39
    v_mfma_f32_16x16x32_bf16 v[60:63], v[84:87], v[252:255], v[60:63]
    v_pk_max_i16 v166, v166, 0
    v_pk_max_i16 v167, v167, 0
    s_waitcnt lgkmcnt(0)
    v_mfma_f32_16x16x32_bf16 v[64:67], v[88:91], v[180:183], v[64:67]
    v_cvt_pk_bf16_f32 v144, v40, v41
    v_cvt_pk_bf16_f32 v145, v42, v43
    v_pk_max_i16 v144, v144, 0
    v_pk_max_i16 v145, v145, 0
    v_cvt_pk_bf16_f32 v148, v44, v45
    v_cvt_pk_bf16_f32 v149, v46, v47
    v_mfma_f32_16x16x32_bf16 v[68:71], v[88:91], v[252:255], v[68:71]
    v_pk_max_i16 v148, v148, 0
    v_pk_max_i16 v149, v149, 0
    s_nop 7
    v_cvt_pk_bf16_f32 v146, v48, v49
    v_cvt_pk_bf16_f32 v147, v50, v51
    v_pk_max_i16 v146, v146, 0
    v_pk_max_i16 v147, v147, 0
    v_cvt_pk_bf16_f32 v150, v52, v53
    v_cvt_pk_bf16_f32 v151, v54, v55
    v_pk_max_i16 v150, v150, 0
    v_pk_max_i16 v151, v151, 0
    v_cvt_pk_bf16_f32 v152, v56, v57
    v_cvt_pk_bf16_f32 v153, v58, v59
    v_pk_max_i16 v152, v152, 0
    v_pk_max_i16 v153, v153, 0
    v_cvt_pk_bf16_f32 v156, v60, v61
    v_cvt_pk_bf16_f32 v157, v62, v63
    v_pk_max_i16 v156, v156, 0
    v_pk_max_i16 v157, v157, 0
    v_cvt_pk_bf16_f32 v154, v64, v65
    v_cvt_pk_bf16_f32 v155, v66, v67
    v_pk_max_i16 v154, v154, 0
    v_pk_max_i16 v155, v155, 0
    v_cvt_pk_bf16_f32 v158, v68, v69
    v_cvt_pk_bf16_f32 v159, v70, v71
    v_pk_max_i16 v158, v158, 0
    v_pk_max_i16 v159, v159, 0
    s_nop 1
.Lk1aend_9:
    v_lshlrev_b32 v6, 4, v1
    s_lshl_b32 s68, s32, 10
    s_mov_b32 s95, 0
    v_and_b32 v9, 31, v1
    v_lshrrev_b32 v10, 5, v1
    s_lshl_b32 s52, s33, 5
    v_add_u32 v11, s52, v9
    v_mul_u32_u24 v12, 48, v11
    v_add_u32 v12, 71680, v12
    v_lshl_add_u32 v13, v10, 4, v12
    ds_read_b128 v[24:27], v13 offset:0
    ds_read_b32 v32, v12 offset:32
    ds_read_b128 v[28:31], v13 offset:6144
    ds_read_b32 v36, v12 offset:6176
    s_cmp_eq_u32 s32, 0
    s_cbranch_scc0 .Lk1w0_168
    s_waitcnt vmcnt(0)
    v_cmp_ne_u32 vcc, 0, v18
    v_cmp_ne_u32 s[54:55], 0, v19
    s_nop 1
    s_and_b64 s[54:55], s[54:55], vcc
    s_or_b32 s54, s54, 0x80808080
    s_or_b32 s55, s55, 0x80808080
    s_and_b32 s54, s54, s55
    s_cmp_eq_u32 s54, -1
    s_cbranch_scc1 .Lk1s1ok_169
    s_mov_b32 s94, 0x20000
.Lk1s1p_170:
    v_lshrrev_b32 v16, 3, v1
    v_lshlrev_b32 v16, 7, v16
    v_and_b32 v17, 7, v1
    v_lshl_add_u32 v16, v17, 2, v16
    s_mov_b32 s52, 196608
    buffer_load_dword v18, v16, s[44:47], s52 offen sc1
    buffer_load_dword v19, v16, s[44:47], s52 offen offset:1024 sc1
    s_waitcnt vmcnt(0)
    v_cmp_ne_u32 vcc, 0, v18
    v_cmp_ne_u32 s[54:55], 0, v19
    s_nop 1
    s_and_b64 s[54:55], s[54:55], vcc
    s_or_b32 s54, s54, 0x80808080
    s_or_b32 s55, s55, 0x80808080
    s_and_b32 s54, s54, s55
    s_cmp_eq_u32 s54, -1
    s_cbranch_scc1 .Lk1s1pd_171
    s_sub_u32 s94, s94, 1
    s_cmp_eq_u32 s94, 0
    s_cbranch_scc1 .Lk1s1pd_171
    s_sleep 1
    s_branch .Lk1s1p_170
.Lk1s1pd_171:
.Lk1s1ok_169:
    v_max_f32 v18, v18, v19
    s_nop 1
    v_max_f32_dpp v18, v18, v18 row_ror:8 row_mask:0xf bank_mask:0xf
    v_mov_b32 v19, v18
    s_nop 1
    v_permlane16_swap_b32 v18, v19
    s_nop 1
    v_max_f32 v18, v18, v19
    v_mov_b32 v19, v18
    s_nop 1
    v_permlane32_swap_b32 v18, v19
    s_nop 1
    v_max_f32 v18, v18, v19
    s_nop 0
    v_readlane_b32 s54, v18, 0
    v_readlane_b32 s55, v18, 1
    v_readlane_b32 s56, v18, 2
    s_nop 1
    v_mov_b32 v19, s54
    v_add_f32 v19, s55, v19
    v_add_f32 v19, s56, v19
    v_mov_b32 v18, 159808
    ds_write_b32 v18, v19
    v_mov_b32 v19, 0
    ds_write_b32 v18, v19 offset:4
.Lk1w0_168:
    s_waitcnt lgkmcnt(0)
    s_barrier
    v_mov_b32 v9, 159808
    ds_read_b32 v7, v9
    v_and_b32 v9, 31, v1
    s_lshl_b32 s52, s33, 5
    v_add_u32 v9, s52, v9
    s_lshl_b32 s54, s28, 9
    s_add_u32 s54, s54, 163840
    v_lshlrev_b32 v9, 2, v9
    buffer_load_dword v5, v9, s[44:47], s54 offen sc1
    s_add_u32 m0, s68, 0
    s_add_u32 s69, s68, 0
    buffer_load_dwordx4 v6, s[44:47], s69 offen sc1 lds
    s_waitcnt lgkmcnt(0)
    v_mov_b32 v8, v7
    v_lshlrev_b32 v2, 4, v1
    s_mul_i32 s52, s34, 36864
    v_add_u32 v2, s52, v2
    v_and_b32 v9, 31, v1
    v_lshlrev_b32 v3, 2, v9
    s_mul_i32 s52, s34, 4608
    s_add_u32 s52, s52, 65536
    v_add_u32 v3, s52, v3
    v_mov_b32 v10, v9
    v_mov_b32 v11, 20
    v_cmp_le_u32 vcc, 20, v9
    s_nop 1
    v_cndmask_b32 v10, v10, v11, vcc
    v_mov_b32 v11, 19
    v_cmp_le_u32 vcc, 28, v9
    s_nop 1
    v_cndmask_b32 v10, v10, v11, vcc
    v_lshlrev_b32 v10, 4, v10
    v_lshrrev_b32 v11, 5, v1
    v_mul_u32_u24 v11, 336, v11
    v_add_u32 v4, v10, v11
    s_mul_i32 s52, s34, 48384
    s_add_u32 s52, s52, 73728
    v_add_u32 v4, s52, v4
    s_add_u32 m0, s68, 32768
    s_add_u32 s69, s68, 32768
    buffer_load_dwordx4 v6, s[44:47], s69 offen sc1 lds
    v_cmp_gt_u32 vcc, 32, v1
    v_mov_b32 v10, 0
    v_mov_b32 v11, 0x3f803f80
    v_mov_b32 v12, 0x3f80
    v_cndmask_b32 v121, v10, v11, vcc
    v_cndmask_b32 v122, v10, v12, vcc
    v_mov_b32 v123, 0
    v_cndmask_b32 v125, v10, v11, vcc
    v_cndmask_b32 v126, v10, v12, vcc
    v_mov_b32 v127, 0
    v_cmp_gt_u32 vcc, 32, v1
    s_nop 0
    v_mov_b32 v9, 0
    v_cndmask_b32 v32, v9, v32, vcc
    v_mov_b32 v35, 0
    v_dot2_f32_bf16 v9, v24, v24, v9
    v_dot2_f32_bf16 v9, v25, v25, v9
    v_dot2_f32_bf16 v9, v26, v26, v9
    v_dot2_f32_bf16 v9, v27, v27, v9
    v_dot2_f32_bf16 v9, v32, v32, v9
    s_nop 2
    v_mov_b32 v10, v9
    s_nop 1
    v_permlane32_swap_b32 v9, v10
    s_nop 1
    v_add_f32 v9, v9, v10
    s_add_u32 m0, s68, 40960
    s_add_u32 s69, s68, 40960
    buffer_load_dwordx4 v6, s[44:47], s69 offen sc1 lds
    v_mul_f32 v9, v9, v8
    v_sqrt_f32 v9, v9
    s_nop 0
    v_mul_f32 v9, 0xbf810000, v9
    v_cvt_pk_bf16_f32 v12, v9, v9
    v_lshlrev_b32 v13, 16, v12
    v_sub_f32 v14, v9, v13
    v_cvt_pk_bf16_f32 v12, v9, v14
    v_and_b32 v13, 0xffff0000, v12
    v_sub_f32 v14, v14, v13
    v_mov_b32 v15, 0
    v_cvt_pk_bf16_f32 v13, v14, v15
    v_cndmask_b32 v33, v15, v12, vcc
    v_cndmask_b32 v34, v15, v13, vcc
    v_mov_b32 v9, 0
    v_cndmask_b32 v36, v9, v36, vcc
    v_mov_b32 v39, 0
    v_dot2_f32_bf16 v9, v28, v28, v9
    v_dot2_f32_bf16 v9, v29, v29, v9
    v_dot2_f32_bf16 v9, v30, v30, v9
    v_dot2_f32_bf16 v9, v31, v31, v9
    v_dot2_f32_bf16 v9, v36, v36, v9
    s_nop 2
    v_mov_b32 v10, v9
    s_nop 1
    v_permlane32_swap_b32 v9, v10
    s_add_u32 m0, s68, 65536
    s_add_u32 s69, s68, 65536
    buffer_load_dwordx4 v6, s[44:47], s69 offen sc1 lds
    s_nop 1
    v_add_f32 v9, v9, v10
    v_mul_f32 v9, v9, v8
    v_sqrt_f32 v9, v9
    s_nop 0
    v_mul_f32 v9, 0xbf810000, v9
    v_cvt_pk_bf16_f32 v12, v9, v9
    v_lshlrev_b32 v13, 16, v12
    v_sub_f32 v14, v9, v13
    v_cvt_pk_bf16_f32 v12, v9, v14
    v_and_b32 v13, 0xffff0000, v12
    v_sub_f32 v14, v14, v13
    v_mov_b32 v15, 0
    v_cvt_pk_bf16_f32 v13, v14, v15
    v_cndmask_b32 v37, v15, v12, vcc
    v_cndmask_b32 v38, v15, v13, vcc
    s_mov_b32 s36, s18
    s_mov_b32 s37, s19
    s_and_b32 s37, s37, 0xffff
    s_mov_b32 s38, 5308416
    s_mov_b32 s39, 0x20000
    s_mov_b32 s40, s12
    s_mov_b32 s41, s13
    s_and_b32 s41, s41, 0xffff
    s_mov_b32 s42, 663552
    s_mov_b32 s43, 0x20000
    s_add_u32 m0, s68, 73728
    s_add_u32 s69, s68, 73728
    buffer_load_dwordx4 v6, s[44:47], s69 offen sc1 lds
    s_cmp_ge_u32 s32, 3
    s_cselect_b32 s64, 1, 0
    s_mul_i32 s53, s64, 3
    s_sub_u32 s53, s32, s53
    s_min_u32 s53, s53, 2
    s_mul_i32 s65, s53, 3072
    s_mul_i32 s54, s64, 9216
    s_add_u32 s65, s65, s54
    s_mul_i32 s56, s53, 192
    s_mul_i32 s54, s31, 288
    s_add_u32 s52, s56, 0
    v_add_u32 v16, s52, v1
    v_mul_u32_u24 v17, 58255, v16
    v_lshrrev_b32 v17, 20, v17
    v_mul_u32_u24 v18, 18, v17
    v_sub_u32 v18, v16, v18
    v_mul_u32_u24 v19, 1152, v17
    v_lshl_add_u32 v19, v18, 4, v19
    v_add_u32 v175, s54, v19
    s_add_u32 s52, s56, 64
    v_add_u32 v16, s52, v1
    v_mul_u32_u24 v17, 58255, v16
    v_lshrrev_b32 v17, 20, v17
    v_mul_u32_u24 v18, 18, v17
    v_sub_u32 v18, v16, v18
    v_mul_u32_u24 v19, 1152, v17
    s_add_u32 m0, s68, 114688
    s_add_u32 s69, s68, 114688
    buffer_load_dwordx4 v6, s[44:47], s69 offen sc1 lds
    v_lshl_add_u32 v19, v18, 4, v19
    v_add_u32 v176, s54, v19
    s_add_u32 s52, s56, 128
    v_add_u32 v16, s52, v1
    v_mul_u32_u24 v17, 58255, v16
    v_lshrrev_b32 v17, 20, v17
    v_mul_u32_u24 v18, 18, v17
    v_sub_u32 v18, v16, v18
    v_mul_u32_u24 v19, 1152, v17
    v_lshl_add_u32 v19, v18, 4, v19
    v_add_u32 v177, s54, v19
    s_lshl_b32 s52, s30, 1
    s_add_u32 s52, s52, s64
    s_mul_i32 s61, s52, 663552
    s_lshl_b32 s52, s34, 10
    v_lshlrev_b32 v182, 4, v1
    v_add_u32 v182, s52, v182
    v_xor_b32 v183, 0x400, v182
    v_and_b32 v14, 15, v1
    v_lshrrev_b32 v15, 4, v1
    v_lshrrev_b32 v16, 2, v14
    v_lshl_add_u32 v16, v15, 2, v16
    v_and_b32 v17, 3, v14
    v_lshlrev_b32 v17, 3, v17
    v_mul_u32_u24 v18, 288, v16
    v_add_u32 v172, v18, v17
    s_add_u32 m0, s68, 122880
    s_add_u32 s69, s68, 122880
    buffer_load_dwordx4 v6, s[44:47], s69 offen sc1 lds
    s_mul_i32 s52, s34, 9216
    v_add_u32 v172, s52, v172
    v_add_u32 v173, 55296, v172
    v_add_u32 v174, 110592, v172
    s_lshl_b32 s52, s28, 4
    s_lshl_b32 s53, s30, 2
    s_add_u32 s52, s52, s53
    s_lshl_b32 s53, s34, 1
    s_add_u32 s52, s52, s53
    s_mul_i32 s52, s52, 73728
    s_lshl_b32 s53, s33, 11
    s_add_u32 s52, s52, s53
    s_add_u32 s66, s52, 8388608
    s_lshl_b32 s52, s31, 1
    s_add_u32 s52, s52, s34
    s_mul_i32 s52, s52, 20
    v_and_b32 v13, 31, v1
    v_lshrrev_b32 v14, 5, v1
    s_lshl_b32 s54, s33, 5
    v_add_u32 v13, s54, v13
    v_lshrrev_b32 v15, 4, v13
    v_lshlrev_b32 v15, 10, v15
    v_and_b32 v13, 15, v13
    v_lshl_add_u32 v15, v13, 4, v15
    v_lshlrev_b32 v16, 2, v14
    v_add_u32 v16, 0, v16
    v_add_u32 v16, s52, v16
    v_lshrrev_b32 v17, 5, v16
    v_lshlrev_b32 v17, 13, v17
    v_bfe_u32 v18, v16, 3, 2
    v_lshl_add_u32 v17, v18, 8, v17
    v_bfe_u32 v18, v16, 2, 1
    v_lshl_add_u32 v17, v18, 3, v17
    v_add_u32 v20, v17, v15
    v_lshlrev_b32 v16, 2, v14
    v_add_u32 v16, 8, v16
    v_add_u32 v16, s52, v16
    v_lshrrev_b32 v17, 5, v16
    v_lshlrev_b32 v17, 13, v17
    v_bfe_u32 v18, v16, 3, 2
    v_lshl_add_u32 v17, v18, 8, v17
    v_bfe_u32 v18, v16, 2, 1
    v_lshl_add_u32 v17, v18, 3, v17
    v_add_u32 v21, v17, v15
    v_lshlrev_b32 v16, 2, v14
    v_add_u32 v16, 16, v16
    v_add_u32 v16, s52, v16
    v_lshrrev_b32 v17, 5, v16
    v_lshlrev_b32 v17, 13, v17
    v_bfe_u32 v18, v16, 3, 2
    v_lshl_add_u32 v17, v18, 8, v17
    v_bfe_u32 v18, v16, 2, 1
    v_lshl_add_u32 v17, v18, 3, v17
    v_add_u32 v22, v17, v15
    v_mov_b32 v18, 0x7f000000
    v_cmp_gt_u32 vcc, 32, v1
    s_nop 1
    v_cndmask_b32 v22, v18, v22, vcc
    s_waitcnt vmcnt(0)
    s_barrier
    v_mov_b32 v72, 0
    v_mov_b32 v73, 0
    v_mov_b32 v74, 0
    v_mov_b32 v75, 0
    v_mov_b32 v76, 0
    v_mov_b32 v77, 0
    v_mov_b32 v78, 0
    v_mov_b32 v79, 0
    v_mov_b32 v80, 0
    v_mov_b32 v81, 0
    v_mov_b32 v82, 0
    v_mov_b32 v83, 0
    v_mov_b32 v84, 0
    v_mov_b32 v85, 0
    v_mov_b32 v86, 0
    v_mov_b32 v87, 0
    v_mov_b32 v88, 0
    v_mov_b32 v89, 0
    v_mov_b32 v90, 0
    v_mov_b32 v91, 0
    v_mov_b32 v92, 0
    v_mov_b32 v93, 0
    v_mov_b32 v94, 0
    v_mov_b32 v95, 0
    v_mov_b32 v96, 0
    v_mov_b32 v97, 0
    v_mov_b32 v98, 0
    v_mov_b32 v99, 0
    v_mov_b32 v100, 0
    v_mov_b32 v101, 0
    v_mov_b32 v102, 0
    v_mov_b32 v103, 0
    ds_read_b128 v[112:115], v2 offset:0
    ds_read_b32 v120, v3 offset:0
    ds_read_b128 v[128:131], v4 offset:0
    ds_read_b128 v[116:119], v2 offset:1024
    ds_read_b32 v124, v3 offset:128
    ds_read_b128 v[136:139], v4 offset:672
    s_waitcnt lgkmcnt(4)
    v_mfma_f32_32x32x16_bf16 v[40:55], v[112:115], v[24:27], 0
    v_mfma_f32_32x32x8bf16_1k v[40:55], v[120:121], v[32:33], v[40:55]
    s_nop 7
    s_nop 3
    v_mfma_f32_32x32x16_bf16 v[56:71], v[112:115], v[28:31], 0
    ds_read_b128 v[132:135], v4 offset:1344
    v_exp_f32 v40, v40
    v_exp_f32 v41, v41
    v_exp_f32 v42, v42
    v_exp_f32 v43, v43
    s_add_u32 m0, s68, 8192
    s_add_u32 s69, s68, 8192
    buffer_load_dwordx4 v6, s[44:47], s69 offen sc1 lds
    v_exp_f32 v44, v44
    v_exp_f32 v45, v45
    v_exp_f32 v46, v46
    v_exp_f32 v47, v47
    v_cvt_pk_bf16_f32 v104, v40, v41
    v_cvt_pk_bf16_f32 v105, v42, v43
    v_mfma_f32_32x32x8bf16_1k v[56:71], v[120:121], v[36:37], v[56:71]
    v_exp_f32 v48, v48
    v_exp_f32 v49, v49
    v_exp_f32 v50, v50
    v_exp_f32 v51, v51
    v_cvt_pk_bf16_f32 v106, v44, v45
    v_cvt_pk_bf16_f32 v107, v46, v47
    v_exp_f32 v52, v52
    v_exp_f32 v53, v53
    s_waitcnt lgkmcnt(4)
    v_mfma_f32_32x32x16_bf16 v[72:87], v[128:131], v[104:107], v[72:87]
    v_exp_f32 v54, v54
    v_exp_f32 v55, v55
    v_cvt_pk_bf16_f32 v108, v48, v49
    v_cvt_pk_bf16_f32 v109, v50, v51
    v_cvt_pk_bf16_f32 v110, v52, v53
    v_cvt_pk_bf16_f32 v111, v54, v55
    s_waitcnt lgkmcnt(2)
    v_mfma_f32_32x32x16_bf16 v[40:55], v[116:119], v[24:27], 0
    v_exp_f32 v56, v56
    v_exp_f32 v57, v57
    v_exp_f32 v58, v58
    v_exp_f32 v59, v59
    s_add_u32 m0, s68, 81920
    s_add_u32 s69, s68, 81920
    buffer_load_dwordx4 v6, s[44:47], s69 offen sc1 lds
    s_waitcnt lgkmcnt(1)
    v_mfma_f32_32x32x16_bf16 v[72:87], v[136:139], v[108:111], v[72:87]
    v_exp_f32 v60, v60
    v_exp_f32 v61, v61
    v_exp_f32 v62, v62
    v_exp_f32 v63, v63
    v_cvt_pk_bf16_f32 v104, v56, v57
    v_cvt_pk_bf16_f32 v105, v58, v59
    v_mfma_f32_32x32x8bf16_1k v[40:55], v[124:125], v[32:33], v[40:55]
    ds_read_b128 v[112:115], v2 offset:2048
    ds_read_b32 v120, v3 offset:256
    ds_read_b128 v[140:143], v4 offset:2016
    v_exp_f32 v64, v64
    v_exp_f32 v65, v65
    v_exp_f32 v66, v66
    v_exp_f32 v67, v67
    v_cvt_pk_bf16_f32 v106, v60, v61
    v_cvt_pk_bf16_f32 v107, v62, v63
    v_exp_f32 v68, v68
    v_exp_f32 v69, v69
    v_mfma_f32_32x32x16_bf16 v[88:103], v[128:131], v[104:107], v[88:103]
    v_exp_f32 v70, v70
    v_exp_f32 v71, v71
    v_cvt_pk_bf16_f32 v108, v64, v65
    v_cvt_pk_bf16_f32 v109, v66, v67
    v_cvt_pk_bf16_f32 v110, v68, v69
    v_cvt_pk_bf16_f32 v111, v70, v71
    v_mfma_f32_32x32x16_bf16 v[56:71], v[116:119], v[28:31], 0
    ds_read_b128 v[128:131], v4 offset:2688
    v_exp_f32 v40, v40
    v_exp_f32 v41, v41
    v_exp_f32 v42, v42
    v_exp_f32 v43, v43
    s_add_u32 m0, s68, 131072
    s_add_u32 s69, s68, 131072
    buffer_load_dwordx4 v6, s[44:47], s69 offen sc1 lds
    v_mfma_f32_32x32x16_bf16 v[88:103], v[136:139], v[108:111], v[88:103]
    v_exp_f32 v44, v44
    v_exp_f32 v45, v45
    v_exp_f32 v46, v46
    v_exp_f32 v47, v47
    v_cvt_pk_bf16_f32 v104, v40, v41
    v_cvt_pk_bf16_f32 v105, v42, v43
    v_mfma_f32_32x32x8bf16_1k v[56:71], v[124:125], v[36:37], v[56:71]
    v_exp_f32 v48, v48
    v_exp_f32 v49, v49
    v_exp_f32 v50, v50
    v_exp_f32 v51, v51
    v_cvt_pk_bf16_f32 v106, v44, v45
    v_cvt_pk_bf16_f32 v107, v46, v47
    v_exp_f32 v52, v52
    v_exp_f32 v53, v53
    s_waitcnt lgkmcnt(4)
    v_mfma_f32_32x32x16_bf16 v[72:87], v[132:135], v[104:107], v[72:87]
    v_exp_f32 v54, v54
    v_exp_f32 v55, v55
    v_cvt_pk_bf16_f32 v108, v48, v49
    v_cvt_pk_bf16_f32 v109, v50, v51
    v_cvt_pk_bf16_f32 v110, v52, v53
    v_cvt_pk_bf16_f32 v111, v54, v55
    s_waitcnt lgkmcnt(2)
    v_mfma_f32_32x32x16_bf16 v[40:55], v[112:115], v[24:27], 0
    v_exp_f32 v56, v56
    v_exp_f32 v57, v57
    v_exp_f32 v58, v58
    v_exp_f32 v59, v59
    s_add_u32 m0, s68, 49152
    s_add_u32 s69, s68, 49152
    buffer_load_dwordx4 v6, s[44:47], s69 offen sc1 lds
    s_waitcnt lgkmcnt(1)
    v_mfma_f32_32x32x16_bf16 v[72:87], v[140:143], v[108:111], v[72:87]
    v_exp_f32 v60, v60
    v_exp_f32 v61, v61
    v_exp_f32 v62, v62
    v_exp_f32 v63, v63
    v_cvt_pk_bf16_f32 v104, v56, v57
    v_cvt_pk_bf16_f32 v105, v58, v59
    v_mfma_f32_32x32x8bf16_1k v[40:55], v[120:121], v[32:33], v[40:55]
    ds_read_b128 v[116:119], v2 offset:3072
    ds_read_b32 v124, v3 offset:384
    ds_read_b128 v[136:139], v4 offset:3360
    v_exp_f32 v64, v64
    v_exp_f32 v65, v65
    v_exp_f32 v66, v66
    v_exp_f32 v67, v67
    v_cvt_pk_bf16_f32 v106, v60, v61
    v_cvt_pk_bf16_f32 v107, v62, v63
    v_exp_f32 v68, v68
    v_exp_f32 v69, v69
    v_mfma_f32_32x32x16_bf16 v[88:103], v[132:135], v[104:107], v[88:103]
    v_exp_f32 v70, v70
    v_exp_f32 v71, v71
    v_cvt_pk_bf16_f32 v108, v64, v65
    v_cvt_pk_bf16_f32 v109, v66, v67
    v_cvt_pk_bf16_f32 v110, v68, v69
    v_cvt_pk_bf16_f32 v111, v70, v71
    v_mfma_f32_32x32x16_bf16 v[56:71], v[112:115], v[28:31], 0
    ds_read_b128 v[132:135], v4 offset:4032
    v_exp_f32 v40, v40
    v_exp_f32 v41, v41
    v_exp_f32 v42, v42
    v_exp_f32 v43, v43
    s_add_u32 m0, s68, 16384
    s_add_u32 s69, s68, 16384
    buffer_load_dwordx4 v6, s[44:47], s69 offen sc1 lds
    v_mfma_f32_32x32x16_bf16 v[88:103], v[140:143], v[108:111], v[88:103]
    v_exp_f32 v44, v44
    v_exp_f32 v45, v45
    v_exp_f32 v46, v46
    v_exp_f32 v47, v47
    v_cvt_pk_bf16_f32 v104, v40, v41
    v_cvt_pk_bf16_f32 v105, v42, v43
    v_mfma_f32_32x32x8bf16_1k v[56:71], v[120:121], v[36:37], v[56:71]
    v_exp_f32 v48, v48
    v_exp_f32 v49, v49
    v_exp_f32 v50, v50
    v_exp_f32 v51, v51
    v_cvt_pk_bf16_f32 v106, v44, v45
    v_cvt_pk_bf16_f32 v107, v46, v47
    v_exp_f32 v52, v52
    v_exp_f32 v53, v53
    s_waitcnt lgkmcnt(4)
    v_mfma_f32_32x32x16_bf16 v[72:87], v[128:131], v[104:107], v[72:87]
    v_exp_f32 v54, v54
    v_exp_f32 v55, v55
    v_cvt_pk_bf16_f32 v108, v48, v49
    v_cvt_pk_bf16_f32 v109, v50, v51
    v_cvt_pk_bf16_f32 v110, v52, v53
    v_cvt_pk_bf16_f32 v111, v54, v55
    s_waitcnt lgkmcnt(2)
    v_mfma_f32_32x32x16_bf16 v[40:55], v[116:119], v[24:27], 0
    v_exp_f32 v56, v56
    v_exp_f32 v57, v57
    v_exp_f32 v58, v58
    v_exp_f32 v59, v59
    s_add_u32 m0, s68, 90112
    s_add_u32 s69, s68, 90112
    buffer_load_dwordx4 v6, s[44:47], s69 offen sc1 lds
    s_waitcnt lgkmcnt(1)
    v_mfma_f32_32x32x16_bf16 v[72:87], v[136:139], v[108:111], v[72:87]
    v_exp_f32 v60, v60
    v_exp_f32 v61, v61
    v_exp_f32 v62, v62
    v_exp_f32 v63, v63
    v_cvt_pk_bf16_f32 v104, v56, v57
    v_cvt_pk_bf16_f32 v105, v58, v59
    v_mfma_f32_32x32x8bf16_1k v[40:55], v[124:125], v[32:33], v[40:55]
    ds_read_b128 v[112:115], v2 offset:4096
    ds_read_b32 v120, v3 offset:512
    ds_read_b128 v[140:143], v4 offset:4704
    v_exp_f32 v64, v64
    v_exp_f32 v65, v65
    v_exp_f32 v66, v66
    v_exp_f32 v67, v67
    v_cvt_pk_bf16_f32 v106, v60, v61
    v_cvt_pk_bf16_f32 v107, v62, v63
    v_exp_f32 v68, v68
    v_exp_f32 v69, v69
    v_mfma_f32_32x32x16_bf16 v[88:103], v[128:131], v[104:107], v[88:103]
    v_exp_f32 v70, v70
    v_exp_f32 v71, v71
    v_cvt_pk_bf16_f32 v108, v64, v65
    v_cvt_pk_bf16_f32 v109, v66, v67
    v_cvt_pk_bf16_f32 v110, v68, v69
    v_cvt_pk_bf16_f32 v111, v70, v71
    v_mfma_f32_32x32x16_bf16 v[56:71], v[116:119], v[28:31], 0
    ds_read_b128 v[128:131], v4 offset:5376
    v_exp_f32 v40, v40
    v_exp_f32 v41, v41
    v_exp_f32 v42, v42
    v_exp_f32 v43, v43
    s_add_u32 m0, s68, 139264
    s_add_u32 s69, s68, 139264
    buffer_load_dwordx4 v6, s[44:47], s69 offen sc1 lds
    v_mfma_f32_32x32x16_bf16 v[88:103], v[136:139], v[108:111], v[88:103]
    v_exp_f32 v44, v44
    v_exp_f32 v45, v45
    v_exp_f32 v46, v46
    v_exp_f32 v47, v47
    v_cvt_pk_bf16_f32 v104, v40, v41
    v_cvt_pk_bf16_f32 v105, v42, v43
    v_mfma_f32_32x32x8bf16_1k v[56:71], v[124:125], v[36:37], v[56:71]
    v_exp_f32 v48, v48
    v_exp_f32 v49, v49
    v_exp_f32 v50, v50
    v_exp_f32 v51, v51
    v_cvt_pk_bf16_f32 v106, v44, v45
    v_cvt_pk_bf16_f32 v107, v46, v47
    v_exp_f32 v52, v52
    v_exp_f32 v53, v53
    s_waitcnt lgkmcnt(4)
    v_mfma_f32_32x32x16_bf16 v[72:87], v[132:135], v[104:107], v[72:87]
    v_exp_f32 v54, v54
    v_exp_f32 v55, v55
    v_cvt_pk_bf16_f32 v108, v48, v49
    v_cvt_pk_bf16_f32 v109, v50, v51
    v_cvt_pk_bf16_f32 v110, v52, v53
    v_cvt_pk_bf16_f32 v111, v54, v55
    s_waitcnt lgkmcnt(2)
    v_mfma_f32_32x32x16_bf16 v[40:55], v[112:115], v[24:27], 0
    v_exp_f32 v56, v56
    v_exp_f32 v57, v57
    v_exp_f32 v58, v58
    v_exp_f32 v59, v59
    s_add_u32 m0, s68, 57344
    s_add_u32 s69, s68, 57344
    buffer_load_dwordx4 v6, s[44:47], s69 offen sc1 lds
    s_waitcnt lgkmcnt(1)
    v_mfma_f32_32x32x16_bf16 v[72:87], v[140:143], v[108:111], v[72:87]
    v_exp_f32 v60, v60
    v_exp_f32 v61, v61
    v_exp_f32 v62, v62
    v_exp_f32 v63, v63
    v_cvt_pk_bf16_f32 v104, v56, v57
    v_cvt_pk_bf16_f32 v105, v58, v59
    v_mfma_f32_32x32x8bf16_1k v[40:55], v[120:121], v[32:33], v[40:55]
    ds_read_b128 v[116:119], v2 offset:5120
    ds_read_b32 v124, v3 offset:640
    ds_read_b128 v[136:139], v4 offset:6048
    v_exp_f32 v64, v64
    v_exp_f32 v65, v65
    v_exp_f32 v66, v66
    v_exp_f32 v67, v67
    v_cvt_pk_bf16_f32 v106, v60, v61
    v_cvt_pk_bf16_f32 v107, v62, v63
    v_exp_f32 v68, v68
    v_exp_f32 v69, v69
    v_mfma_f32_32x32x16_bf16 v[88:103], v[132:135], v[104:107], v[88:103]
    v_exp_f32 v70, v70
    v_exp_f32 v71, v71
    v_cvt_pk_bf16_f32 v108, v64, v65
    v_cvt_pk_bf16_f32 v109, v66, v67
    v_cvt_pk_bf16_f32 v110, v68, v69
    v_cvt_pk_bf16_f32 v111, v70, v71
    s_waitcnt vmcnt(4)
    s_barrier
    v_mfma_f32_32x32x16_bf16 v[56:71], v[112:115], v[28:31], 0
    ds_read_b128 v[132:135], v4 offset:6720
    v_exp_f32 v40, v40
    v_exp_f32 v41, v41
    v_exp_f32 v42, v42
    v_exp_f32 v43, v43
    s_add_u32 m0, s68, 24576
    s_add_u32 s69, s68, 24576
    buffer_load_dwordx4 v6, s[44:47], s69 offen sc1 lds
    v_mfma_f32_32x32x16_bf16 v[88:103], v[140:143], v[108:111], v[88:103]
    v_exp_f32 v44, v44
    v_exp_f32 v45, v45
    v_exp_f32 v46, v46
    v_exp_f32 v47, v47
    v_cvt_pk_bf16_f32 v104, v40, v41
    v_cvt_pk_bf16_f32 v105, v42, v43
    v_mfma_f32_32x32x8bf16_1k v[56:71], v[120:121], v[36:37], v[56:71]
    v_exp_f32 v48, v48
    v_exp_f32 v49, v49
    v_exp_f32 v50, v50
    v_exp_f32 v51, v51
    v_cvt_pk_bf16_f32 v106, v44, v45
    v_cvt_pk_bf16_f32 v107, v46, v47
    v_exp_f32 v52, v52
    v_exp_f32 v53, v53
    s_waitcnt lgkmcnt(4)
    v_mfma_f32_32x32x16_bf16 v[72:87], v[128:131], v[104:107], v[72:87]
    v_exp_f32 v54, v54
    v_exp_f32 v55, v55
    v_cvt_pk_bf16_f32 v108, v48, v49
    v_cvt_pk_bf16_f32 v109, v50, v51
    v_cvt_pk_bf16_f32 v110, v52, v53
    v_cvt_pk_bf16_f32 v111, v54, v55
    s_waitcnt lgkmcnt(2)
    v_mfma_f32_32x32x16_bf16 v[40:55], v[116:119], v[24:27], 0
    v_exp_f32 v56, v56
    v_exp_f32 v57, v57
    v_exp_f32 v58, v58
    v_exp_f32 v59, v59
    s_add_u32 m0, s68, 98304
    s_add_u32 s69, s68, 98304
    buffer_load_dwordx4 v6, s[44:47], s69 offen sc1 lds
    s_waitcnt lgkmcnt(1)
    v_mfma_f32_32x32x16_bf16 v[72:87], v[136:139], v[108:111], v[72:87]
    v_exp_f32 v60, v60
    v_exp_f32 v61, v61
    v_exp_f32 v62, v62
    v_exp_f32 v63, v63
    v_cvt_pk_bf16_f32 v104, v56, v57
    v_cvt_pk_bf16_f32 v105, v58, v59
    v_mfma_f32_32x32x8bf16_1k v[40:55], v[124:125], v[32:33], v[40:55]
    ds_read_b128 v[112:115], v2 offset:6144
    ds_read_b32 v120, v3 offset:768
    ds_read_b128 v[140:143], v4 offset:7392
    v_exp_f32 v64, v64
    v_exp_f32 v65, v65
    v_exp_f32 v66, v66
    v_exp_f32 v67, v67
    s_mul_i32 s56, s34, 24576
    s_add_u32 s56, s56, s67
    s_add_u32 s56, s56, 0
    buffer_store_dwordx4 v[144:147], v6, s[44:47], s56 offen sc1
    v_cvt_pk_bf16_f32 v106, v60, v61
    v_cvt_pk_bf16_f32 v107, v62, v63
    v_exp_f32 v68, v68
    v_exp_f32 v69, v69
    v_mfma_f32_32x32x16_bf16 v[88:103], v[128:131], v[104:107], v[88:103]
    v_exp_f32 v70, v70
    v_exp_f32 v71, v71
    v_cvt_pk_bf16_f32 v108, v64, v65
    v_cvt_pk_bf16_f32 v109, v66, v67
    v_cvt_pk_bf16_f32 v110, v68, v69
    v_cvt_pk_bf16_f32 v111, v70, v71
    v_mfma_f32_32x32x16_bf16 v[56:71], v[116:119], v[28:31], 0
    ds_read_b128 v[128:131], v4 offset:8064
    v_exp_f32 v40, v40
    v_exp_f32 v41, v41
    v_exp_f32 v42, v42
    v_exp_f32 v43, v43
    s_add_u32 m0, s68, 147456
    s_add_u32 s69, s68, 147456
    buffer_load_dwordx4 v6, s[44:47], s69 offen sc1 lds
    v_mfma_f32_32x32x16_bf16 v[88:103], v[136:139], v[108:111], v[88:103]
    v_exp_f32 v44, v44
    v_exp_f32 v45, v45
    v_exp_f32 v46, v46
    v_exp_f32 v47, v47
    v_cvt_pk_bf16_f32 v104, v40, v41
    v_cvt_pk_bf16_f32 v105, v42, v43
    v_mfma_f32_32x32x8bf16_1k v[56:71], v[124:125], v[36:37], v[56:71]
    v_exp_f32 v48, v48
    v_exp_f32 v49, v49
    v_exp_f32 v50, v50
    v_exp_f32 v51, v51
    v_cvt_pk_bf16_f32 v106, v44, v45
    v_cvt_pk_bf16_f32 v107, v46, v47
    v_exp_f32 v52, v52
    v_exp_f32 v53, v53
    s_waitcnt lgkmcnt(4)
    v_mfma_f32_32x32x16_bf16 v[72:87], v[132:135], v[104:107], v[72:87]
    v_exp_f32 v54, v54
    v_exp_f32 v55, v55
    v_cvt_pk_bf16_f32 v108, v48, v49
    v_cvt_pk_bf16_f32 v109, v50, v51
    v_cvt_pk_bf16_f32 v110, v52, v53
    v_cvt_pk_bf16_f32 v111, v54, v55
    s_waitcnt lgkmcnt(2)
    v_mfma_f32_32x32x16_bf16 v[40:55], v[112:115], v[24:27], 0
    v_exp_f32 v56, v56
    v_exp_f32 v57, v57
    v_exp_f32 v58, v58
    v_exp_f32 v59, v59
    s_add_u32 m0, s68, 106496
    s_add_u32 s69, s68, 106496
    buffer_load_dwordx4 v6, s[44:47], s69 offen sc1 lds
    s_waitcnt lgkmcnt(1)
    v_mfma_f32_32x32x16_bf16 v[72:87], v[140:143], v[108:111], v[72:87]
    v_exp_f32 v60, v60
    v_exp_f32 v61, v61
    v_exp_f32 v62, v62
    v_exp_f32 v63, v63
    v_cvt_pk_bf16_f32 v104, v56, v57
    v_cvt_pk_bf16_f32 v105, v58, v59
    v_mfma_f32_32x32x8bf16_1k v[40:55], v[120:121], v[32:33], v[40:55]
    ds_read_b128 v[116:119], v2 offset:7168
    ds_read_b32 v124, v3 offset:896
    ds_read_b128 v[136:139], v4 offset:8736
    v_exp_f32 v64, v64
    v_exp_f32 v65, v65
    v_exp_f32 v66, v66
    v_exp_f32 v67, v67
    s_mul_i32 s56, s34, 24576
    s_add_u32 s56, s56, s67
    s_add_u32 s56, s56, 1024
    buffer_store_dwordx4 v[148:151], v6, s[44:47], s56 offen sc1
    v_cvt_pk_bf16_f32 v106, v60, v61
    v_cvt_pk_bf16_f32 v107, v62, v63
    v_exp_f32 v68, v68
    v_exp_f32 v69, v69
    v_mfma_f32_32x32x16_bf16 v[88:103], v[132:135], v[104:107], v[88:103]
    v_exp_f32 v70, v70
    v_exp_f32 v71, v71
    v_cvt_pk_bf16_f32 v108, v64, v65
    v_cvt_pk_bf16_f32 v109, v66, v67
    v_cvt_pk_bf16_f32 v110, v68, v69
    v_cvt_pk_bf16_f32 v111, v70, v71
    v_mfma_f32_32x32x16_bf16 v[56:71], v[112:115], v[28:31], 0
    ds_read_b128 v[132:135], v4 offset:9408
    v_exp_f32 v40, v40
    v_exp_f32 v41, v41
    v_exp_f32 v42, v42
    v_exp_f32 v43, v43
    s_cmp_lt_u32 s32, 4
    s_cbranch_scc0 .Lk1kvs_172
    s_add_u32 m0, s68, 155648
    s_add_u32 s69, s68, 155648
    buffer_load_dwordx4 v6, s[44:47], s69 offen sc1 lds
.Lk1kvs_172:
    v_mfma_f32_32x32x16_bf16 v[88:103], v[140:143], v[108:111], v[88:103]
    v_exp_f32 v44, v44
    v_exp_f32 v45, v45
    v_exp_f32 v46, v46
    v_exp_f32 v47, v47
    v_cvt_pk_bf16_f32 v104, v40, v41
    v_cvt_pk_bf16_f32 v105, v42, v43
    v_mfma_f32_32x32x8bf16_1k v[56:71], v[120:121], v[36:37], v[56:71]
    v_exp_f32 v48, v48
    v_exp_f32 v49, v49
    v_exp_f32 v50, v50
    v_exp_f32 v51, v51
    v_cvt_pk_bf16_f32 v106, v44, v45
    v_cvt_pk_bf16_f32 v107, v46, v47
    v_exp_f32 v52, v52
    v_exp_f32 v53, v53
    s_waitcnt lgkmcnt(4)
    v_mfma_f32_32x32x16_bf16 v[72:87], v[128:131], v[104:107], v[72:87]
    v_exp_f32 v54, v54
    v_exp_f32 v55, v55
    v_cvt_pk_bf16_f32 v108, v48, v49
    v_cvt_pk_bf16_f32 v109, v50, v51
    v_cvt_pk_bf16_f32 v110, v52, v53
    v_cvt_pk_bf16_f32 v111, v54, v55
    s_waitcnt lgkmcnt(2)
    v_mfma_f32_32x32x16_bf16 v[40:55], v[116:119], v[24:27], 0
    v_exp_f32 v56, v56
    v_exp_f32 v57, v57
    v_exp_f32 v58, v58
    v_exp_f32 v59, v59
    s_mul_i32 s56, s34, 24576
    s_add_u32 s56, s56, s67
    s_add_u32 s56, s56, 8192
    buffer_store_dwordx4 v[152:155], v6, s[44:47], s56 offen sc1
    s_waitcnt lgkmcnt(1)
    v_mfma_f32_32x32x16_bf16 v[72:87], v[136:139], v[108:111], v[72:87]
    v_exp_f32 v60, v60
    v_exp_f32 v61, v61
    v_exp_f32 v62, v62
    v_exp_f32 v63, v63
    v_cvt_pk_bf16_f32 v104, v56, v57
    v_cvt_pk_bf16_f32 v105, v58, v59
    v_mfma_f32_32x32x8bf16_1k v[40:55], v[124:125], v[32:33], v[40:55]
    ds_read_b128 v[112:115], v2 offset:8192
    ds_read_b32 v120, v3 offset:1024
    ds_read_b128 v[140:143], v4 offset:10080
    v_exp_f32 v64, v64
    v_exp_f32 v65, v65
    v_exp_f32 v66, v66
    v_exp_f32 v67, v67
    v_cvt_pk_bf16_f32 v106, v60, v61
    v_cvt_pk_bf16_f32 v107, v62, v63
    v_exp_f32 v68, v68
    v_exp_f32 v69, v69
    v_mfma_f32_32x32x16_bf16 v[88:103], v[128:131], v[104:107], v[88:103]
    v_exp_f32 v70, v70
    v_exp_f32 v71, v71
    v_cvt_pk_bf16_f32 v108, v64, v65
    v_cvt_pk_bf16_f32 v109, v66, v67
    v_cvt_pk_bf16_f32 v110, v68, v69
    v_cvt_pk_bf16_f32 v111, v70, v71
    v_mfma_f32_32x32x16_bf16 v[56:71], v[116:119], v[28:31], 0
    ds_read_b128 v[128:131], v4 offset:10752
    v_exp_f32 v40, v40
    v_exp_f32 v41, v41
    v_exp_f32 v42, v42
    v_exp_f32 v43, v43
    v_mfma_f32_32x32x16_bf16 v[88:103], v[136:139], v[108:111], v[88:103]
    v_exp_f32 v44, v44
    v_exp_f32 v45, v45
    v_exp_f32 v46, v46
    v_exp_f32 v47, v47
    v_cvt_pk_bf16_f32 v104, v40, v41
    v_cvt_pk_bf16_f32 v105, v42, v43
    v_mfma_f32_32x32x8bf16_1k v[56:71], v[124:125], v[36:37], v[56:71]
    v_exp_f32 v48, v48
    v_exp_f32 v49, v49
    v_exp_f32 v50, v50
    v_exp_f32 v51, v51
    v_cvt_pk_bf16_f32 v106, v44, v45
    v_cvt_pk_bf16_f32 v107, v46, v47
    v_exp_f32 v52, v52
    v_exp_f32 v53, v53
    s_waitcnt lgkmcnt(4)
    v_mfma_f32_32x32x16_bf16 v[72:87], v[132:135], v[104:107], v[72:87]
    v_exp_f32 v54, v54
    v_exp_f32 v55, v55
    v_cvt_pk_bf16_f32 v108, v48, v49
    v_cvt_pk_bf16_f32 v109, v50, v51
    v_cvt_pk_bf16_f32 v110, v52, v53
    v_cvt_pk_bf16_f32 v111, v54, v55
    s_waitcnt lgkmcnt(2)
    v_mfma_f32_32x32x16_bf16 v[40:55], v[112:115], v[24:27], 0
    v_exp_f32 v56, v56
    v_exp_f32 v57, v57
    v_exp_f32 v58, v58
    v_exp_f32 v59, v59
    s_mul_i32 s56, s34, 24576
    s_add_u32 s56, s56, s67
    s_add_u32 s56, s56, 9216
    buffer_store_dwordx4 v[156:159], v6, s[44:47], s56 offen sc1
    s_waitcnt lgkmcnt(1)
    v_mfma_f32_32x32x16_bf16 v[72:87], v[140:143], v[108:111], v[72:87]
    v_exp_f32 v60, v60
    v_exp_f32 v61, v61
    v_exp_f32 v62, v62
    v_exp_f32 v63, v63
    v_cvt_pk_bf16_f32 v104, v56, v57
    v_cvt_pk_bf16_f32 v105, v58, v59
    v_mfma_f32_32x32x8bf16_1k v[40:55], v[120:121], v[32:33], v[40:55]
    ds_read_b128 v[116:119], v2 offset:9216
    ds_read_b32 v124, v3 offset:1152
    ds_read_b128 v[136:139], v4 offset:11424
    v_exp_f32 v64, v64
    v_exp_f32 v65, v65
    v_exp_f32 v66, v66
    v_exp_f32 v67, v67
    v_cvt_pk_bf16_f32 v106, v60, v61
    v_cvt_pk_bf16_f32 v107, v62, v63
    v_exp_f32 v68, v68
    v_exp_f32 v69, v69
    v_mfma_f32_32x32x16_bf16 v[88:103], v[132:135], v[104:107], v[88:103]
    v_exp_f32 v70, v70
    v_exp_f32 v71, v71
    v_cvt_pk_bf16_f32 v108, v64, v65
    v_cvt_pk_bf16_f32 v109, v66, v67
    v_cvt_pk_bf16_f32 v110, v68, v69
    v_cvt_pk_bf16_f32 v111, v70, v71
    s_waitcnt vmcnt(2)
    s_barrier
    s_mov_b32 s36, s18
    s_mov_b32 s37, s19
    s_and_b32 s37, s37, 0xffff
    s_mov_b32 s38, 5308416
    s_mov_b32 s39, 0x20000
    s_mov_b32 s40, s12
    s_mov_b32 s41, s13
    s_and_b32 s41, s41, 0xffff
    s_mov_b32 s42, 663552
    s_mov_b32 s43, 0x20000
    s_and_b32 s52, s28, 7
    s_lshl_b32 s52, s52, 2
    s_add_u32 s52, s52, s31
    s_cmp_lt_u32 s32, 6
    s_cbranch_scc0 .Lk1pfw_173
    s_mul_i32 s53, s52, 324
    s_mul_i32 s54, s32, 54
    s_add_u32 s53, s53, s54
    s_mul_i32 s54, s30, 10368
    s_add_u32 s53, s53, s54
    s_lshl_b32 s53, s53, 7
    v_min_u32 v8, 53, v1
    v_lshlrev_b32 v8, 7, v8
    buffer_load_dword v160, v8, s[36:39], s53 offen
    s_branch .Lk1pfw_173_e
.Lk1pfw_173:
    s_cmp_eq_u32 s32, 6
    s_cbranch_scc0 .Lk1pfw_173_e
    s_mul_i32 s53, s52, 41
    v_min_u32 v8, 40, v1
    v_add_u32 v8, s53, v8
    v_min_u32 v8, 1295, v8
    v_lshlrev_b32 v8, 7, v8
    s_mul_i32 s53, s30, 165888
    buffer_load_dword v160, v8, s[40:43], s53 offen
.Lk1pfw_173_e:
    v_add_u32 v2, 4096, v2
    v_add_u32 v3, 512, v3
    v_add_u32 v4, 5376, v4
    s_mul_i32 s60, s34, 2
    s_sub_u32 s60, 6, s60
    s_mov_b32 s59, 0
.Lk1att_174:
    v_add_u32 v2, 4096, v2
    v_add_u32 v3, 512, v3
    v_add_u32 v4, 5376, v4
    v_mfma_f32_32x32x16_bf16 v[56:71], v[112:115], v[28:31], 0
    ds_read_b128 v[132:135], v4 offset:1344
    v_exp_f32 v40, v40
    v_exp_f32 v41, v41
    v_exp_f32 v42, v42
    v_exp_f32 v43, v43
    s_cmp_eq_u32 s59, 0
    s_cbranch_scc0 .Lk1it_175
    s_lshl_b32 s57, s34, 3
    s_add_u32 s56, s67, 16384
    s_add_u32 s56, s56, s57
    buffer_store_dwordx2 v[164:165], v6, s[44:47], s56 offen sc1
.Lk1it_175:
    v_mfma_f32_32x32x16_bf16 v[88:103], v[140:143], v[108:111], v[88:103]
    v_exp_f32 v44, v44
    v_exp_f32 v45, v45
    v_exp_f32 v46, v46
    v_exp_f32 v47, v47
    v_cvt_pk_bf16_f32 v104, v40, v41
    v_cvt_pk_bf16_f32 v105, v42, v43
    v_mfma_f32_32x32x8bf16_1k v[56:71], v[120:121], v[36:37], v[56:71]
    v_exp_f32 v48, v48
    v_exp_f32 v49, v49
    v_exp_f32 v50, v50
    v_exp_f32 v51, v51
    v_cvt_pk_bf16_f32 v106, v44, v45
    v_cvt_pk_bf16_f32 v107, v46, v47
    v_exp_f32 v52, v52
    v_exp_f32 v53, v53
    s_waitcnt lgkmcnt(4)
    v_mfma_f32_32x32x16_bf16 v[72:87], v[128:131], v[104:107], v[72:87]
    v_exp_f32 v54, v54
    v_exp_f32 v55, v55
    v_cvt_pk_bf16_f32 v108, v48, v49
    v_cvt_pk_bf16_f32 v109, v50, v51
    v_cvt_pk_bf16_f32 v110, v52, v53
    v_cvt_pk_bf16_f32 v111, v54, v55
    s_waitcnt lgkmcnt(2)
    v_mfma_f32_32x32x16_bf16 v[40:55], v[116:119], v[24:27], 0
    v_exp_f32 v56, v56
    v_exp_f32 v57, v57
    v_exp_f32 v58, v58
    v_exp_f32 v59, v59
    s_waitcnt lgkmcnt(1)
    v_mfma_f32_32x32x16_bf16 v[72:87], v[136:139], v[108:111], v[72:87]
    v_exp_f32 v60, v60
    v_exp_f32 v61, v61
    v_exp_f32 v62, v62
    v_exp_f32 v63, v63
    v_cvt_pk_bf16_f32 v104, v56, v57
    v_cvt_pk_bf16_f32 v105, v58, v59
    v_mfma_f32_32x32x8bf16_1k v[40:55], v[124:125], v[32:33], v[40:55]
    ds_read_b128 v[112:115], v2 offset:2048
    ds_read_b32 v120, v3 offset:256
    ds_read_b128 v[140:143], v4 offset:2016
    v_exp_f32 v64, v64
    v_exp_f32 v65, v65
    v_exp_f32 v66, v66
    v_exp_f32 v67, v67
    v_cvt_pk_bf16_f32 v106, v60, v61
    v_cvt_pk_bf16_f32 v107, v62, v63
    v_exp_f32 v68, v68
    v_exp_f32 v69, v69
    v_mfma_f32_32x32x16_bf16 v[88:103], v[128:131], v[104:107], v[88:103]
    v_exp_f32 v70, v70
    v_exp_f32 v71, v71
    v_cvt_pk_bf16_f32 v108, v64, v65
    v_cvt_pk_bf16_f32 v109, v66, v67
    v_cvt_pk_bf16_f32 v110, v68, v69
    v_cvt_pk_bf16_f32 v111, v70, v71
    v_mfma_f32_32x32x16_bf16 v[56:71], v[116:119], v[28:31], 0
    ds_read_b128 v[128:131], v4 offset:2688
    v_exp_f32 v40, v40
    v_exp_f32 v41, v41
    v_exp_f32 v42, v42
    v_exp_f32 v43, v43
    v_mfma_f32_32x32x16_bf16 v[88:103], v[136:139], v[108:111], v[88:103]
    v_exp_f32 v44, v44
    v_exp_f32 v45, v45
    v_exp_f32 v46, v46
    v_exp_f32 v47, v47
    v_cvt_pk_bf16_f32 v104, v40, v41
    v_cvt_pk_bf16_f32 v105, v42, v43
    v_mfma_f32_32x32x8bf16_1k v[56:71], v[124:125], v[36:37], v[56:71]
    v_exp_f32 v48, v48
    v_exp_f32 v49, v49
    v_exp_f32 v50, v50
    v_exp_f32 v51, v51
    v_cvt_pk_bf16_f32 v106, v44, v45
    v_cvt_pk_bf16_f32 v107, v46, v47
    v_exp_f32 v52, v52
    v_exp_f32 v53, v53
    s_waitcnt lgkmcnt(4)
    v_mfma_f32_32x32x16_bf16 v[72:87], v[132:135], v[104:107], v[72:87]
    v_exp_f32 v54, v54
    v_exp_f32 v55, v55
    v_cvt_pk_bf16_f32 v108, v48, v49
    v_cvt_pk_bf16_f32 v109, v50, v51
    v_cvt_pk_bf16_f32 v110, v52, v53
    v_cvt_pk_bf16_f32 v111, v54, v55
    s_waitcnt lgkmcnt(2)
    v_mfma_f32_32x32x16_bf16 v[40:55], v[112:115], v[24:27], 0
    v_exp_f32 v56, v56
    v_exp_f32 v57, v57
    v_exp_f32 v58, v58
    v_exp_f32 v59, v59
    s_waitcnt lgkmcnt(1)
    v_mfma_f32_32x32x16_bf16 v[72:87], v[140:143], v[108:111], v[72:87]
    v_exp_f32 v60, v60
    v_exp_f32 v61, v61
    v_exp_f32 v62, v62
    v_exp_f32 v63, v63
    v_cvt_pk_bf16_f32 v104, v56, v57
    v_cvt_pk_bf16_f32 v105, v58, v59
    v_mfma_f32_32x32x8bf16_1k v[40:55], v[120:121], v[32:33], v[40:55]
    ds_read_b128 v[116:119], v2 offset:3072
    ds_read_b32 v124, v3 offset:384
    ds_read_b128 v[136:139], v4 offset:3360
    v_exp_f32 v64, v64
    v_exp_f32 v65, v65
    v_exp_f32 v66, v66
    v_exp_f32 v67, v67
    v_cvt_pk_bf16_f32 v106, v60, v61
    v_cvt_pk_bf16_f32 v107, v62, v63
    v_exp_f32 v68, v68
    v_exp_f32 v69, v69
    v_mfma_f32_32x32x16_bf16 v[88:103], v[132:135], v[104:107], v[88:103]
    v_exp_f32 v70, v70
    v_exp_f32 v71, v71
    v_cvt_pk_bf16_f32 v108, v64, v65
    v_cvt_pk_bf16_f32 v109, v66, v67
    v_cvt_pk_bf16_f32 v110, v68, v69
    v_cvt_pk_bf16_f32 v111, v70, v71
    v_mfma_f32_32x32x16_bf16 v[56:71], v[112:115], v[28:31], 0
    ds_read_b128 v[132:135], v4 offset:4032
    v_exp_f32 v40, v40
    v_exp_f32 v41, v41
    v_exp_f32 v42, v42
    v_exp_f32 v43, v43
    s_cmp_eq_u32 s59, 0
    s_cbranch_scc0 .Lk1it_176
    s_lshl_b32 s57, s34, 3
    s_add_u32 s56, s67, 17408
    s_add_u32 s56, s56, s57
    buffer_store_dwordx2 v[166:167], v6, s[44:47], s56 offen sc1
.Lk1it_176:
    v_mfma_f32_32x32x16_bf16 v[88:103], v[140:143], v[108:111], v[88:103]
    v_exp_f32 v44, v44
    v_exp_f32 v45, v45
    v_exp_f32 v46, v46
    v_exp_f32 v47, v47
    v_cvt_pk_bf16_f32 v104, v40, v41
    v_cvt_pk_bf16_f32 v105, v42, v43
    v_mfma_f32_32x32x8bf16_1k v[56:71], v[120:121], v[36:37], v[56:71]
    v_exp_f32 v48, v48
    v_exp_f32 v49, v49
    v_exp_f32 v50, v50
    v_exp_f32 v51, v51
    v_cvt_pk_bf16_f32 v106, v44, v45
    v_cvt_pk_bf16_f32 v107, v46, v47
    v_exp_f32 v52, v52
    v_exp_f32 v53, v53
    s_waitcnt lgkmcnt(4)
    v_mfma_f32_32x32x16_bf16 v[72:87], v[128:131], v[104:107], v[72:87]
    v_exp_f32 v54, v54
    v_exp_f32 v55, v55
    v_cvt_pk_bf16_f32 v108, v48, v49
    v_cvt_pk_bf16_f32 v109, v50, v51
    v_cvt_pk_bf16_f32 v110, v52, v53
    v_cvt_pk_bf16_f32 v111, v54, v55
    s_waitcnt lgkmcnt(2)
    v_mfma_f32_32x32x16_bf16 v[40:55], v[116:119], v[24:27], 0
    v_exp_f32 v56, v56
    v_exp_f32 v57, v57
    v_exp_f32 v58, v58
    v_exp_f32 v59, v59
    s_waitcnt lgkmcnt(1)
    v_mfma_f32_32x32x16_bf16 v[72:87], v[136:139], v[108:111], v[72:87]
    v_exp_f32 v60, v60
    v_exp_f32 v61, v61
    v_exp_f32 v62, v62
    v_exp_f32 v63, v63
    v_cvt_pk_bf16_f32 v104, v56, v57
    v_cvt_pk_bf16_f32 v105, v58, v59
    v_mfma_f32_32x32x8bf16_1k v[40:55], v[124:125], v[32:33], v[40:55]
    ds_read_b128 v[112:115], v2 offset:4096
    ds_read_b32 v120, v3 offset:512
    ds_read_b128 v[140:143], v4 offset:4704
    v_exp_f32 v64, v64
    v_exp_f32 v65, v65
    v_exp_f32 v66, v66
    v_exp_f32 v67, v67
    v_cvt_pk_bf16_f32 v106, v60, v61
    v_cvt_pk_bf16_f32 v107, v62, v63
    v_exp_f32 v68, v68
    v_exp_f32 v69, v69
    v_mfma_f32_32x32x16_bf16 v[88:103], v[128:131], v[104:107], v[88:103]
    v_exp_f32 v70, v70
    v_exp_f32 v71, v71
    v_cvt_pk_bf16_f32 v108, v64, v65
    v_cvt_pk_bf16_f32 v109, v66, v67
    v_cvt_pk_bf16_f32 v110, v68, v69
    v_cvt_pk_bf16_f32 v111, v70, v71
    v_mfma_f32_32x32x16_bf16 v[56:71], v[116:119], v[28:31], 0
    ds_read_b128 v[128:131], v4 offset:5376
    v_exp_f32 v40, v40
    v_exp_f32 v41, v41
    v_exp_f32 v42, v42
    v_exp_f32 v43, v43
    v_mfma_f32_32x32x16_bf16 v[88:103], v[136:139], v[108:111], v[88:103]
    v_exp_f32 v44, v44
    v_exp_f32 v45, v45
    v_exp_f32 v46, v46
    v_exp_f32 v47, v47
    v_cvt_pk_bf16_f32 v104, v40, v41
    v_cvt_pk_bf16_f32 v105, v42, v43
    v_mfma_f32_32x32x8bf16_1k v[56:71], v[124:125], v[36:37], v[56:71]
    v_exp_f32 v48, v48
    v_exp_f32 v49, v49
    v_exp_f32 v50, v50
    v_exp_f32 v51, v51
    v_cvt_pk_bf16_f32 v106, v44, v45
    v_cvt_pk_bf16_f32 v107, v46, v47
    v_exp_f32 v52, v52
    v_exp_f32 v53, v53
    s_waitcnt lgkmcnt(4)
    v_mfma_f32_32x32x16_bf16 v[72:87], v[132:135], v[104:107], v[72:87]
    v_exp_f32 v54, v54
    v_exp_f32 v55, v55
    v_cvt_pk_bf16_f32 v108, v48, v49
    v_cvt_pk_bf16_f32 v109, v50, v51
    v_cvt_pk_bf16_f32 v110, v52, v53
    v_cvt_pk_bf16_f32 v111, v54, v55
    s_waitcnt lgkmcnt(2)
    v_mfma_f32_32x32x16_bf16 v[40:55], v[112:115], v[24:27], 0
    v_exp_f32 v56, v56
    v_exp_f32 v57, v57
    v_exp_f32 v58, v58
    v_exp_f32 v59, v59
    s_waitcnt lgkmcnt(1)
    v_mfma_f32_32x32x16_bf16 v[72:87], v[140:143], v[108:111], v[72:87]
    v_exp_f32 v60, v60
    v_exp_f32 v61, v61
    v_exp_f32 v62, v62
    v_exp_f32 v63, v63
    v_cvt_pk_bf16_f32 v104, v56, v57
    v_cvt_pk_bf16_f32 v105, v58, v59
    v_mfma_f32_32x32x8bf16_1k v[40:55], v[120:121], v[32:33], v[40:55]
    ds_read_b128 v[116:119], v2 offset:5120
    ds_read_b32 v124, v3 offset:640
    ds_read_b128 v[136:139], v4 offset:6048
    v_exp_f32 v64, v64
    v_exp_f32 v65, v65
    v_exp_f32 v66, v66
    v_exp_f32 v67, v67
    v_cvt_pk_bf16_f32 v106, v60, v61
    v_cvt_pk_bf16_f32 v107, v62, v63
    v_exp_f32 v68, v68
    v_exp_f32 v69, v69
    v_mfma_f32_32x32x16_bf16 v[88:103], v[132:135], v[104:107], v[88:103]
    v_exp_f32 v70, v70
    v_exp_f32 v71, v71
    v_cvt_pk_bf16_f32 v108, v64, v65
    v_cvt_pk_bf16_f32 v109, v66, v67
    v_cvt_pk_bf16_f32 v110, v68, v69
    v_cvt_pk_bf16_f32 v111, v70, v71
    s_cmp_eq_u32 s59, 1
    s_cbranch_scc0 .Lk1it_177
    s_waitcnt vmcnt(0)
    s_barrier
    s_cmp_eq_u32 s32, 0
    s_cbranch_scc0 .Lk1w0_178
    s_lshl_b32 s56, s28, 2
    s_add_u32 s56, s56, s30
    s_lshl_b32 s56, s56, 7
    s_add_u32 s56, s56, 198656
    s_lshl_b32 s57, s31, 2
    s_add_u32 s56, s56, s57
    v_mov_b32 v8, 0x7f000000
    v_mov_b32 v9, 0
    v_cmp_eq_u32 vcc, 0, v1
    s_nop 1
    v_cndmask_b32 v8, v8, v9, vcc
    v_mov_b32 v9, 1
    buffer_store_dword v9, v8, s[44:47], s56 offen sc1
.Lk1w0_178:
    s_cmp_lt_u32 s32, 6
    s_cbranch_scc0 .Lk1wd_179
    s_add_u32 m0, s65, 73728
    s_add_u32 s52, s61, 0
    buffer_load_dwordx4 v175, s[36:39], s52 offen lds
.Lk1wd_179:
    s_cmp_lt_u32 s32, 6
    s_cbranch_scc0 .Lk1wd_180
    s_add_u32 m0, s65, 74752
    s_add_u32 s52, s61, 0
    buffer_load_dwordx4 v176, s[36:39], s52 offen lds
.Lk1wd_180:
    s_cmp_lt_u32 s32, 6
    s_cbranch_scc0 .Lk1wd_181
    s_add_u32 m0, s65, 75776
    s_add_u32 s52, s61, 0
    buffer_load_dwordx4 v177, s[36:39], s52 offen lds
.Lk1wd_181:
    s_cmp_lt_u32 s32, 6
    s_cbranch_scc0 .Lk1wd_182
    s_add_u32 m0, s65, 122112
    s_add_u32 s52, s61, 36864
    buffer_load_dwordx4 v175, s[36:39], s52 offen lds
.Lk1wd_182:
    s_cmp_lt_u32 s32, 6
    s_cbranch_scc0 .Lk1wd_183
    s_add_u32 m0, s65, 123136
    s_add_u32 s52, s61, 36864
    buffer_load_dwordx4 v176, s[36:39], s52 offen lds
.Lk1wd_183:
    s_cmp_lt_u32 s32, 6
    s_cbranch_scc0 .Lk1wd_184
    s_add_u32 m0, s65, 124160
    s_add_u32 s52, s61, 36864
    buffer_load_dwordx4 v177, s[36:39], s52 offen lds
.Lk1wd_184:
    s_cmp_eq_u32 s32, 7
    s_cbranch_scc0 .Lk1cp2_185
    s_getpc_b64 s[54:55]
.Lk1pc2_186:
    s_lshr_b32 s57, s2, 3
    s_lshl_b32 s57, s57, 3
    v_and_b32 v8, 7, v1
    v_add_u32 v8, s57, v8
    v_lshlrev_b32 v8, 7, v8
    s_mov_b32 s56, .Lcode_tail-.Lk1pc2_186
    v_add_u32 v8, s56, v8
    s_mov_b32 s56, .Lcode_end-.Lk1pc2_186-4
    v_min_u32 v8, s56, v8
    v_and_b32 v8, -4, v8
    v_mov_b32 v10, s54
    v_mov_b32 v11, s55
    v_add_co_u32 v10, vcc, v10, v8
    s_nop 1
    v_addc_co_u32 v11, vcc, 0, v11, vcc
    global_load_dword v163, v[10:11], off sc1
.Lk1cp2_185:
.Lk1it_177:
    s_cmp_eq_u32 s60, 2
    s_cbranch_scc0 .Lk1it_187
    s_lshl_b32 s56, s28, 2
    s_add_u32 s56, s56, s30
    s_lshl_b32 s56, s56, 7
    s_add_u32 s56, s56, 198656
    v_mov_b32 v14, 0
    buffer_load_dwordx4 v[168:171], v14, s[44:47], s56 offen sc1
.Lk1it_187:
    s_add_u32 s59, s59, 1
    s_sub_u32 s60, s60, 1
    s_cmp_lg_u32 s60, 0
    s_cbranch_scc1 .Lk1att_174
.Lcode_tail:
    v_add_u32 v2, 4096, v2
    v_add_u32 v3, 512, v3
    v_add_u32 v4, 5376, v4
    v_mfma_f32_32x32x16_bf16 v[56:71], v[112:115], v[28:31], 0
    ds_read_b128 v[132:135], v4 offset:1344
    v_exp_f32 v40, v40
    v_exp_f32 v41, v41
    v_exp_f32 v42, v42
    v_exp_f32 v43, v43
    s_waitcnt vmcnt(0)
    v_min_u32 v168, v168, v169
    v_min_u32 v170, v170, v171
    v_min_u32 v168, v168, v170
    s_nop 0
    v_readfirstlane_b32 s56, v168
    s_nop 1
    s_cmp_lg_u32 s56, 0
    s_cbranch_scc1 .Lk1f2ok_188
    s_mov_b32 s94, 0x20000
.Lk1f2p_189:
    s_lshl_b32 s56, s28, 2
    s_add_u32 s56, s56, s30
    s_lshl_b32 s56, s56, 7
    s_add_u32 s56, s56, 198656
    v_mov_b32 v14, 0
    buffer_load_dwordx4 v[168:171], v14, s[44:47], s56 offen sc1
    s_waitcnt vmcnt(0)
    v_min_u32 v168, v168, v169
    v_min_u32 v170, v170, v171
    v_min_u32 v168, v168, v170
    s_nop 0
    v_readfirstlane_b32 s56, v168
    s_nop 1
    s_cmp_lg_u32 s56, 0
    s_cbranch_scc1 .Lk1f2pd_190
    s_sub_u32 s94, s94, 1
    s_cmp_eq_u32 s94, 0
    s_cbranch_scc1 .Lk1f2pd_190
    s_sleep 1
    s_branch .Lk1f2p_189
.Lk1f2pd_190:
.Lk1f2ok_188:
    v_mfma_f32_32x32x16_bf16 v[88:103], v[140:143], v[108:111], v[88:103]
    v_exp_f32 v44, v44
    v_exp_f32 v45, v45
    v_exp_f32 v46, v46
    v_exp_f32 v47, v47
    v_cvt_pk_bf16_f32 v104, v40, v41
    v_cvt_pk_bf16_f32 v105, v42, v43
    v_mfma_f32_32x32x8bf16_1k v[56:71], v[120:121], v[36:37], v[56:71]
    v_exp_f32 v48, v48
    v_exp_f32 v49, v49
    v_exp_f32 v50, v50
    v_exp_f32 v51, v51
    v_cvt_pk_bf16_f32 v106, v44, v45
    v_cvt_pk_bf16_f32 v107, v46, v47
    v_exp_f32 v52, v52
    v_exp_f32 v53, v53
    s_waitcnt lgkmcnt(4)
    v_mfma_f32_32x32x16_bf16 v[72:87], v[128:131], v[104:107], v[72:87]
    v_exp_f32 v54, v54
    v_exp_f32 v55, v55
    v_cvt_pk_bf16_f32 v108, v48, v49
    v_cvt_pk_bf16_f32 v109, v50, v51
    v_cvt_pk_bf16_f32 v110, v52, v53
    v_cvt_pk_bf16_f32 v111, v54, v55
    s_waitcnt lgkmcnt(2)
    v_mfma_f32_32x32x16_bf16 v[40:55], v[116:119], v[24:27], 0
    v_exp_f32 v56, v56
    v_exp_f32 v57, v57
    v_exp_f32 v58, v58
    v_exp_f32 v59, v59
    v_and_b32 v14, 15, v1
    s_lshl_b32 s52, s33, 1
    s_add_u32 s52, s52, s34
    s_lshl_b32 s52, s52, 4
    v_add_u32 v14, s52, v14
    v_lshlrev_b32 v14, 2, v14
    s_lshl_b32 s52, s28, 9
    s_add_u32 s52, s52, 172032
    buffer_load_dword v181, v14, s[44:47], s52 offen sc1
    s_waitcnt lgkmcnt(1)
    v_mfma_f32_32x32x16_bf16 v[72:87], v[136:139], v[108:111], v[72:87]
    v_exp_f32 v60, v60
    v_exp_f32 v61, v61
    v_exp_f32 v62, v62
    v_exp_f32 v63, v63
    v_cvt_pk_bf16_f32 v104, v56, v57
    v_cvt_pk_bf16_f32 v105, v58, v59
    v_mfma_f32_32x32x8bf16_1k v[40:55], v[124:125], v[32:33], v[40:55]
    ds_read_b128 v[112:115], v2 offset:2048
    ds_read_b32 v120, v3 offset:256
    ds_read_b128 v[140:143], v4 offset:2016
    v_exp_f32 v64, v64
    v_exp_f32 v65, v65
    v_exp_f32 v66, v66
    v_exp_f32 v67, v67
    v_cvt_pk_bf16_f32 v106, v60, v61
    v_cvt_pk_bf16_f32 v107, v62, v63
    v_exp_f32 v68, v68
    v_exp_f32 v69, v69
    v_mfma_f32_32x32x16_bf16 v[88:103], v[128:131], v[104:107], v[88:103]
    v_exp_f32 v70, v70
    v_exp_f32 v71, v71
    v_cvt_pk_bf16_f32 v108, v64, v65
    v_cvt_pk_bf16_f32 v109, v66, v67
    v_cvt_pk_bf16_f32 v110, v68, v69
    v_cvt_pk_bf16_f32 v111, v70, v71
    v_mfma_f32_32x32x16_bf16 v[56:71], v[116:119], v[28:31], 0
    ds_read_b128 v[128:131], v4 offset:2688
    v_exp_f32 v40, v40
    v_exp_f32 v41, v41
    v_exp_f32 v42, v42
    v_exp_f32 v43, v43
    s_add_u32 s52, s66, 0
    buffer_load_dwordx4 v[184:187], v182, s[44:47], s52 offen sc1
    buffer_load_dwordx4 v[188:191], v183, s[44:47], s52 offen sc1
    v_mfma_f32_32x32x16_bf16 v[88:103], v[136:139], v[108:111], v[88:103]
    v_exp_f32 v44, v44
    v_exp_f32 v45, v45
    v_exp_f32 v46, v46
    v_exp_f32 v47, v47
    v_cvt_pk_bf16_f32 v104, v40, v41
    v_cvt_pk_bf16_f32 v105, v42, v43
    v_mfma_f32_32x32x8bf16_1k v[56:71], v[124:125], v[36:37], v[56:71]
    v_exp_f32 v48, v48
    v_exp_f32 v49, v49
    v_exp_f32 v50, v50
    v_exp_f32 v51, v51
    s_add_u32 s52, s66, 8192
    buffer_load_dwordx4 v[192:195], v182, s[44:47], s52 offen sc1
    buffer_load_dwordx4 v[196:199], v183, s[44:47], s52 offen sc1
    v_cvt_pk_bf16_f32 v106, v44, v45
    v_cvt_pk_bf16_f32 v107, v46, v47
    v_exp_f32 v52, v52
    v_exp_f32 v53, v53
    s_waitcnt lgkmcnt(4)
    v_mfma_f32_32x32x16_bf16 v[72:87], v[132:135], v[104:107], v[72:87]
    v_exp_f32 v54, v54
    v_exp_f32 v55, v55
    v_cvt_pk_bf16_f32 v108, v48, v49
    v_cvt_pk_bf16_f32 v109, v50, v51
    v_cvt_pk_bf16_f32 v110, v52, v53
    v_cvt_pk_bf16_f32 v111, v54, v55
    s_waitcnt lgkmcnt(2)
    v_mfma_f32_32x32x16_bf16 v[40:55], v[112:115], v[24:27], 0
    v_exp_f32 v56, v56
    v_exp_f32 v57, v57
    v_exp_f32 v58, v58
    v_exp_f32 v59, v59
    s_add_u32 s52, s66, 16384
    buffer_load_dwordx4 v[200:203], v182, s[44:47], s52 offen sc1
    buffer_load_dwordx4 v[204:207], v183, s[44:47], s52 offen sc1
    s_waitcnt lgkmcnt(1)
    v_mfma_f32_32x32x16_bf16 v[72:87], v[140:143], v[108:111], v[72:87]
    v_exp_f32 v60, v60
    v_exp_f32 v61, v61
    v_exp_f32 v62, v62
    v_exp_f32 v63, v63
    v_cvt_pk_bf16_f32 v104, v56, v57
    v_cvt_pk_bf16_f32 v105, v58, v59
    v_mfma_f32_32x32x8bf16_1k v[40:55], v[120:121], v[32:33], v[40:55]
    ds_read_b128 v[116:119], v2 offset:3072
    ds_read_b32 v124, v3 offset:384
    ds_read_b128 v[136:139], v4 offset:3360
    v_exp_f32 v64, v64
    v_exp_f32 v65, v65
    v_exp_f32 v66, v66
    v_exp_f32 v67, v67
    s_add_u32 s52, s66, 24576
    buffer_load_dwordx4 v[208:211], v182, s[44:47], s52 offen sc1
    buffer_load_dwordx4 v[212:215], v183, s[44:47], s52 offen sc1
    v_cvt_pk_bf16_f32 v106, v60, v61
    v_cvt_pk_bf16_f32 v107, v62, v63
    v_exp_f32 v68, v68
    v_exp_f32 v69, v69
    v_mfma_f32_32x32x16_bf16 v[88:103], v[132:135], v[104:107], v[88:103]
    v_exp_f32 v70, v70
    v_exp_f32 v71, v71
    v_cvt_pk_bf16_f32 v108, v64, v65
    v_cvt_pk_bf16_f32 v109, v66, v67
    v_cvt_pk_bf16_f32 v110, v68, v69
    v_cvt_pk_bf16_f32 v111, v70, v71
    v_mfma_f32_32x32x16_bf16 v[56:71], v[112:115], v[28:31], 0
    ds_read_b128 v[132:135], v4 offset:4032
    v_exp_f32 v40, v40
    v_exp_f32 v41, v41
    v_exp_f32 v42, v42
    v_exp_f32 v43, v43
    s_add_u32 s52, s66, 32768
    buffer_load_dwordx4 v[216:219], v182, s[44:47], s52 offen sc1
    buffer_load_dwordx4 v[220:223], v183, s[44:47], s52 offen sc1
    v_mfma_f32_32x32x16_bf16 v[88:103], v[140:143], v[108:111], v[88:103]
    v_exp_f32 v44, v44
    v_exp_f32 v45, v45
    v_exp_f32 v46, v46
    v_exp_f32 v47, v47
    v_cvt_pk_bf16_f32 v104, v40, v41
    v_cvt_pk_bf16_f32 v105, v42, v43
    v_mfma_f32_32x32x8bf16_1k v[56:71], v[120:121], v[36:37], v[56:71]
    v_exp_f32 v48, v48
    v_exp_f32 v49, v49
    v_exp_f32 v50, v50
    v_exp_f32 v51, v51
    s_add_u32 s52, s66, 40960
    buffer_load_dwordx4 v[224:227], v182, s[44:47], s52 offen sc1
    buffer_load_dwordx4 v[228:231], v183, s[44:47], s52 offen sc1
    v_cvt_pk_bf16_f32 v106, v44, v45
    v_cvt_pk_bf16_f32 v107, v46, v47
    v_exp_f32 v52, v52
    v_exp_f32 v53, v53
    s_waitcnt lgkmcnt(4)
    v_mfma_f32_32x32x16_bf16 v[72:87], v[128:131], v[104:107], v[72:87]
    v_exp_f32 v54, v54
    v_exp_f32 v55, v55
    v_cvt_pk_bf16_f32 v108, v48, v49
    v_cvt_pk_bf16_f32 v109, v50, v51
    v_cvt_pk_bf16_f32 v110, v52, v53
    v_cvt_pk_bf16_f32 v111, v54, v55
    s_waitcnt lgkmcnt(2)
    v_mfma_f32_32x32x16_bf16 v[40:55], v[116:119], v[24:27], 0
    v_exp_f32 v56, v56
    v_exp_f32 v57, v57
    v_exp_f32 v58, v58
    v_exp_f32 v59, v59
    s_add_u32 s52, s66, 49152
    buffer_load_dwordx4 v[232:235], v182, s[44:47], s52 offen sc1
    buffer_load_dwordx4 v[236:239], v183, s[44:47], s52 offen sc1
    s_waitcnt lgkmcnt(1)
    v_mfma_f32_32x32x16_bf16 v[72:87], v[136:139], v[108:111], v[72:87]
    v_exp_f32 v60, v60
    v_exp_f32 v61, v61
    v_exp_f32 v62, v62
    v_exp_f32 v63, v63
    v_cvt_pk_bf16_f32 v104, v56, v57
    v_cvt_pk_bf16_f32 v105, v58, v59
    v_mfma_f32_32x32x8bf16_1k v[40:55], v[124:125], v[32:33], v[40:55]
    ds_read_b128 v[140:143], v4 offset:4704
    v_exp_f32 v64, v64
    v_exp_f32 v65, v65
    v_exp_f32 v66, v66
    v_exp_f32 v67, v67
    s_add_u32 s52, s66, 57344
    buffer_load_dwordx4 v[240:243], v182, s[44:47], s52 offen sc1
    buffer_load_dwordx4 v[244:247], v183, s[44:47], s52 offen sc1
    v_cvt_pk_bf16_f32 v106, v60, v61
    v_cvt_pk_bf16_f32 v107, v62, v63
    v_exp_f32 v68, v68
    v_exp_f32 v69, v69
    v_mfma_f32_32x32x16_bf16 v[88:103], v[128:131], v[104:107], v[88:103]
    v_exp_f32 v70, v70
    v_exp_f32 v71, v71
    v_cvt_pk_bf16_f32 v108, v64, v65
    v_cvt_pk_bf16_f32 v109, v66, v67
    v_cvt_pk_bf16_f32 v110, v68, v69
    v_cvt_pk_bf16_f32 v111, v70, v71
    v_mfma_f32_32x32x16_bf16 v[56:71], v[116:119], v[28:31], 0
    v_exp_f32 v40, v40
    v_exp_f32 v41, v41
    v_exp_f32 v42, v42
    v_exp_f32 v43, v43
    s_add_u32 s52, s66, 65536
    buffer_load_dwordx4 v[248:251], v182, s[44:47], s52 offen sc1
    buffer_load_dwordx4 v[252:255], v183, s[44:47], s52 offen sc1
    v_mfma_f32_32x32x16_bf16 v[88:103], v[136:139], v[108:111], v[88:103]
    v_exp_f32 v44, v44
    v_exp_f32 v45, v45
    v_exp_f32 v46, v46
    v_exp_f32 v47, v47
    v_cvt_pk_bf16_f32 v104, v40, v41
    v_cvt_pk_bf16_f32 v105, v42, v43
    v_mfma_f32_32x32x8bf16_1k v[56:71], v[124:125], v[36:37], v[56:71]
    v_exp_f32 v48, v48
    v_exp_f32 v49, v49
    v_exp_f32 v50, v50
    v_exp_f32 v51, v51
    v_cvt_pk_bf16_f32 v106, v44, v45
    v_cvt_pk_bf16_f32 v107, v46, v47
    v_exp_f32 v52, v52
    v_exp_f32 v53, v53
    s_waitcnt lgkmcnt(1)
    v_mfma_f32_32x32x16_bf16 v[72:87], v[132:135], v[104:107], v[72:87]
    v_exp_f32 v54, v54
    v_exp_f32 v55, v55
    v_cvt_pk_bf16_f32 v108, v48, v49
    v_cvt_pk_bf16_f32 v109, v50, v51
    v_cvt_pk_bf16_f32 v110, v52, v53
    v_cvt_pk_bf16_f32 v111, v54, v55
    v_exp_f32 v56, v56
    v_exp_f32 v57, v57
    v_exp_f32 v58, v58
    v_exp_f32 v59, v59
    s_waitcnt lgkmcnt(0)
    v_mfma_f32_32x32x16_bf16 v[72:87], v[140:143], v[108:111], v[72:87]
    v_exp_f32 v60, v60
    v_exp_f32 v61, v61
    v_exp_f32 v62, v62
    v_exp_f32 v63, v63
    v_cvt_pk_bf16_f32 v104, v56, v57
    v_cvt_pk_bf16_f32 v105, v58, v59
    v_exp_f32 v64, v64
    v_exp_f32 v65, v65
    v_exp_f32 v66, v66
    v_exp_f32 v67, v67
    v_cvt_pk_bf16_f32 v106, v60, v61
    v_cvt_pk_bf16_f32 v107, v62, v63
    v_exp_f32 v68, v68
    v_exp_f32 v69, v69
    v_mfma_f32_32x32x16_bf16 v[88:103], v[132:135], v[104:107], v[88:103]
    v_exp_f32 v70, v70
    v_exp_f32 v71, v71
    v_cvt_pk_bf16_f32 v108, v64, v65
    v_cvt_pk_bf16_f32 v109, v66, v67
    v_cvt_pk_bf16_f32 v110, v68, v69
    v_cvt_pk_bf16_f32 v111, v70, v71
    s_nop 1
    v_mfma_f32_32x32x16_bf16 v[88:103], v[140:143], v[108:111], v[88:103]
.Lk1epi_191:
    s_nop 7
    s_nop 7
    s_barrier
    s_cmp_lt_u32 s32, 6
    s_cbranch_scc0 .Lk1wd_192
    s_add_u32 m0, s65, 0
    s_add_u32 s52, s61, 73728
    buffer_load_dwordx4 v175, s[36:39], s52 offen lds
.Lk1wd_192:
    s_cmp_lt_u32 s32, 6
    s_cbranch_scc0 .Lk1wd_193
    s_add_u32 m0, s65, 1024
    s_add_u32 s52, s61, 73728
    buffer_load_dwordx4 v176, s[36:39], s52 offen lds
.Lk1wd_193:
    s_cmp_lt_u32 s32, 6
    s_cbranch_scc0 .Lk1wd_194
    s_add_u32 m0, s65, 2048
    s_add_u32 s52, s61, 73728
    buffer_load_dwordx4 v177, s[36:39], s52 offen lds
.Lk1wd_194:
    s_cmp_lt_u32 s32, 6
    s_cbranch_scc0 .Lk1wd_195
    s_add_u32 m0, s65, 18432
    s_add_u32 s52, s61, 110592
    buffer_load_dwordx4 v175, s[36:39], s52 offen lds
.Lk1wd_195:
    s_cmp_lt_u32 s32, 6
    s_cbranch_scc0 .Lk1wd_196
    s_add_u32 m0, s65, 19456
    s_add_u32 s52, s61, 110592
    buffer_load_dwordx4 v176, s[36:39], s52 offen lds
.Lk1wd_196:
    s_cmp_lt_u32 s32, 6
    s_cbranch_scc0 .Lk1wd_197
    s_add_u32 m0, s65, 20480
    s_add_u32 s52, s61, 110592
    buffer_load_dwordx4 v177, s[36:39], s52 offen lds
.Lk1wd_197:
    v_lshlrev_b32 v8, 4, v1
    v_add_u32 v8, 36864, v8
    s_mul_i32 s52, s32, 3072
    v_add_u32 v9, s52, v8
    s_xor_b32 s53, s32, 4
    s_mul_i32 s53, s53, 3072
    v_add_u32 v10, s53, v8
    s_cmp_eq_u32 s34, 0
    s_cbranch_scc0 .Lk1e1_198
    ds_write_b128 v9, v[88:91] offset:0
    ds_write_b128 v9, v[92:95] offset:1024
    ds_write_b128 v9, v[96:99] offset:2048
    s_branch .Lk1e2_199
.Lk1e1_198:
    ds_write_b128 v9, v[72:75] offset:0
    ds_write_b128 v9, v[76:79] offset:1024
    ds_write_b128 v9, v[80:83] offset:2048
    v_mov_b32 v72, v88
    v_mov_b32 v73, v89
    v_mov_b32 v74, v90
    v_mov_b32 v75, v91
    v_mov_b32 v76, v92
    v_mov_b32 v77, v93
    v_mov_b32 v78, v94
    v_mov_b32 v79, v95
    v_mov_b32 v80, v96
    v_mov_b32 v81, v97
    v_mov_b32 v82, v98
    v_mov_b32 v83, v99
.Lk1e2_199:
    s_waitcnt lgkmcnt(0)
    s_barrier
    ds_read_b128 v[40:43], v10 offset:0
    ds_read_b128 v[44:47], v10 offset:1024
    ds_read_b128 v[48:51], v10 offset:2048
    s_waitcnt lgkmcnt(0)
    v_add_f32 v72, v72, v40
    v_add_f32 v73, v73, v41
    v_add_f32 v74, v74, v42
    v_add_f32 v75, v75, v43
    v_add_f32 v76, v76, v44
    v_add_f32 v77, v77, v45
    v_add_f32 v78, v78, v46
    v_add_f32 v79, v79, v47
    v_add_f32 v80, v80, v48
    v_add_f32 v81, v81, v49
    v_add_f32 v82, v82, v50
    v_add_f32 v83, v83, v51
    v_mov_b32 v11, v82
    v_mov_b32 v12, v82
    s_nop 1
    v_permlane32_swap_b32 v11, v12
    s_nop 1
    s_cmp_eq_u32 s95, 0
    s_cbranch_scc0 .Lk1lok_200
    v_mov_b32 v12, 0x13800000
    v_cmp_lt_f32 vcc, v11, v12
    s_nop 1
    s_cmp_eq_u64 vcc, 0
    s_cbranch_scc1 .Lk1lok_200
    v_mov_b32 v12, 159812
    v_mov_b32 v13, 1
    ds_write_b32 v12, v13
.Lk1lok_200:
    v_rcp_f32 v12, v11
    s_nop 0
    v_mul_f32 v12, v12, v5
    v_mul_f32 v72, v72, v12
    v_mul_f32 v73, v73, v12
    v_mul_f32 v74, v74, v12
    v_mul_f32 v75, v75, v12
    v_mul_f32 v76, v76, v12
    v_mul_f32 v77, v77, v12
    v_mul_f32 v78, v78, v12
    v_mul_f32 v79, v79, v12
    v_mul_f32 v80, v80, v12
    v_mul_f32 v81, v81, v12
    v_cvt_pk_bf16_f32 v40, v72, v73
    v_cvt_pk_bf16_f32 v41, v74, v75
    v_cvt_pk_bf16_f32 v42, v76, v77
    v_cvt_pk_bf16_f32 v43, v78, v79
    v_cvt_pk_bf16_f32 v44, v80, v81
    v_mov_b32 v45, 0
    s_lshl_b32 s53, s28, 2
    s_add_u32 s53, s53, s30
    s_mul_i32 s53, s53, 40960
    s_add_u32 s53, s53, 4194304
    buffer_store_dwordx2 v[40:41], v20, s[44:47], s53 offen sc1
    buffer_store_dwordx2 v[42:43], v21, s[44:47], s53 offen sc1
    buffer_store_dwordx2 v[44:45], v22, s[44:47], s53 offen sc1
    s_waitcnt lgkmcnt(0)
    s_barrier
    s_cmp_eq_u32 s34, 1
    s_cbranch_scc0 .Lk1k1_202
    s_setprio 1
.Lk1k1_202:
    v_mov_b32 v14, 159812
    ds_read_b32 v15, v14
    ds_read_b64_tr_b16 v[96:97], v173 offset:18432
    ds_read_b64_tr_b16 v[98:99], v173 offset:23040
    ds_read_b64_tr_b16 v[100:101], v173 offset:18464
    ds_read_b64_tr_b16 v[102:103], v173 offset:23072
    ds_read_b64_tr_b16 v[104:105], v173 offset:18496
    ds_read_b64_tr_b16 v[106:107], v173 offset:23104
    ds_read_b64_tr_b16 v[108:109], v173 offset:18528
    ds_read_b64_tr_b16 v[110:111], v173 offset:23136
    ds_read_b64_tr_b16 v[112:113], v173 offset:18560
    ds_read_b64_tr_b16 v[114:115], v173 offset:23168
    ds_read_b64_tr_b16 v[116:117], v173 offset:18592
    ds_read_b64_tr_b16 v[118:119], v173 offset:23200
    ds_read_b64_tr_b16 v[120:121], v173 offset:18624
    ds_read_b64_tr_b16 v[122:123], v173 offset:23232
    ds_read_b64_tr_b16 v[124:125], v173 offset:18656
    ds_read_b64_tr_b16 v[126:127], v173 offset:23264
    ds_read_b64_tr_b16 v[128:129], v173 offset:18688
    ds_read_b64_tr_b16 v[130:131], v173 offset:23296
    s_waitcnt lgkmcnt(15)
    v_readfirstlane_b32 s52, v15
    s_nop 1
    s_sub_u32 s52, s52, s95
    s_cmp_eq_u32 s52, 1
    s_cbranch_scc0 .Lk1nr_203
    s_branch .Lk1redo_201
.Lk1nr_203:
    s_cmp_lt_u32 s32, 6
    s_cselect_b64 vcc, -1, 0
    s_cbranch_vccz .Lk1w2_204
    s_waitcnt vmcnt(25)
    s_branch .Lk1we_205
.Lk1w2_204:
    s_waitcnt vmcnt(19)
.Lk1we_205:
    v_mfma_f32_16x16x32_bf16 v[24:27], v[96:99], v[184:187], 0
    v_mfma_f32_16x16x32_bf16 v[28:31], v[96:99], v[188:191], 0
    s_cbranch_vccz .Lk1wd_206
    s_add_u32 m0, s65, 36864
    s_add_u32 s52, s61, 147456
    buffer_load_dwordx4 v175, s[36:39], s52 offen lds
.Lk1wd_206:
    s_waitcnt lgkmcnt(14)
    v_mfma_f32_16x16x32_bf16 v[32:35], v[100:103], v[184:187], 0
    ds_read_b64_tr_b16 v[96:97], v174 offset:11520
    v_mfma_f32_16x16x32_bf16 v[36:39], v[100:103], v[188:191], 0
    ds_read_b64_tr_b16 v[98:99], v174 offset:16128
    s_cbranch_vccz .Lk1wd_207
    s_add_u32 m0, s65, 37888
    s_add_u32 s52, s61, 147456
    buffer_load_dwordx4 v176, s[36:39], s52 offen lds
.Lk1wd_207:
    s_waitcnt lgkmcnt(14)
    v_mfma_f32_16x16x32_bf16 v[40:43], v[104:107], v[184:187], 0
    ds_read_b64_tr_b16 v[100:101], v174 offset:11552
    v_mfma_f32_16x16x32_bf16 v[44:47], v[104:107], v[188:191], 0
    ds_read_b64_tr_b16 v[102:103], v174 offset:16160
    s_waitcnt lgkmcnt(14)
    v_mfma_f32_16x16x32_bf16 v[48:51], v[108:111], v[184:187], 0
    ds_read_b64_tr_b16 v[104:105], v174 offset:11584
    s_cbranch_vccz .Lk1wd_208
    s_add_u32 m0, s65, 38912
    s_add_u32 s52, s61, 147456
    buffer_load_dwordx4 v177, s[36:39], s52 offen lds
.Lk1wd_208:
    v_mfma_f32_16x16x32_bf16 v[52:55], v[108:111], v[188:191], 0
    ds_read_b64_tr_b16 v[106:107], v174 offset:16192
    s_waitcnt lgkmcnt(14)
    v_mfma_f32_16x16x32_bf16 v[56:59], v[112:115], v[184:187], 0
    ds_read_b64_tr_b16 v[108:109], v174 offset:11616
    v_mfma_f32_16x16x32_bf16 v[60:63], v[112:115], v[188:191], 0
    ds_read_b64_tr_b16 v[110:111], v174 offset:16224
    s_lshr_b32 s56, s65, 10
    s_mul_i32 s53, s64, 9
    s_sub_u32 s56, s56, s53
    s_add_u32 s56, s56, 0
    s_lshl_b32 s56, s56, 6
    v_add_u32 v16, s56, v1
    v_mul_u32_u24 v17, 58255, v16
    v_lshrrev_b32 v17, 20, v17
    v_mul_u32_u24 v18, 18, v17
    v_sub_u32 v18, v16, v18
    s_mul_i32 s53, s31, 288
    v_lshlrev_b32 v18, 4, v18
    v_add_u32 v144, s53, v18
    s_waitcnt lgkmcnt(14)
    v_mfma_f32_16x16x32_bf16 v[64:67], v[116:119], v[184:187], 0
    ds_read_b64_tr_b16 v[112:113], v174 offset:11648
    v_mfma_f32_16x16x32_bf16 v[68:71], v[116:119], v[188:191], 0
    ds_read_b64_tr_b16 v[114:115], v174 offset:16256
    s_waitcnt lgkmcnt(14)
    v_mfma_f32_16x16x32_bf16 v[72:75], v[120:123], v[184:187], 0
    ds_read_b64_tr_b16 v[116:117], v174 offset:11680
    v_and_b32 v19, 3, v17
    v_bfe_u32 v20, v17, 2, 2
    v_lshl_add_u32 v19, v20, 3, v19
    v_bfe_u32 v20, v17, 4, 1
    v_lshl_add_u32 v19, v20, 2, v19
    s_mul_i32 s53, s64, 96
    v_add_u32 v141, s53, v19
    v_mfma_f32_16x16x32_bf16 v[76:79], v[120:123], v[188:191], 0
    ds_read_b64_tr_b16 v[118:119], v174 offset:16288
    s_waitcnt lgkmcnt(14)
    v_mfma_f32_16x16x32_bf16 v[80:83], v[124:127], v[184:187], 0
    ds_read_b64_tr_b16 v[120:121], v174 offset:11712
    v_mfma_f32_16x16x32_bf16 v[84:87], v[124:127], v[188:191], 0
    ds_read_b64_tr_b16 v[122:123], v174 offset:16320
    s_waitcnt lgkmcnt(14)
    v_mfma_f32_16x16x32_bf16 v[88:91], v[128:131], v[184:187], 0
    ds_read_b64_tr_b16 v[124:125], v174 offset:11744
    v_mfma_f32_16x16x32_bf16 v[92:95], v[128:131], v[188:191], 0
    ds_read_b64_tr_b16 v[126:127], v174 offset:16352
    s_add_u32 s52, s66, 73728
    buffer_load_dwordx4 v[184:187], v182, s[44:47], s52 offen sc1
    buffer_load_dwordx4 v[188:191], v183, s[44:47], s52 offen sc1
    s_cbranch_vccz .Lk1w2_209
    s_waitcnt vmcnt(11)
    s_branch .Lk1we_210
.Lk1w2_209:
    s_waitcnt vmcnt(19)
.Lk1we_210:
    s_barrier
    s_waitcnt lgkmcnt(14)
    v_mfma_f32_16x16x32_bf16 v[24:27], v[96:99], v[192:195], v[24:27]
    ds_read_b64_tr_b16 v[128:129], v174 offset:11776
    v_mfma_f32_16x16x32_bf16 v[28:31], v[96:99], v[196:199], v[28:31]
    ds_read_b64_tr_b16 v[130:131], v174 offset:16384
    s_cbranch_vccz .Lk1wd_211
    s_add_u32 m0, s65, 55296
    s_add_u32 s52, s61, 184320
    buffer_load_dwordx4 v175, s[36:39], s52 offen lds
.Lk1wd_211:
    s_waitcnt lgkmcnt(14)
    v_mfma_f32_16x16x32_bf16 v[32:35], v[100:103], v[192:195], v[32:35]
    ds_read_b64_tr_b16 v[96:97], v172 offset:0
    v_mfma_f32_16x16x32_bf16 v[36:39], v[100:103], v[196:199], v[36:39]
    ds_read_b64_tr_b16 v[98:99], v172 offset:4608
    s_cbranch_vccz .Lk1wd_212
    s_add_u32 m0, s65, 56320
    s_add_u32 s52, s61, 184320
    buffer_load_dwordx4 v176, s[36:39], s52 offen lds
.Lk1wd_212:
    s_waitcnt lgkmcnt(14)
    v_mfma_f32_16x16x32_bf16 v[40:43], v[104:107], v[192:195], v[40:43]
    ds_read_b64_tr_b16 v[100:101], v172 offset:32
    v_mfma_f32_16x16x32_bf16 v[44:47], v[104:107], v[196:199], v[44:47]
    ds_read_b64_tr_b16 v[102:103], v172 offset:4640
    s_waitcnt lgkmcnt(14)
    v_mfma_f32_16x16x32_bf16 v[48:51], v[108:111], v[192:195], v[48:51]
    ds_read_b64_tr_b16 v[104:105], v172 offset:64
    s_cbranch_vccz .Lk1wd_213
    s_add_u32 m0, s65, 57344
    s_add_u32 s52, s61, 184320
    buffer_load_dwordx4 v177, s[36:39], s52 offen lds
.Lk1wd_213:
    v_mfma_f32_16x16x32_bf16 v[52:55], v[108:111], v[196:199], v[52:55]
    ds_read_b64_tr_b16 v[106:107], v172 offset:4672
    s_waitcnt lgkmcnt(14)
    v_mfma_f32_16x16x32_bf16 v[56:59], v[112:115], v[192:195], v[56:59]
    ds_read_b64_tr_b16 v[108:109], v172 offset:96
    v_mfma_f32_16x16x32_bf16 v[60:63], v[112:115], v[196:199], v[60:63]
    ds_read_b64_tr_b16 v[110:111], v172 offset:4704
    s_lshr_b32 s56, s65, 10
    s_mul_i32 s53, s64, 9
    s_sub_u32 s56, s56, s53
    s_add_u32 s56, s56, 1
    s_lshl_b32 s56, s56, 6
    v_add_u32 v16, s56, v1
    v_mul_u32_u24 v17, 58255, v16
    v_lshrrev_b32 v17, 20, v17
    v_mul_u32_u24 v18, 18, v17
    v_sub_u32 v18, v16, v18
    s_mul_i32 s53, s31, 288
    v_lshlrev_b32 v18, 4, v18
    v_add_u32 v145, s53, v18
    s_waitcnt lgkmcnt(14)
    v_mfma_f32_16x16x32_bf16 v[64:67], v[116:119], v[192:195], v[64:67]
    ds_read_b64_tr_b16 v[112:113], v172 offset:128
    v_mfma_f32_16x16x32_bf16 v[68:71], v[116:119], v[196:199], v[68:71]
    ds_read_b64_tr_b16 v[114:115], v172 offset:4736
    s_waitcnt lgkmcnt(14)
    v_mfma_f32_16x16x32_bf16 v[72:75], v[120:123], v[192:195], v[72:75]
    ds_read_b64_tr_b16 v[116:117], v172 offset:160
    v_and_b32 v19, 3, v17
    v_bfe_u32 v20, v17, 2, 2
    v_lshl_add_u32 v19, v20, 3, v19
    v_bfe_u32 v20, v17, 4, 1
    v_lshl_add_u32 v19, v20, 2, v19
    s_mul_i32 s53, s64, 96
    v_add_u32 v142, s53, v19
    v_mfma_f32_16x16x32_bf16 v[76:79], v[120:123], v[196:199], v[76:79]
    ds_read_b64_tr_b16 v[118:119], v172 offset:4768
    s_waitcnt lgkmcnt(14)
    v_mfma_f32_16x16x32_bf16 v[80:83], v[124:127], v[192:195], v[80:83]
    ds_read_b64_tr_b16 v[120:121], v172 offset:192
    v_mfma_f32_16x16x32_bf16 v[84:87], v[124:127], v[196:199], v[84:87]
    ds_read_b64_tr_b16 v[122:123], v172 offset:4800
    s_waitcnt lgkmcnt(14)
    v_mfma_f32_16x16x32_bf16 v[88:91], v[128:131], v[192:195], v[88:91]
    ds_read_b64_tr_b16 v[124:125], v172 offset:224
    v_mfma_f32_16x16x32_bf16 v[92:95], v[128:131], v[196:199], v[92:95]
    ds_read_b64_tr_b16 v[126:127], v172 offset:4832
    s_add_u32 s52, s66, 81920
    buffer_load_dwordx4 v[192:195], v182, s[44:47], s52 offen sc1
    buffer_load_dwordx4 v[196:199], v183, s[44:47], s52 offen sc1
    s_cbranch_vccz .Lk1w2_214
    s_waitcnt vmcnt(13)
    s_branch .Lk1we_215
.Lk1w2_214:
    s_waitcnt vmcnt(19)
.Lk1we_215:
    s_cbranch_vccz .Lk1w2_216
    s_waitcnt vmcnt(10)
    s_branch .Lk1we_217
.Lk1w2_216:
    s_waitcnt vmcnt(4)
.Lk1we_217:
    s_barrier
    s_cmp_eq_u32 s32, 0
    s_cbranch_scc0 .Lk1w0_218
    s_lshl_b32 s56, s28, 2
    s_add_u32 s56, s56, s30
    s_lshl_b32 s56, s56, 7
    s_add_u32 s56, s56, 198672
    s_lshl_b32 s57, s31, 2
    s_add_u32 s56, s56, s57
    v_mov_b32 v14, 0x7f000000
    v_mov_b32 v15, 0
    v_cmp_eq_u32 vcc, 0, v1
    s_nop 1
    v_cndmask_b32 v14, v14, v15, vcc
    v_mov_b32 v15, 1
    buffer_store_dword v15, v14, s[44:47], s56 offen sc1
.Lk1w0_218:
    s_cmp_lt_u32 s32, 6
    s_cselect_b64 vcc, -1, 0
    s_waitcnt lgkmcnt(14)
    v_mfma_f32_16x16x32_bf16 v[24:27], v[96:99], v[200:203], v[24:27]
    ds_read_b64_tr_b16 v[128:129], v172 offset:256
    v_mfma_f32_16x16x32_bf16 v[28:31], v[96:99], v[204:207], v[28:31]
    ds_read_b64_tr_b16 v[130:131], v172 offset:4864
    s_cbranch_vccz .Lk1wd_219
    s_add_u32 m0, s65, 73728
    s_add_u32 s52, s61, 221184
    buffer_load_dwordx4 v175, s[36:39], s52 offen lds
.Lk1wd_219:
    s_waitcnt lgkmcnt(14)
    v_mfma_f32_16x16x32_bf16 v[32:35], v[100:103], v[200:203], v[32:35]
    ds_read_b64_tr_b16 v[96:97], v172 offset:18432
    v_mfma_f32_16x16x32_bf16 v[36:39], v[100:103], v[204:207], v[36:39]
    ds_read_b64_tr_b16 v[98:99], v172 offset:23040
    s_cbranch_vccz .Lk1wd_220
    s_add_u32 m0, s65, 74752
    s_add_u32 s52, s61, 221184
    buffer_load_dwordx4 v176, s[36:39], s52 offen lds
.Lk1wd_220:
    s_waitcnt lgkmcnt(14)
    v_mfma_f32_16x16x32_bf16 v[40:43], v[104:107], v[200:203], v[40:43]
    ds_read_b64_tr_b16 v[100:101], v172 offset:18464
    v_mfma_f32_16x16x32_bf16 v[44:47], v[104:107], v[204:207], v[44:47]
    ds_read_b64_tr_b16 v[102:103], v172 offset:23072
    s_waitcnt lgkmcnt(14)
    v_mfma_f32_16x16x32_bf16 v[48:51], v[108:111], v[200:203], v[48:51]
    ds_read_b64_tr_b16 v[104:105], v172 offset:18496
    s_cbranch_vccz .Lk1wd_221
    s_add_u32 m0, s65, 75776
    s_add_u32 s52, s61, 221184
    buffer_load_dwordx4 v177, s[36:39], s52 offen lds
.Lk1wd_221:
    v_mfma_f32_16x16x32_bf16 v[52:55], v[108:111], v[204:207], v[52:55]
    ds_read_b64_tr_b16 v[106:107], v172 offset:23104
    s_waitcnt lgkmcnt(14)
    v_mfma_f32_16x16x32_bf16 v[56:59], v[112:115], v[200:203], v[56:59]
    ds_read_b64_tr_b16 v[108:109], v172 offset:18528
    v_mfma_f32_16x16x32_bf16 v[60:63], v[112:115], v[204:207], v[60:63]
    ds_read_b64_tr_b16 v[110:111], v172 offset:23136
    s_lshr_b32 s56, s65, 10
    s_mul_i32 s53, s64, 9
    s_sub_u32 s56, s56, s53
    s_add_u32 s56, s56, 2
    s_lshl_b32 s56, s56, 6
    v_add_u32 v16, s56, v1
    v_mul_u32_u24 v17, 58255, v16
    v_lshrrev_b32 v17, 20, v17
    v_mul_u32_u24 v18, 18, v17
    v_sub_u32 v18, v16, v18
    s_mul_i32 s53, s31, 288
    v_lshlrev_b32 v18, 4, v18
    v_add_u32 v146, s53, v18
    s_waitcnt lgkmcnt(14)
    v_mfma_f32_16x16x32_bf16 v[64:67], v[116:119], v[200:203], v[64:67]
    ds_read_b64_tr_b16 v[112:113], v172 offset:18560
    v_mfma_f32_16x16x32_bf16 v[68:71], v[116:119], v[204:207], v[68:71]
    ds_read_b64_tr_b16 v[114:115], v172 offset:23168
    s_waitcnt lgkmcnt(14)
    v_mfma_f32_16x16x32_bf16 v[72:75], v[120:123], v[200:203], v[72:75]
    ds_read_b64_tr_b16 v[116:117], v172 offset:18592
    v_and_b32 v19, 3, v17
    v_bfe_u32 v20, v17, 2, 2
    v_lshl_add_u32 v19, v20, 3, v19
    v_bfe_u32 v20, v17, 4, 1
    v_lshl_add_u32 v19, v20, 2, v19
    s_mul_i32 s53, s64, 96
    v_add_u32 v143, s53, v19
    v_mfma_f32_16x16x32_bf16 v[76:79], v[120:123], v[204:207], v[76:79]
    ds_read_b64_tr_b16 v[118:119], v172 offset:23200
    s_waitcnt lgkmcnt(14)
    v_mfma_f32_16x16x32_bf16 v[80:83], v[124:127], v[200:203], v[80:83]
    ds_read_b64_tr_b16 v[120:121], v172 offset:18624
    v_mfma_f32_16x16x32_bf16 v[84:87], v[124:127], v[204:207], v[84:87]
    ds_read_b64_tr_b16 v[122:123], v172 offset:23232
    s_waitcnt lgkmcnt(14)
    v_mfma_f32_16x16x32_bf16 v[88:91], v[128:131], v[200:203], v[88:91]
    ds_read_b64_tr_b16 v[124:125], v172 offset:18656
    v_mfma_f32_16x16x32_bf16 v[92:95], v[128:131], v[204:207], v[92:95]
    ds_read_b64_tr_b16 v[126:127], v172 offset:23264
    s_add_u32 s52, s66, 90112
    buffer_load_dwordx4 v[200:203], v182, s[44:47], s52 offen sc1
    buffer_load_dwordx4 v[204:207], v183, s[44:47], s52 offen sc1
    s_cbranch_vccz .Lk1w2_222
    s_waitcnt vmcnt(12)
    s_branch .Lk1we_223
.Lk1w2_222:
    s_waitcnt vmcnt(19)
.Lk1we_223:
    s_barrier
    s_waitcnt lgkmcnt(14)
    v_mfma_f32_16x16x32_bf16 v[24:27], v[96:99], v[208:211], v[24:27]
    ds_read_b64_tr_b16 v[128:129], v172 offset:18688
    v_mfma_f32_16x16x32_bf16 v[28:31], v[96:99], v[212:215], v[28:31]
    ds_read_b64_tr_b16 v[130:131], v172 offset:23296
    s_cbranch_vccz .Lk1wd_224
    s_add_u32 m0, s65, 92160
    s_add_u32 s52, s61, 258048
    buffer_load_dwordx4 v175, s[36:39], s52 offen lds
.Lk1wd_224:
    s_waitcnt lgkmcnt(14)
    v_mfma_f32_16x16x32_bf16 v[32:35], v[100:103], v[208:211], v[32:35]
    ds_read_b64_tr_b16 v[96:97], v172 offset:36864
    v_mfma_f32_16x16x32_bf16 v[36:39], v[100:103], v[212:215], v[36:39]
    ds_read_b64_tr_b16 v[98:99], v172 offset:41472
    s_cbranch_vccz .Lk1wd_225
    s_add_u32 m0, s65, 93184
    s_add_u32 s52, s61, 258048
    buffer_load_dwordx4 v176, s[36:39], s52 offen lds
.Lk1wd_225:
    s_waitcnt lgkmcnt(14)
    v_mfma_f32_16x16x32_bf16 v[40:43], v[104:107], v[208:211], v[40:43]
    ds_read_b64_tr_b16 v[100:101], v172 offset:36896
    v_mfma_f32_16x16x32_bf16 v[44:47], v[104:107], v[212:215], v[44:47]
    ds_read_b64_tr_b16 v[102:103], v172 offset:41504
    s_waitcnt lgkmcnt(14)
    v_mfma_f32_16x16x32_bf16 v[48:51], v[108:111], v[208:211], v[48:51]
    ds_read_b64_tr_b16 v[104:105], v172 offset:36928
    s_cbranch_vccz .Lk1wd_226
    s_add_u32 m0, s65, 94208
    s_add_u32 s52, s61, 258048
    buffer_load_dwordx4 v177, s[36:39], s52 offen lds
.Lk1wd_226:
    v_mfma_f32_16x16x32_bf16 v[52:55], v[108:111], v[212:215], v[52:55]
    ds_read_b64_tr_b16 v[106:107], v172 offset:41536
    s_waitcnt lgkmcnt(14)
    v_mfma_f32_16x16x32_bf16 v[56:59], v[112:115], v[208:211], v[56:59]
    ds_read_b64_tr_b16 v[108:109], v172 offset:36960
    v_mfma_f32_16x16x32_bf16 v[60:63], v[112:115], v[212:215], v[60:63]
    ds_read_b64_tr_b16 v[110:111], v172 offset:41568
    v_add_u32 v19, 0, v141
    v_mul_u32_u24 v20, 52429, v19
    v_lshrrev_b32 v20, 20, v20
    v_mul_u32_u24 v21, 20, v20
    v_sub_u32 v21, v19, v21
    v_min_u32 v21, 17, v21
    v_mad_u32_u24 v21, v20, 18, v21
    s_mul_i32 s53, s30, 144
    v_add_u32 v21, s53, v21
    v_min_u32 v21, 575, v21
    v_mul_u32_u24 v21, 1152, v21
    v_add_u32 v132, v21, v144
    s_waitcnt lgkmcnt(14)
    v_mfma_f32_16x16x32_bf16 v[64:67], v[116:119], v[208:211], v[64:67]
    ds_read_b64_tr_b16 v[112:113], v172 offset:36992
    v_mfma_f32_16x16x32_bf16 v[68:71], v[116:119], v[212:215], v[68:71]
    ds_read_b64_tr_b16 v[114:115], v172 offset:41600
    s_waitcnt lgkmcnt(14)
    v_mfma_f32_16x16x32_bf16 v[72:75], v[120:123], v[208:211], v[72:75]
    ds_read_b64_tr_b16 v[116:117], v172 offset:37024
    v_add_u32 v19, 0, v142
    v_mul_u32_u24 v20, 52429, v19
    v_lshrrev_b32 v20, 20, v20
    v_mul_u32_u24 v21, 20, v20
    v_sub_u32 v21, v19, v21
    v_min_u32 v21, 17, v21
    v_mad_u32_u24 v21, v20, 18, v21
    s_mul_i32 s53, s30, 144
    v_add_u32 v21, s53, v21
    v_min_u32 v21, 575, v21
    v_mul_u32_u24 v21, 1152, v21
    v_add_u32 v133, v21, v145
    v_mfma_f32_16x16x32_bf16 v[76:79], v[120:123], v[212:215], v[76:79]
    ds_read_b64_tr_b16 v[118:119], v172 offset:41632
    s_waitcnt lgkmcnt(14)
    v_mfma_f32_16x16x32_bf16 v[80:83], v[124:127], v[208:211], v[80:83]
    ds_read_b64_tr_b16 v[120:121], v172 offset:37056
    v_mfma_f32_16x16x32_bf16 v[84:87], v[124:127], v[212:215], v[84:87]
    ds_read_b64_tr_b16 v[122:123], v172 offset:41664
    s_waitcnt lgkmcnt(14)
    v_mfma_f32_16x16x32_bf16 v[88:91], v[128:131], v[208:211], v[88:91]
    ds_read_b64_tr_b16 v[124:125], v172 offset:37088
    v_mfma_f32_16x16x32_bf16 v[92:95], v[128:131], v[212:215], v[92:95]
    ds_read_b64_tr_b16 v[126:127], v172 offset:41696
    s_add_u32 s52, s66, 98304
    buffer_load_dwordx4 v[208:211], v182, s[44:47], s52 offen sc1
    buffer_load_dwordx4 v[212:215], v183, s[44:47], s52 offen sc1
    s_cbranch_vccz .Lk1w2_227
    s_waitcnt vmcnt(12)
    s_branch .Lk1we_228
.Lk1w2_227:
    s_waitcnt vmcnt(19)
.Lk1we_228:
    s_barrier
    s_waitcnt lgkmcnt(14)
    v_mfma_f32_16x16x32_bf16 v[24:27], v[96:99], v[216:219], v[24:27]
    ds_read_b64_tr_b16 v[128:129], v172 offset:37120
    v_mfma_f32_16x16x32_bf16 v[28:31], v[96:99], v[220:223], v[28:31]
    ds_read_b64_tr_b16 v[130:131], v172 offset:41728
    s_cbranch_vccz .Lk1wd_229
    s_add_u32 m0, s65, 110592
    s_add_u32 s52, s61, 294912
    buffer_load_dwordx4 v175, s[36:39], s52 offen lds
.Lk1wd_229:
    s_waitcnt lgkmcnt(14)
    v_mfma_f32_16x16x32_bf16 v[32:35], v[100:103], v[216:219], v[32:35]
    ds_read_b64_tr_b16 v[96:97], v173 offset:0
    v_mfma_f32_16x16x32_bf16 v[36:39], v[100:103], v[220:223], v[36:39]
    ds_read_b64_tr_b16 v[98:99], v173 offset:4608
    s_cbranch_vccz .Lk1wd_230
    s_add_u32 m0, s65, 111616
    s_add_u32 s52, s61, 294912
    buffer_load_dwordx4 v176, s[36:39], s52 offen lds
.Lk1wd_230:
    s_waitcnt lgkmcnt(14)
    v_mfma_f32_16x16x32_bf16 v[40:43], v[104:107], v[216:219], v[40:43]
    ds_read_b64_tr_b16 v[100:101], v173 offset:32
    v_mfma_f32_16x16x32_bf16 v[44:47], v[104:107], v[220:223], v[44:47]
    ds_read_b64_tr_b16 v[102:103], v173 offset:4640
    s_waitcnt lgkmcnt(14)
    v_mfma_f32_16x16x32_bf16 v[48:51], v[108:111], v[216:219], v[48:51]
    ds_read_b64_tr_b16 v[104:105], v173 offset:64
    s_cbranch_vccz .Lk1wd_231
    s_add_u32 m0, s65, 112640
    s_add_u32 s52, s61, 294912
    buffer_load_dwordx4 v177, s[36:39], s52 offen lds
.Lk1wd_231:
    v_mfma_f32_16x16x32_bf16 v[52:55], v[108:111], v[220:223], v[52:55]
    ds_read_b64_tr_b16 v[106:107], v173 offset:4672
    s_waitcnt lgkmcnt(14)
    v_mfma_f32_16x16x32_bf16 v[56:59], v[112:115], v[216:219], v[56:59]
    ds_read_b64_tr_b16 v[108:109], v173 offset:96
    v_mfma_f32_16x16x32_bf16 v[60:63], v[112:115], v[220:223], v[60:63]
    ds_read_b64_tr_b16 v[110:111], v173 offset:4704
    v_add_u32 v19, 0, v143
    v_mul_u32_u24 v20, 52429, v19
    v_lshrrev_b32 v20, 20, v20
    v_mul_u32_u24 v21, 20, v20
    v_sub_u32 v21, v19, v21
    v_min_u32 v21, 17, v21
    v_mad_u32_u24 v21, v20, 18, v21
    s_mul_i32 s53, s30, 144
    v_add_u32 v21, s53, v21
    v_min_u32 v21, 575, v21
    v_mul_u32_u24 v21, 1152, v21
    v_add_u32 v134, v21, v146
    s_waitcnt lgkmcnt(14)
    v_mfma_f32_16x16x32_bf16 v[64:67], v[116:119], v[216:219], v[64:67]
    ds_read_b64_tr_b16 v[112:113], v173 offset:128
    v_mfma_f32_16x16x32_bf16 v[68:71], v[116:119], v[220:223], v[68:71]
    ds_read_b64_tr_b16 v[114:115], v173 offset:4736
    s_waitcnt lgkmcnt(14)
    v_mfma_f32_16x16x32_bf16 v[72:75], v[120:123], v[216:219], v[72:75]
    ds_read_b64_tr_b16 v[116:117], v173 offset:160
    v_add_u32 v19, 32, v141
    v_mul_u32_u24 v20, 52429, v19
    v_lshrrev_b32 v20, 20, v20
    v_mul_u32_u24 v21, 20, v20
    v_sub_u32 v21, v19, v21
    v_min_u32 v21, 17, v21
    v_mad_u32_u24 v21, v20, 18, v21
    s_mul_i32 s53, s30, 144
    v_add_u32 v21, s53, v21
    v_min_u32 v21, 575, v21
    v_mul_u32_u24 v21, 1152, v21
    v_add_u32 v135, v21, v144
    v_mfma_f32_16x16x32_bf16 v[76:79], v[120:123], v[220:223], v[76:79]
    ds_read_b64_tr_b16 v[118:119], v173 offset:4768
    s_waitcnt lgkmcnt(14)
    v_mfma_f32_16x16x32_bf16 v[80:83], v[124:127], v[216:219], v[80:83]
    ds_read_b64_tr_b16 v[120:121], v173 offset:192
    v_mfma_f32_16x16x32_bf16 v[84:87], v[124:127], v[220:223], v[84:87]
    ds_read_b64_tr_b16 v[122:123], v173 offset:4800
    s_waitcnt lgkmcnt(14)
    v_mfma_f32_16x16x32_bf16 v[88:91], v[128:131], v[216:219], v[88:91]
    ds_read_b64_tr_b16 v[124:125], v173 offset:224
    v_mfma_f32_16x16x32_bf16 v[92:95], v[128:131], v[220:223], v[92:95]
    ds_read_b64_tr_b16 v[126:127], v173 offset:4832
    s_add_u32 s52, s66, 106496
    buffer_load_dwordx4 v[216:219], v182, s[44:47], s52 offen sc1
    buffer_load_dwordx4 v[220:223], v183, s[44:47], s52 offen sc1
    s_cbranch_vccz .Lk1w2_232
    s_waitcnt vmcnt(12)
    s_branch .Lk1we_233
.Lk1w2_232:
    s_waitcnt vmcnt(19)
.Lk1we_233:
    s_barrier
    s_waitcnt lgkmcnt(14)
    v_mfma_f32_16x16x32_bf16 v[24:27], v[96:99], v[224:227], v[24:27]
    ds_read_b64_tr_b16 v[128:129], v173 offset:256
    v_mfma_f32_16x16x32_bf16 v[28:31], v[96:99], v[228:231], v[28:31]
    ds_read_b64_tr_b16 v[130:131], v173 offset:4864
    s_cbranch_vccz .Lk1wd_234
    s_add_u32 m0, s65, 129024
    s_add_u32 s52, s61, 331776
    buffer_load_dwordx4 v175, s[36:39], s52 offen lds
.Lk1wd_234:
    s_waitcnt lgkmcnt(14)
    v_mfma_f32_16x16x32_bf16 v[32:35], v[100:103], v[224:227], v[32:35]
    ds_read_b64_tr_b16 v[96:97], v173 offset:18432
    v_mfma_f32_16x16x32_bf16 v[36:39], v[100:103], v[228:231], v[36:39]
    ds_read_b64_tr_b16 v[98:99], v173 offset:23040
    s_waitcnt lgkmcnt(14)
    v_mfma_f32_16x16x32_bf16 v[40:43], v[104:107], v[224:227], v[40:43]
    ds_read_b64_tr_b16 v[100:101], v173 offset:18464
    s_cbranch_vccz .Lk1wd_235
    s_add_u32 m0, s65, 130048
    s_add_u32 s52, s61, 331776
    buffer_load_dwordx4 v176, s[36:39], s52 offen lds
.Lk1wd_235:
    v_mfma_f32_16x16x32_bf16 v[44:47], v[104:107], v[228:231], v[44:47]
    ds_read_b64_tr_b16 v[102:103], v173 offset:23072
    s_waitcnt lgkmcnt(14)
    v_mfma_f32_16x16x32_bf16 v[48:51], v[108:111], v[224:227], v[48:51]
    ds_read_b64_tr_b16 v[104:105], v173 offset:18496
    v_mfma_f32_16x16x32_bf16 v[52:55], v[108:111], v[228:231], v[52:55]
    ds_read_b64_tr_b16 v[106:107], v173 offset:23104
    s_waitcnt lgkmcnt(14)
    v_mfma_f32_16x16x32_bf16 v[56:59], v[112:115], v[224:227], v[56:59]
    ds_read_b64_tr_b16 v[108:109], v173 offset:18528
    s_cbranch_vccz .Lk1wd_236
    s_add_u32 m0, s65, 131072
    s_add_u32 s52, s61, 331776
    buffer_load_dwordx4 v177, s[36:39], s52 offen lds
.Lk1wd_236:
    v_mfma_f32_16x16x32_bf16 v[60:63], v[112:115], v[228:231], v[60:63]
    ds_read_b64_tr_b16 v[110:111], v173 offset:23136
    s_waitcnt lgkmcnt(14)
    v_mfma_f32_16x16x32_bf16 v[64:67], v[116:119], v[224:227], v[64:67]
    ds_read_b64_tr_b16 v[112:113], v173 offset:18560
    v_mfma_f32_16x16x32_bf16 v[68:71], v[116:119], v[228:231], v[68:71]
    ds_read_b64_tr_b16 v[114:115], v173 offset:23168
    v_add_u32 v19, 32, v142
    v_mul_u32_u24 v20, 52429, v19
    v_lshrrev_b32 v20, 20, v20
    v_mul_u32_u24 v21, 20, v20
    v_sub_u32 v21, v19, v21
    v_min_u32 v21, 17, v21
    v_mad_u32_u24 v21, v20, 18, v21
    s_mul_i32 s53, s30, 144
    v_add_u32 v21, s53, v21
    v_min_u32 v21, 575, v21
    v_mul_u32_u24 v21, 1152, v21
    v_add_u32 v136, v21, v145
    s_waitcnt lgkmcnt(14)
    v_mfma_f32_16x16x32_bf16 v[72:75], v[120:123], v[224:227], v[72:75]
    ds_read_b64_tr_b16 v[116:117], v173 offset:18592
    v_mfma_f32_16x16x32_bf16 v[76:79], v[120:123], v[228:231], v[76:79]
    ds_read_b64_tr_b16 v[118:119], v173 offset:23200
    s_waitcnt lgkmcnt(14)
    v_mfma_f32_16x16x32_bf16 v[80:83], v[124:127], v[224:227], v[80:83]
    ds_read_b64_tr_b16 v[120:121], v173 offset:18624
    v_mfma_f32_16x16x32_bf16 v[84:87], v[124:127], v[228:231], v[84:87]
    ds_read_b64_tr_b16 v[122:123], v173 offset:23232
    s_waitcnt lgkmcnt(14)
    v_mfma_f32_16x16x32_bf16 v[88:91], v[128:131], v[224:227], v[88:91]
    ds_read_b64_tr_b16 v[124:125], v173 offset:18656
    v_mfma_f32_16x16x32_bf16 v[92:95], v[128:131], v[228:231], v[92:95]
    ds_read_b64_tr_b16 v[126:127], v173 offset:23264
    s_add_u32 s52, s66, 114688
    buffer_load_dwordx4 v[224:227], v182, s[44:47], s52 offen sc1
    buffer_load_dwordx4 v[228:231], v183, s[44:47], s52 offen sc1
    s_cbranch_vccz .Lk1w2_237
    s_waitcnt vmcnt(12)
    s_branch .Lk1we_238
.Lk1w2_237:
    s_waitcnt vmcnt(19)
.Lk1we_238:
    s_barrier
    s_waitcnt lgkmcnt(14)
    v_mfma_f32_16x16x32_bf16 v[24:27], v[96:99], v[232:235], v[24:27]
    ds_read_b64_tr_b16 v[128:129], v173 offset:18688
    v_mfma_f32_16x16x32_bf16 v[28:31], v[96:99], v[236:239], v[28:31]
    ds_read_b64_tr_b16 v[130:131], v173 offset:23296
    s_cbranch_vccz .Lk1wd_239
    s_add_u32 m0, s65, 0
    s_add_u32 s52, s61, 368640
    buffer_load_dwordx4 v175, s[36:39], s52 offen lds
.Lk1wd_239:
    s_waitcnt lgkmcnt(14)
    v_mfma_f32_16x16x32_bf16 v[32:35], v[100:103], v[232:235], v[32:35]
    ds_read_b64_tr_b16 v[96:97], v173 offset:36864
    v_mfma_f32_16x16x32_bf16 v[36:39], v[100:103], v[236:239], v[36:39]
    ds_read_b64_tr_b16 v[98:99], v173 offset:41472
    s_waitcnt lgkmcnt(14)
    v_mfma_f32_16x16x32_bf16 v[40:43], v[104:107], v[232:235], v[40:43]
    ds_read_b64_tr_b16 v[100:101], v173 offset:36896
    s_cbranch_vccz .Lk1wd_240
    s_add_u32 m0, s65, 1024
    s_add_u32 s52, s61, 368640
    buffer_load_dwordx4 v176, s[36:39], s52 offen lds
.Lk1wd_240:
    v_mfma_f32_16x16x32_bf16 v[44:47], v[104:107], v[236:239], v[44:47]
    ds_read_b64_tr_b16 v[102:103], v173 offset:41504
    s_waitcnt lgkmcnt(14)
    v_mfma_f32_16x16x32_bf16 v[48:51], v[108:111], v[232:235], v[48:51]
    ds_read_b64_tr_b16 v[104:105], v173 offset:36928
    v_mfma_f32_16x16x32_bf16 v[52:55], v[108:111], v[236:239], v[52:55]
    ds_read_b64_tr_b16 v[106:107], v173 offset:41536
    s_waitcnt lgkmcnt(14)
    v_mfma_f32_16x16x32_bf16 v[56:59], v[112:115], v[232:235], v[56:59]
    ds_read_b64_tr_b16 v[108:109], v173 offset:36960
    s_cbranch_vccz .Lk1wd_241
    s_add_u32 m0, s65, 2048
    s_add_u32 s52, s61, 368640
    buffer_load_dwordx4 v177, s[36:39], s52 offen lds
.Lk1wd_241:
    v_mfma_f32_16x16x32_bf16 v[60:63], v[112:115], v[236:239], v[60:63]
    ds_read_b64_tr_b16 v[110:111], v173 offset:41568
    s_waitcnt lgkmcnt(14)
    v_mfma_f32_16x16x32_bf16 v[64:67], v[116:119], v[232:235], v[64:67]
    ds_read_b64_tr_b16 v[112:113], v173 offset:36992
    v_mfma_f32_16x16x32_bf16 v[68:71], v[116:119], v[236:239], v[68:71]
    ds_read_b64_tr_b16 v[114:115], v173 offset:41600
    v_add_u32 v19, 32, v143
    v_mul_u32_u24 v20, 52429, v19
    v_lshrrev_b32 v20, 20, v20
    v_mul_u32_u24 v21, 20, v20
    v_sub_u32 v21, v19, v21
    v_min_u32 v21, 17, v21
    v_mad_u32_u24 v21, v20, 18, v21
    s_mul_i32 s53, s30, 144
    v_add_u32 v21, s53, v21
    v_min_u32 v21, 575, v21
    v_mul_u32_u24 v21, 1152, v21
    v_add_u32 v137, v21, v146
    s_waitcnt lgkmcnt(14)
    v_mfma_f32_16x16x32_bf16 v[72:75], v[120:123], v[232:235], v[72:75]
    ds_read_b64_tr_b16 v[116:117], v173 offset:37024
    v_mfma_f32_16x16x32_bf16 v[76:79], v[120:123], v[236:239], v[76:79]
    ds_read_b64_tr_b16 v[118:119], v173 offset:41632
    s_waitcnt lgkmcnt(14)
    v_mfma_f32_16x16x32_bf16 v[80:83], v[124:127], v[232:235], v[80:83]
    ds_read_b64_tr_b16 v[120:121], v173 offset:37056
    v_mfma_f32_16x16x32_bf16 v[84:87], v[124:127], v[236:239], v[84:87]
    ds_read_b64_tr_b16 v[122:123], v173 offset:41664
    s_waitcnt lgkmcnt(14)
    v_mfma_f32_16x16x32_bf16 v[88:91], v[128:131], v[232:235], v[88:91]
    ds_read_b64_tr_b16 v[124:125], v173 offset:37088
    v_mfma_f32_16x16x32_bf16 v[92:95], v[128:131], v[236:239], v[92:95]
    ds_read_b64_tr_b16 v[126:127], v173 offset:41696
    s_add_u32 s52, s66, 122880
    buffer_load_dwordx4 v[232:235], v182, s[44:47], s52 offen sc1
    buffer_load_dwordx4 v[236:239], v183, s[44:47], s52 offen sc1
    s_cbranch_vccz .Lk1w2_242
    s_waitcnt vmcnt(12)
    s_branch .Lk1we_243
.Lk1w2_242:
    s_waitcnt vmcnt(19)
.Lk1we_243:
    s_barrier
    s_waitcnt lgkmcnt(14)
    v_mfma_f32_16x16x32_bf16 v[24:27], v[96:99], v[240:243], v[24:27]
    ds_read_b64_tr_b16 v[128:129], v173 offset:37120
    v_mfma_f32_16x16x32_bf16 v[28:31], v[96:99], v[244:247], v[28:31]
    ds_read_b64_tr_b16 v[130:131], v173 offset:41728
    s_cbranch_vccz .Lk1wd_244
    s_add_u32 m0, s65, 18432
    s_add_u32 s52, s61, 405504
    buffer_load_dwordx4 v175, s[36:39], s52 offen lds
.Lk1wd_244:
    s_waitcnt lgkmcnt(14)
    v_mfma_f32_16x16x32_bf16 v[32:35], v[100:103], v[240:243], v[32:35]
    ds_read_b64_tr_b16 v[96:97], v174 offset:0
    v_mfma_f32_16x16x32_bf16 v[36:39], v[100:103], v[244:247], v[36:39]
    ds_read_b64_tr_b16 v[98:99], v174 offset:4608
    s_waitcnt lgkmcnt(14)
    v_mfma_f32_16x16x32_bf16 v[40:43], v[104:107], v[240:243], v[40:43]
    ds_read_b64_tr_b16 v[100:101], v174 offset:32
    s_cbranch_vccz .Lk1wd_245
    s_add_u32 m0, s65, 19456
    s_add_u32 s52, s61, 405504
    buffer_load_dwordx4 v176, s[36:39], s52 offen lds
.Lk1wd_245:
    v_mfma_f32_16x16x32_bf16 v[44:47], v[104:107], v[244:247], v[44:47]
    ds_read_b64_tr_b16 v[102:103], v174 offset:4640
    s_waitcnt lgkmcnt(14)
    v_mfma_f32_16x16x32_bf16 v[48:51], v[108:111], v[240:243], v[48:51]
    ds_read_b64_tr_b16 v[104:105], v174 offset:64
    v_mfma_f32_16x16x32_bf16 v[52:55], v[108:111], v[244:247], v[52:55]
    ds_read_b64_tr_b16 v[106:107], v174 offset:4672
    s_waitcnt lgkmcnt(14)
    v_mfma_f32_16x16x32_bf16 v[56:59], v[112:115], v[240:243], v[56:59]
    ds_read_b64_tr_b16 v[108:109], v174 offset:96
    s_cbranch_vccz .Lk1wd_246
    s_add_u32 m0, s65, 20480
    s_add_u32 s52, s61, 405504
    buffer_load_dwordx4 v177, s[36:39], s52 offen lds
.Lk1wd_246:
    v_mfma_f32_16x16x32_bf16 v[60:63], v[112:115], v[244:247], v[60:63]
    ds_read_b64_tr_b16 v[110:111], v174 offset:4704
    s_waitcnt lgkmcnt(14)
    v_mfma_f32_16x16x32_bf16 v[64:67], v[116:119], v[240:243], v[64:67]
    ds_read_b64_tr_b16 v[112:113], v174 offset:128
    v_mfma_f32_16x16x32_bf16 v[68:71], v[116:119], v[244:247], v[68:71]
    ds_read_b64_tr_b16 v[114:115], v174 offset:4736
    v_add_u32 v19, 64, v141
    v_mul_u32_u24 v20, 52429, v19
    v_lshrrev_b32 v20, 20, v20
    v_mul_u32_u24 v21, 20, v20
    v_sub_u32 v21, v19, v21
    v_min_u32 v21, 17, v21
    v_mad_u32_u24 v21, v20, 18, v21
    s_mul_i32 s53, s30, 144
    v_add_u32 v21, s53, v21
    v_min_u32 v21, 575, v21
    v_mul_u32_u24 v21, 1152, v21
    v_add_u32 v138, v21, v144
    s_waitcnt lgkmcnt(14)
    v_mfma_f32_16x16x32_bf16 v[72:75], v[120:123], v[240:243], v[72:75]
    ds_read_b64_tr_b16 v[116:117], v174 offset:160
    v_mfma_f32_16x16x32_bf16 v[76:79], v[120:123], v[244:247], v[76:79]
    ds_read_b64_tr_b16 v[118:119], v174 offset:4768
    s_waitcnt lgkmcnt(14)
    v_mfma_f32_16x16x32_bf16 v[80:83], v[124:127], v[240:243], v[80:83]
    ds_read_b64_tr_b16 v[120:121], v174 offset:192
    v_mfma_f32_16x16x32_bf16 v[84:87], v[124:127], v[244:247], v[84:87]
    ds_read_b64_tr_b16 v[122:123], v174 offset:4800
    s_waitcnt lgkmcnt(14)
    v_mfma_f32_16x16x32_bf16 v[88:91], v[128:131], v[240:243], v[88:91]
    ds_read_b64_tr_b16 v[124:125], v174 offset:224
    v_mfma_f32_16x16x32_bf16 v[92:95], v[128:131], v[244:247], v[92:95]
    ds_read_b64_tr_b16 v[126:127], v174 offset:4832
    s_add_u32 s52, s66, 131072
    buffer_load_dwordx4 v[240:243], v182, s[44:47], s52 offen sc1
    buffer_load_dwordx4 v[244:247], v183, s[44:47], s52 offen sc1
    s_lshl_b32 s56, s28, 2
    s_add_u32 s56, s56, s30
    s_lshl_b32 s56, s56, 7
    s_add_u32 s56, s56, 198672
    v_mov_b32 v14, 0
    buffer_load_dwordx4 v[168:171], v14, s[44:47], s56 offen sc1
    s_cbranch_vccz .Lk1w2_247
    s_waitcnt vmcnt(13)
    s_branch .Lk1we_248
.Lk1w2_247:
    s_waitcnt vmcnt(20)
.Lk1we_248:
    s_barrier
    s_waitcnt lgkmcnt(14)
    v_mfma_f32_16x16x32_bf16 v[24:27], v[96:99], v[248:251], v[24:27]
    ds_read_b64_tr_b16 v[128:129], v174 offset:256
    v_mfma_f32_16x16x32_bf16 v[28:31], v[96:99], v[252:255], v[28:31]
    ds_read_b64_tr_b16 v[130:131], v174 offset:4864
    s_cbranch_vccz .Lk1wd_249
    s_add_u32 m0, s65, 36864
    s_add_u32 s52, s61, 442368
    buffer_load_dwordx4 v175, s[36:39], s52 offen lds
.Lk1wd_249:
    s_waitcnt lgkmcnt(14)
    v_mfma_f32_16x16x32_bf16 v[32:35], v[100:103], v[248:251], v[32:35]
    ds_read_b64_tr_b16 v[96:97], v174 offset:18432
    v_mfma_f32_16x16x32_bf16 v[36:39], v[100:103], v[252:255], v[36:39]
    ds_read_b64_tr_b16 v[98:99], v174 offset:23040
    s_waitcnt lgkmcnt(14)
    v_mfma_f32_16x16x32_bf16 v[40:43], v[104:107], v[248:251], v[40:43]
    ds_read_b64_tr_b16 v[100:101], v174 offset:18464
    s_cbranch_vccz .Lk1wd_250
    s_add_u32 m0, s65, 37888
    s_add_u32 s52, s61, 442368
    buffer_load_dwordx4 v176, s[36:39], s52 offen lds
.Lk1wd_250:
    v_mfma_f32_16x16x32_bf16 v[44:47], v[104:107], v[252:255], v[44:47]
    ds_read_b64_tr_b16 v[102:103], v174 offset:23072
    s_waitcnt lgkmcnt(14)
    v_mfma_f32_16x16x32_bf16 v[48:51], v[108:111], v[248:251], v[48:51]
    ds_read_b64_tr_b16 v[104:105], v174 offset:18496
    v_mfma_f32_16x16x32_bf16 v[52:55], v[108:111], v[252:255], v[52:55]
    ds_read_b64_tr_b16 v[106:107], v174 offset:23104
    s_waitcnt lgkmcnt(14)
    v_mfma_f32_16x16x32_bf16 v[56:59], v[112:115], v[248:251], v[56:59]
    ds_read_b64_tr_b16 v[108:109], v174 offset:18528
    s_cbranch_vccz .Lk1wd_251
    s_add_u32 m0, s65, 38912
    s_add_u32 s52, s61, 442368
    buffer_load_dwordx4 v177, s[36:39], s52 offen lds
.Lk1wd_251:
    v_mfma_f32_16x16x32_bf16 v[60:63], v[112:115], v[252:255], v[60:63]
    ds_read_b64_tr_b16 v[110:111], v174 offset:23136
    s_waitcnt lgkmcnt(14)
    v_mfma_f32_16x16x32_bf16 v[64:67], v[116:119], v[248:251], v[64:67]
    ds_read_b64_tr_b16 v[112:113], v174 offset:18560
    v_mfma_f32_16x16x32_bf16 v[68:71], v[116:119], v[252:255], v[68:71]
    ds_read_b64_tr_b16 v[114:115], v174 offset:23168
    v_add_u32 v19, 64, v142
    v_mul_u32_u24 v20, 52429, v19
    v_lshrrev_b32 v20, 20, v20
    v_mul_u32_u24 v21, 20, v20
    v_sub_u32 v21, v19, v21
    v_min_u32 v21, 17, v21
    v_mad_u32_u24 v21, v20, 18, v21
    s_mul_i32 s53, s30, 144
    v_add_u32 v21, s53, v21
    v_min_u32 v21, 575, v21
    v_mul_u32_u24 v21, 1152, v21
    v_add_u32 v139, v21, v145
    s_waitcnt lgkmcnt(14)
    v_mfma_f32_16x16x32_bf16 v[72:75], v[120:123], v[248:251], v[72:75]
    ds_read_b64_tr_b16 v[116:117], v174 offset:18592
    v_mfma_f32_16x16x32_bf16 v[76:79], v[120:123], v[252:255], v[76:79]
    ds_read_b64_tr_b16 v[118:119], v174 offset:23200
    s_waitcnt lgkmcnt(14)
    v_mfma_f32_16x16x32_bf16 v[80:83], v[124:127], v[248:251], v[80:83]
    ds_read_b64_tr_b16 v[120:121], v174 offset:18624
    v_mfma_f32_16x16x32_bf16 v[84:87], v[124:127], v[252:255], v[84:87]
    ds_read_b64_tr_b16 v[122:123], v174 offset:23232
    s_waitcnt lgkmcnt(14)
    v_mfma_f32_16x16x32_bf16 v[88:91], v[128:131], v[248:251], v[88:91]
    ds_read_b64_tr_b16 v[124:125], v174 offset:18656
    v_mfma_f32_16x16x32_bf16 v[92:95], v[128:131], v[252:255], v[92:95]
    ds_read_b64_tr_b16 v[126:127], v174 offset:23264
    s_add_u32 s52, s66, 139264
    buffer_load_dwordx4 v[248:251], v182, s[44:47], s52 offen sc1
    buffer_load_dwordx4 v[252:255], v183, s[44:47], s52 offen sc1
    s_cbranch_vccz .Lk1w2_252
    s_waitcnt vmcnt(13)
    s_branch .Lk1we_253
.Lk1w2_252:
    s_waitcnt vmcnt(17)
.Lk1we_253:
    s_cbranch_vccz .Lk1w2_254
    s_waitcnt vmcnt(5)
    s_branch .Lk1we_255
.Lk1w2_254:
    s_waitcnt vmcnt(2)
.Lk1we_255:
    v_min_u32 v168, v168, v169
    v_min_u32 v170, v170, v171
    v_min_u32 v168, v168, v170
    s_nop 0
    v_readfirstlane_b32 s56, v168
    s_nop 1
    s_cmp_lg_u32 s56, 0
    s_cbranch_scc1 .Lk1f3ok_256
    s_mov_b32 s94, 0x20000
.Lk1f3p_257:
    s_lshl_b32 s56, s28, 2
    s_add_u32 s56, s56, s30
    s_lshl_b32 s56, s56, 7
    s_add_u32 s56, s56, 198672
    v_mov_b32 v14, 0
    buffer_load_dwordx4 v[168:171], v14, s[44:47], s56 offen sc1
    s_waitcnt vmcnt(0)
    v_min_u32 v168, v168, v169
    v_min_u32 v170, v170, v171
    v_min_u32 v168, v168, v170
    s_nop 0
    v_readfirstlane_b32 s56, v168
    s_nop 1
    s_cmp_lg_u32 s56, 0
    s_cbranch_scc1 .Lk1f3pd_258
    s_sub_u32 s94, s94, 1
    s_cmp_eq_u32 s94, 0
    s_cbranch_scc1 .Lk1f3pd_258
    s_sleep 1
    s_branch .Lk1f3p_257
.Lk1f3pd_258:
.Lk1f3ok_256:
    s_barrier
    s_waitcnt lgkmcnt(14)
    v_mfma_f32_16x16x32_bf16 v[24:27], v[96:99], v[184:187], v[24:27]
    ds_read_b64_tr_b16 v[128:129], v174 offset:18688
    v_mfma_f32_16x16x32_bf16 v[28:31], v[96:99], v[188:191], v[28:31]
    ds_read_b64_tr_b16 v[130:131], v174 offset:23296
    s_cbranch_vccz .Lk1wd_259
    s_add_u32 m0, s65, 55296
    s_add_u32 s52, s61, 479232
    buffer_load_dwordx4 v175, s[36:39], s52 offen lds
.Lk1wd_259:
    s_waitcnt lgkmcnt(14)
    v_mfma_f32_16x16x32_bf16 v[32:35], v[100:103], v[184:187], v[32:35]
    ds_read_b64_tr_b16 v[96:97], v172 offset:0
    v_mfma_f32_16x16x32_bf16 v[36:39], v[100:103], v[188:191], v[36:39]
    ds_read_b64_tr_b16 v[98:99], v172 offset:4608
    s_waitcnt lgkmcnt(14)
    v_mfma_f32_16x16x32_bf16 v[40:43], v[104:107], v[184:187], v[40:43]
    ds_read_b64_tr_b16 v[100:101], v172 offset:32
    s_cbranch_vccz .Lk1wd_260
    s_add_u32 m0, s65, 56320
    s_add_u32 s52, s61, 479232
    buffer_load_dwordx4 v176, s[36:39], s52 offen lds
.Lk1wd_260:
    v_mfma_f32_16x16x32_bf16 v[44:47], v[104:107], v[188:191], v[44:47]
    ds_read_b64_tr_b16 v[102:103], v172 offset:4640
    s_waitcnt lgkmcnt(14)
    v_mfma_f32_16x16x32_bf16 v[48:51], v[108:111], v[184:187], v[48:51]
    ds_read_b64_tr_b16 v[104:105], v172 offset:64
    v_mfma_f32_16x16x32_bf16 v[52:55], v[108:111], v[188:191], v[52:55]
    ds_read_b64_tr_b16 v[106:107], v172 offset:4672
    s_waitcnt lgkmcnt(14)
    v_mfma_f32_16x16x32_bf16 v[56:59], v[112:115], v[184:187], v[56:59]
    ds_read_b64_tr_b16 v[108:109], v172 offset:96
    s_cbranch_vccz .Lk1wd_261
    s_add_u32 m0, s65, 57344
    s_add_u32 s52, s61, 479232
    buffer_load_dwordx4 v177, s[36:39], s52 offen lds
.Lk1wd_261:
    v_mfma_f32_16x16x32_bf16 v[60:63], v[112:115], v[188:191], v[60:63]
    ds_read_b64_tr_b16 v[110:111], v172 offset:4704
    s_waitcnt lgkmcnt(14)
    v_mfma_f32_16x16x32_bf16 v[64:67], v[116:119], v[184:187], v[64:67]
    ds_read_b64_tr_b16 v[112:113], v172 offset:128
    v_mfma_f32_16x16x32_bf16 v[68:71], v[116:119], v[188:191], v[68:71]
    ds_read_b64_tr_b16 v[114:115], v172 offset:4736
    v_add_u32 v19, 64, v143
    v_mul_u32_u24 v20, 52429, v19
    v_lshrrev_b32 v20, 20, v20
    v_mul_u32_u24 v21, 20, v20
    v_sub_u32 v21, v19, v21
    v_min_u32 v21, 17, v21
    v_mad_u32_u24 v21, v20, 18, v21
    s_mul_i32 s53, s30, 144
    v_add_u32 v21, s53, v21
    v_min_u32 v21, 575, v21
    v_mul_u32_u24 v21, 1152, v21
    v_add_u32 v140, v21, v146
    s_waitcnt lgkmcnt(14)
    v_mfma_f32_16x16x32_bf16 v[72:75], v[120:123], v[184:187], v[72:75]
    ds_read_b64_tr_b16 v[116:117], v172 offset:160
    v_mfma_f32_16x16x32_bf16 v[76:79], v[120:123], v[188:191], v[76:79]
    ds_read_b64_tr_b16 v[118:119], v172 offset:4768
    s_waitcnt lgkmcnt(14)
    v_mfma_f32_16x16x32_bf16 v[80:83], v[124:127], v[184:187], v[80:83]
    ds_read_b64_tr_b16 v[120:121], v172 offset:192
    v_mfma_f32_16x16x32_bf16 v[84:87], v[124:127], v[188:191], v[84:87]
    ds_read_b64_tr_b16 v[122:123], v172 offset:4800
    s_waitcnt lgkmcnt(14)
    v_mfma_f32_16x16x32_bf16 v[88:91], v[128:131], v[184:187], v[88:91]
    ds_read_b64_tr_b16 v[124:125], v172 offset:224
    v_mfma_f32_16x16x32_bf16 v[92:95], v[128:131], v[188:191], v[92:95]
    ds_read_b64_tr_b16 v[126:127], v172 offset:4832
    s_lshl_b32 s52, s28, 2
    s_add_u32 s52, s52, s30
    s_mul_i32 s52, s52, 40960
    s_lshl_b32 s53, s33, 11
    s_add_u32 s52, s52, s53
    s_mul_i32 s53, s34, 24576
    s_add_u32 s52, s52, s53
    s_add_u32 s52, s52, 4194304
    buffer_load_dwordx4 v[184:187], v182, s[44:47], s52 offen sc1
    buffer_load_dwordx4 v[188:191], v183, s[44:47], s52 offen sc1
    s_cbranch_vccz .Lk1w2_262
    s_waitcnt vmcnt(13)
    s_branch .Lk1we_263
.Lk1w2_262:
    s_waitcnt vmcnt(17)
.Lk1we_263:
    s_barrier
    s_waitcnt lgkmcnt(14)
    v_mfma_f32_16x16x32_bf16 v[24:27], v[96:99], v[192:195], v[24:27]
    ds_read_b64_tr_b16 v[128:129], v172 offset:256
    v_mfma_f32_16x16x32_bf16 v[28:31], v[96:99], v[196:199], v[28:31]
    ds_read_b64_tr_b16 v[130:131], v172 offset:4864
    s_cbranch_vccz .Lk1wd_264
    s_add_u32 m0, s65, 73728
    s_add_u32 s52, s61, 516096
    buffer_load_dwordx4 v175, s[36:39], s52 offen lds
.Lk1wd_264:
    s_waitcnt lgkmcnt(14)
    v_mfma_f32_16x16x32_bf16 v[32:35], v[100:103], v[192:195], v[32:35]
    ds_read_b64_tr_b16 v[96:97], v172 offset:18432
    v_mfma_f32_16x16x32_bf16 v[36:39], v[100:103], v[196:199], v[36:39]
    ds_read_b64_tr_b16 v[98:99], v172 offset:23040
    s_waitcnt lgkmcnt(14)
    v_mfma_f32_16x16x32_bf16 v[40:43], v[104:107], v[192:195], v[40:43]
    ds_read_b64_tr_b16 v[100:101], v172 offset:18464
    v_mfma_f32_16x16x32_bf16 v[44:47], v[104:107], v[196:199], v[44:47]
    ds_read_b64_tr_b16 v[102:103], v172 offset:23072
    s_cbranch_vccz .Lk1wd_265
    s_add_u32 m0, s65, 74752
    s_add_u32 s52, s61, 516096
    buffer_load_dwordx4 v176, s[36:39], s52 offen lds
.Lk1wd_265:
    s_waitcnt lgkmcnt(14)
    v_mfma_f32_16x16x32_bf16 v[48:51], v[108:111], v[192:195], v[48:51]
    ds_read_b64_tr_b16 v[104:105], v172 offset:18496
    v_mfma_f32_16x16x32_bf16 v[52:55], v[108:111], v[196:199], v[52:55]
    ds_read_b64_tr_b16 v[106:107], v172 offset:23104
    s_waitcnt lgkmcnt(14)
    v_mfma_f32_16x16x32_bf16 v[56:59], v[112:115], v[192:195], v[56:59]
    ds_read_b64_tr_b16 v[108:109], v172 offset:18528
    v_mfma_f32_16x16x32_bf16 v[60:63], v[112:115], v[196:199], v[60:63]
    ds_read_b64_tr_b16 v[110:111], v172 offset:23136
    s_waitcnt lgkmcnt(14)
    v_mfma_f32_16x16x32_bf16 v[64:67], v[116:119], v[192:195], v[64:67]
    ds_read_b64_tr_b16 v[112:113], v172 offset:18560
    s_cbranch_vccz .Lk1wd_266
    s_add_u32 m0, s65, 75776
    s_add_u32 s52, s61, 516096
    buffer_load_dwordx4 v177, s[36:39], s52 offen lds
.Lk1wd_266:
    v_mfma_f32_16x16x32_bf16 v[68:71], v[116:119], v[196:199], v[68:71]
    ds_read_b64_tr_b16 v[114:115], v172 offset:23168
    s_waitcnt lgkmcnt(14)
    v_mfma_f32_16x16x32_bf16 v[72:75], v[120:123], v[192:195], v[72:75]
    ds_read_b64_tr_b16 v[116:117], v172 offset:18592
    v_mfma_f32_16x16x32_bf16 v[76:79], v[120:123], v[196:199], v[76:79]
    ds_read_b64_tr_b16 v[118:119], v172 offset:23200
    s_waitcnt lgkmcnt(14)
    v_mfma_f32_16x16x32_bf16 v[80:83], v[124:127], v[192:195], v[80:83]
    ds_read_b64_tr_b16 v[120:121], v172 offset:18624
    v_mfma_f32_16x16x32_bf16 v[84:87], v[124:127], v[196:199], v[84:87]
    ds_read_b64_tr_b16 v[122:123], v172 offset:23232
    s_waitcnt lgkmcnt(14)
    v_mfma_f32_16x16x32_bf16 v[88:91], v[128:131], v[192:195], v[88:91]
    ds_read_b64_tr_b16 v[124:125], v172 offset:18656
    v_mfma_f32_16x16x32_bf16 v[92:95], v[128:131], v[196:199], v[92:95]
    ds_read_b64_tr_b16 v[126:127], v172 offset:23264
    s_lshl_b32 s52, s28, 2
    s_add_u32 s52, s52, s30
    s_mul_i32 s52, s52, 40960
    s_lshl_b32 s53, s33, 11
    s_add_u32 s52, s52, s53
    s_mul_i32 s53, s34, 24576
    s_add_u32 s52, s52, s53
    s_add_u32 s52, s52, 4202496
    buffer_load_dwordx4 v[192:195], v182, s[44:47], s52 offen sc1
    buffer_load_dwordx4 v[196:199], v183, s[44:47], s52 offen sc1
    s_cbranch_vccz .Lk1w2_267
    s_waitcnt vmcnt(12)
    s_branch .Lk1we_268
.Lk1w2_267:
    s_waitcnt vmcnt(17)
.Lk1we_268:
    s_barrier
    s_waitcnt lgkmcnt(14)
    v_mfma_f32_16x16x32_bf16 v[24:27], v[96:99], v[200:203], v[24:27]
    ds_read_b64_tr_b16 v[128:129], v172 offset:18688
    v_mfma_f32_16x16x32_bf16 v[28:31], v[96:99], v[204:207], v[28:31]
    ds_read_b64_tr_b16 v[130:131], v172 offset:23296
    s_cbranch_vccz .Lk1wd_269
    s_add_u32 m0, s65, 92160
    s_add_u32 s52, s61, 552960
    buffer_load_dwordx4 v175, s[36:39], s52 offen lds
.Lk1wd_269:
    s_waitcnt lgkmcnt(14)
    v_mfma_f32_16x16x32_bf16 v[32:35], v[100:103], v[200:203], v[32:35]
    ds_read_b64_tr_b16 v[96:97], v172 offset:36864
    v_mfma_f32_16x16x32_bf16 v[36:39], v[100:103], v[204:207], v[36:39]
    ds_read_b64_tr_b16 v[98:99], v172 offset:41472
    s_waitcnt lgkmcnt(14)
    v_mfma_f32_16x16x32_bf16 v[40:43], v[104:107], v[200:203], v[40:43]
    ds_read_b64_tr_b16 v[100:101], v172 offset:36896
    v_mfma_f32_16x16x32_bf16 v[44:47], v[104:107], v[204:207], v[44:47]
    ds_read_b64_tr_b16 v[102:103], v172 offset:41504
    s_cbranch_vccz .Lk1wd_270
    s_add_u32 m0, s65, 93184
    s_add_u32 s52, s61, 552960
    buffer_load_dwordx4 v176, s[36:39], s52 offen lds
.Lk1wd_270:
    s_waitcnt lgkmcnt(14)
    v_mfma_f32_16x16x32_bf16 v[48:51], v[108:111], v[200:203], v[48:51]
    ds_read_b64_tr_b16 v[104:105], v172 offset:36928
    v_mfma_f32_16x16x32_bf16 v[52:55], v[108:111], v[204:207], v[52:55]
    ds_read_b64_tr_b16 v[106:107], v172 offset:41536
    s_waitcnt lgkmcnt(14)
    v_mfma_f32_16x16x32_bf16 v[56:59], v[112:115], v[200:203], v[56:59]
    ds_read_b64_tr_b16 v[108:109], v172 offset:36960
    v_mfma_f32_16x16x32_bf16 v[60:63], v[112:115], v[204:207], v[60:63]
    ds_read_b64_tr_b16 v[110:111], v172 offset:41568
    s_waitcnt lgkmcnt(14)
    v_mfma_f32_16x16x32_bf16 v[64:67], v[116:119], v[200:203], v[64:67]
    ds_read_b64_tr_b16 v[112:113], v172 offset:36992
    s_cbranch_vccz .Lk1wd_271
    s_add_u32 m0, s65, 94208
    s_add_u32 s52, s61, 552960
    buffer_load_dwordx4 v177, s[36:39], s52 offen lds
.Lk1wd_271:
    v_mfma_f32_16x16x32_bf16 v[68:71], v[116:119], v[204:207], v[68:71]
    ds_read_b64_tr_b16 v[114:115], v172 offset:41600
    s_waitcnt lgkmcnt(14)
    v_mfma_f32_16x16x32_bf16 v[72:75], v[120:123], v[200:203], v[72:75]
    ds_read_b64_tr_b16 v[116:117], v172 offset:37024
    v_mfma_f32_16x16x32_bf16 v[76:79], v[120:123], v[204:207], v[76:79]
    ds_read_b64_tr_b16 v[118:119], v172 offset:41632
    s_waitcnt lgkmcnt(14)
    v_mfma_f32_16x16x32_bf16 v[80:83], v[124:127], v[200:203], v[80:83]
    ds_read_b64_tr_b16 v[120:121], v172 offset:37056
    v_mfma_f32_16x16x32_bf16 v[84:87], v[124:127], v[204:207], v[84:87]
    ds_read_b64_tr_b16 v[122:123], v172 offset:41664
    s_waitcnt lgkmcnt(14)
    v_mfma_f32_16x16x32_bf16 v[88:91], v[128:131], v[200:203], v[88:91]
    ds_read_b64_tr_b16 v[124:125], v172 offset:37088
    v_mfma_f32_16x16x32_bf16 v[92:95], v[128:131], v[204:207], v[92:95]
    ds_read_b64_tr_b16 v[126:127], v172 offset:41696
    s_cmp_eq_u32 s34, 0
    s_cbranch_scc0 .Lk1h20_272
    s_lshl_b32 s52, s28, 2
    s_add_u32 s52, s52, s30
    s_mul_i32 s52, s52, 40960
    s_lshl_b32 s53, s33, 11
    s_add_u32 s52, s52, s53
    s_mul_i32 s53, s34, 24576
    s_add_u32 s52, s52, s53
    s_add_u32 s52, s52, 4210688
    buffer_load_dwordx4 v[200:203], v182, s[44:47], s52 offen sc1
    buffer_load_dwordx4 v[204:207], v183, s[44:47], s52 offen sc1
.Lk1h20_272:
    s_cbranch_vccz .Lk1w2_273
    s_waitcnt vmcnt(10)
    s_branch .Lk1we_274
.Lk1w2_273:
    s_waitcnt vmcnt(15)
.Lk1we_274:
    s_barrier
    s_waitcnt lgkmcnt(14)
    v_mfma_f32_16x16x32_bf16 v[24:27], v[96:99], v[208:211], v[24:27]
    ds_read_b64_tr_b16 v[128:129], v172 offset:37120
    v_mfma_f32_16x16x32_bf16 v[28:31], v[96:99], v[212:215], v[28:31]
    ds_read_b64_tr_b16 v[130:131], v172 offset:41728
    s_cbranch_vccz .Lk1wd_275
    s_add_u32 m0, s65, 110592
    s_add_u32 s52, s61, 589824
    buffer_load_dwordx4 v175, s[36:39], s52 offen lds
.Lk1wd_275:
    s_waitcnt lgkmcnt(14)
    v_mfma_f32_16x16x32_bf16 v[32:35], v[100:103], v[208:211], v[32:35]
    ds_read_b64_tr_b16 v[96:97], v173 offset:0
    v_mfma_f32_16x16x32_bf16 v[36:39], v[100:103], v[212:215], v[36:39]
    ds_read_b64_tr_b16 v[98:99], v173 offset:4608
    s_waitcnt lgkmcnt(14)
    v_mfma_f32_16x16x32_bf16 v[40:43], v[104:107], v[208:211], v[40:43]
    ds_read_b64_tr_b16 v[100:101], v173 offset:32
    v_mfma_f32_16x16x32_bf16 v[44:47], v[104:107], v[212:215], v[44:47]
    ds_read_b64_tr_b16 v[102:103], v173 offset:4640
    s_cbranch_vccz .Lk1wd_276
    s_add_u32 m0, s65, 111616
    s_add_u32 s52, s61, 589824
    buffer_load_dwordx4 v176, s[36:39], s52 offen lds
.Lk1wd_276:
    s_waitcnt lgkmcnt(14)
    v_mfma_f32_16x16x32_bf16 v[48:51], v[108:111], v[208:211], v[48:51]
    ds_read_b64_tr_b16 v[104:105], v173 offset:64
    v_mfma_f32_16x16x32_bf16 v[52:55], v[108:111], v[212:215], v[52:55]
    ds_read_b64_tr_b16 v[106:107], v173 offset:4672
    s_waitcnt lgkmcnt(14)
    v_mfma_f32_16x16x32_bf16 v[56:59], v[112:115], v[208:211], v[56:59]
    ds_read_b64_tr_b16 v[108:109], v173 offset:96
    v_mfma_f32_16x16x32_bf16 v[60:63], v[112:115], v[212:215], v[60:63]
    ds_read_b64_tr_b16 v[110:111], v173 offset:4704
    s_waitcnt lgkmcnt(14)
    v_mfma_f32_16x16x32_bf16 v[64:67], v[116:119], v[208:211], v[64:67]
    ds_read_b64_tr_b16 v[112:113], v173 offset:128
    s_cbranch_vccz .Lk1wd_277
    s_add_u32 m0, s65, 112640
    s_add_u32 s52, s61, 589824
    buffer_load_dwordx4 v177, s[36:39], s52 offen lds
.Lk1wd_277:
    v_mfma_f32_16x16x32_bf16 v[68:71], v[116:119], v[212:215], v[68:71]
    ds_read_b64_tr_b16 v[114:115], v173 offset:4736
    s_waitcnt lgkmcnt(14)
    v_mfma_f32_16x16x32_bf16 v[72:75], v[120:123], v[208:211], v[72:75]
    ds_read_b64_tr_b16 v[116:117], v173 offset:160
    v_mfma_f32_16x16x32_bf16 v[76:79], v[120:123], v[212:215], v[76:79]
    ds_read_b64_tr_b16 v[118:119], v173 offset:4768
    s_waitcnt lgkmcnt(14)
    v_mfma_f32_16x16x32_bf16 v[80:83], v[124:127], v[208:211], v[80:83]
    ds_read_b64_tr_b16 v[120:121], v173 offset:192
    v_mfma_f32_16x16x32_bf16 v[84:87], v[124:127], v[212:215], v[84:87]
    ds_read_b64_tr_b16 v[122:123], v173 offset:4800
    s_waitcnt lgkmcnt(14)
    v_mfma_f32_16x16x32_bf16 v[88:91], v[128:131], v[208:211], v[88:91]
    ds_read_b64_tr_b16 v[124:125], v173 offset:224
    v_mfma_f32_16x16x32_bf16 v[92:95], v[128:131], v[212:215], v[92:95]
    ds_read_b64_tr_b16 v[126:127], v173 offset:4832
    s_cbranch_vccz .Lk1w2_278
    s_waitcnt vmcnt(8)
    s_branch .Lk1we_279
.Lk1w2_278:
    s_waitcnt vmcnt(13)
.Lk1we_279:
    s_barrier
    s_waitcnt lgkmcnt(14)
    v_mfma_f32_16x16x32_bf16 v[24:27], v[96:99], v[216:219], v[24:27]
    ds_read_b64_tr_b16 v[128:129], v173 offset:256
    v_mfma_f32_16x16x32_bf16 v[28:31], v[96:99], v[220:223], v[28:31]
    ds_read_b64_tr_b16 v[130:131], v173 offset:4864
    s_cbranch_vccz .Lk1wd_280
    s_add_u32 m0, s65, 129024
    s_add_u32 s52, s61, 626688
    buffer_load_dwordx4 v175, s[36:39], s52 offen lds
.Lk1wd_280:
    s_waitcnt lgkmcnt(14)
    v_mfma_f32_16x16x32_bf16 v[32:35], v[100:103], v[216:219], v[32:35]
    ds_read_b64_tr_b16 v[96:97], v173 offset:18432
    v_mfma_f32_16x16x32_bf16 v[36:39], v[100:103], v[220:223], v[36:39]
    ds_read_b64_tr_b16 v[98:99], v173 offset:23040
    s_waitcnt lgkmcnt(14)
    v_mfma_f32_16x16x32_bf16 v[40:43], v[104:107], v[216:219], v[40:43]
    ds_read_b64_tr_b16 v[100:101], v173 offset:18464
    v_mfma_f32_16x16x32_bf16 v[44:47], v[104:107], v[220:223], v[44:47]
    ds_read_b64_tr_b16 v[102:103], v173 offset:23072
    s_cbranch_vccz .Lk1wd_281
    s_add_u32 m0, s65, 130048
    s_add_u32 s52, s61, 626688
    buffer_load_dwordx4 v176, s[36:39], s52 offen lds
.Lk1wd_281:
    s_waitcnt lgkmcnt(14)
    v_mfma_f32_16x16x32_bf16 v[48:51], v[108:111], v[216:219], v[48:51]
    ds_read_b64_tr_b16 v[104:105], v173 offset:18496
    v_mfma_f32_16x16x32_bf16 v[52:55], v[108:111], v[220:223], v[52:55]
    ds_read_b64_tr_b16 v[106:107], v173 offset:23104
    s_waitcnt lgkmcnt(14)
    v_mfma_f32_16x16x32_bf16 v[56:59], v[112:115], v[216:219], v[56:59]
    ds_read_b64_tr_b16 v[108:109], v173 offset:18528
    v_mfma_f32_16x16x32_bf16 v[60:63], v[112:115], v[220:223], v[60:63]
    ds_read_b64_tr_b16 v[110:111], v173 offset:23136
    s_waitcnt lgkmcnt(14)
    v_mfma_f32_16x16x32_bf16 v[64:67], v[116:119], v[216:219], v[64:67]
    ds_read_b64_tr_b16 v[112:113], v173 offset:18560
    s_cbranch_vccz .Lk1wd_282
    s_add_u32 m0, s65, 131072
    s_add_u32 s52, s61, 626688
    buffer_load_dwordx4 v177, s[36:39], s52 offen lds
.Lk1wd_282:
    v_mfma_f32_16x16x32_bf16 v[68:71], v[116:119], v[220:223], v[68:71]
    ds_read_b64_tr_b16 v[114:115], v173 offset:23168
    s_waitcnt lgkmcnt(14)
    v_mfma_f32_16x16x32_bf16 v[72:75], v[120:123], v[216:219], v[72:75]
    ds_read_b64_tr_b16 v[116:117], v173 offset:18592
    v_mfma_f32_16x16x32_bf16 v[76:79], v[120:123], v[220:223], v[76:79]
    ds_read_b64_tr_b16 v[118:119], v173 offset:23200
    s_waitcnt lgkmcnt(14)
    v_mfma_f32_16x16x32_bf16 v[80:83], v[124:127], v[216:219], v[80:83]
    ds_read_b64_tr_b16 v[120:121], v173 offset:18624
    v_mfma_f32_16x16x32_bf16 v[84:87], v[124:127], v[220:223], v[84:87]
    ds_read_b64_tr_b16 v[122:123], v173 offset:23232
    s_waitcnt lgkmcnt(14)
    v_mfma_f32_16x16x32_bf16 v[88:91], v[128:131], v[216:219], v[88:91]
    ds_read_b64_tr_b16 v[124:125], v173 offset:18656
    v_mfma_f32_16x16x32_bf16 v[92:95], v[128:131], v[220:223], v[92:95]
    ds_read_b64_tr_b16 v[126:127], v173 offset:23264
    s_cbranch_vccz .Lk1w2_283
    s_waitcnt vmcnt(6)
    s_branch .Lk1we_284
.Lk1w2_283:
    s_waitcnt vmcnt(11)
.Lk1we_284:
    s_barrier
    s_waitcnt lgkmcnt(14)
    v_mfma_f32_16x16x32_bf16 v[24:27], v[96:99], v[224:227], v[24:27]
    ds_read_b64_tr_b16 v[128:129], v173 offset:18688
    v_mfma_f32_16x16x32_bf16 v[28:31], v[96:99], v[228:231], v[28:31]
    ds_read_b64_tr_b16 v[130:131], v173 offset:23296
    s_cmp_lt_u32 s32, 6
    s_cbranch_scc0 .Lk1wd_285
    s_add_u32 m0, s65, 0
    s_nop 0
    buffer_load_dwordx4 v132, s[40:43], 0 offen lds
.Lk1wd_285:
    s_waitcnt lgkmcnt(14)
    v_mfma_f32_16x16x32_bf16 v[32:35], v[100:103], v[224:227], v[32:35]
    ds_read_b64_tr_b16 v[96:97], v173 offset:36864
    v_mfma_f32_16x16x32_bf16 v[36:39], v[100:103], v[228:231], v[36:39]
    ds_read_b64_tr_b16 v[98:99], v173 offset:41472
    s_waitcnt lgkmcnt(14)
    v_mfma_f32_16x16x32_bf16 v[40:43], v[104:107], v[224:227], v[40:43]
    ds_read_b64_tr_b16 v[100:101], v173 offset:36896
    v_mfma_f32_16x16x32_bf16 v[44:47], v[104:107], v[228:231], v[44:47]
    ds_read_b64_tr_b16 v[102:103], v173 offset:41504
    s_cmp_lt_u32 s32, 6
    s_cbranch_scc0 .Lk1wd_286
    s_add_u32 m0, s65, 1024
    s_nop 0
    buffer_load_dwordx4 v133, s[40:43], 0 offen lds
.Lk1wd_286:
    s_waitcnt lgkmcnt(14)
    v_mfma_f32_16x16x32_bf16 v[48:51], v[108:111], v[224:227], v[48:51]
    ds_read_b64_tr_b16 v[104:105], v173 offset:36928
    v_mfma_f32_16x16x32_bf16 v[52:55], v[108:111], v[228:231], v[52:55]
    ds_read_b64_tr_b16 v[106:107], v173 offset:41536
    s_waitcnt lgkmcnt(14)
    v_mfma_f32_16x16x32_bf16 v[56:59], v[112:115], v[224:227], v[56:59]
    ds_read_b64_tr_b16 v[108:109], v173 offset:36960
    v_mfma_f32_16x16x32_bf16 v[60:63], v[112:115], v[228:231], v[60:63]
    ds_read_b64_tr_b16 v[110:111], v173 offset:41568
    s_waitcnt lgkmcnt(14)
    v_mfma_f32_16x16x32_bf16 v[64:67], v[116:119], v[224:227], v[64:67]
    ds_read_b64_tr_b16 v[112:113], v173 offset:36992
    s_cmp_lt_u32 s32, 6
    s_cbranch_scc0 .Lk1wd_287
    s_add_u32 m0, s65, 2048
    s_nop 0
    buffer_load_dwordx4 v134, s[40:43], 0 offen lds
.Lk1wd_287:
    v_mfma_f32_16x16x32_bf16 v[68:71], v[116:119], v[228:231], v[68:71]
    ds_read_b64_tr_b16 v[114:115], v173 offset:41600
    s_waitcnt lgkmcnt(14)
    v_mfma_f32_16x16x32_bf16 v[72:75], v[120:123], v[224:227], v[72:75]
    ds_read_b64_tr_b16 v[116:117], v173 offset:37024
    v_mfma_f32_16x16x32_bf16 v[76:79], v[120:123], v[228:231], v[76:79]
    ds_read_b64_tr_b16 v[118:119], v173 offset:41632
    s_waitcnt lgkmcnt(14)
    v_mfma_f32_16x16x32_bf16 v[80:83], v[124:127], v[224:227], v[80:83]
    ds_read_b64_tr_b16 v[120:121], v173 offset:37056
    v_mfma_f32_16x16x32_bf16 v[84:87], v[124:127], v[228:231], v[84:87]
    ds_read_b64_tr_b16 v[122:123], v173 offset:41664
    s_waitcnt lgkmcnt(14)
    v_mfma_f32_16x16x32_bf16 v[88:91], v[128:131], v[224:227], v[88:91]
    ds_read_b64_tr_b16 v[124:125], v173 offset:37088
    v_mfma_f32_16x16x32_bf16 v[92:95], v[128:131], v[228:231], v[92:95]
    ds_read_b64_tr_b16 v[126:127], v173 offset:41696
    s_cbranch_vccz .Lk1w2_288
    s_waitcnt vmcnt(6)
    s_branch .Lk1we_289
.Lk1w2_288:
    s_waitcnt vmcnt(9)
.Lk1we_289:
    s_barrier
    s_waitcnt lgkmcnt(14)
    v_mfma_f32_16x16x32_bf16 v[24:27], v[96:99], v[232:235], v[24:27]
    ds_read_b64_tr_b16 v[128:129], v173 offset:37120
    v_mfma_f32_16x16x32_bf16 v[28:31], v[96:99], v[236:239], v[28:31]
    ds_read_b64_tr_b16 v[130:131], v173 offset:41728
    s_cmp_lt_u32 s32, 6
    s_cbranch_scc0 .Lk1wd_290
    s_add_u32 m0, s65, 18432
    s_nop 0
    buffer_load_dwordx4 v135, s[40:43], 0 offen lds
.Lk1wd_290:
    s_waitcnt lgkmcnt(14)
    v_mfma_f32_16x16x32_bf16 v[32:35], v[100:103], v[232:235], v[32:35]
    ds_read_b64_tr_b16 v[96:97], v174 offset:0
    v_mfma_f32_16x16x32_bf16 v[36:39], v[100:103], v[236:239], v[36:39]
    ds_read_b64_tr_b16 v[98:99], v174 offset:4608
    s_waitcnt lgkmcnt(14)
    v_mfma_f32_16x16x32_bf16 v[40:43], v[104:107], v[232:235], v[40:43]
    ds_read_b64_tr_b16 v[100:101], v174 offset:32
    v_mfma_f32_16x16x32_bf16 v[44:47], v[104:107], v[236:239], v[44:47]
    ds_read_b64_tr_b16 v[102:103], v174 offset:4640
    s_cmp_lt_u32 s32, 6
    s_cbranch_scc0 .Lk1wd_291
    s_add_u32 m0, s65, 19456
    s_nop 0
    buffer_load_dwordx4 v136, s[40:43], 0 offen lds
.Lk1wd_291:
    s_waitcnt lgkmcnt(14)
    v_mfma_f32_16x16x32_bf16 v[48:51], v[108:111], v[232:235], v[48:51]
    ds_read_b64_tr_b16 v[104:105], v174 offset:64
    v_mfma_f32_16x16x32_bf16 v[52:55], v[108:111], v[236:239], v[52:55]
    ds_read_b64_tr_b16 v[106:107], v174 offset:4672
    s_waitcnt lgkmcnt(14)
    v_mfma_f32_16x16x32_bf16 v[56:59], v[112:115], v[232:235], v[56:59]
    ds_read_b64_tr_b16 v[108:109], v174 offset:96
    v_mfma_f32_16x16x32_bf16 v[60:63], v[112:115], v[236:239], v[60:63]
    ds_read_b64_tr_b16 v[110:111], v174 offset:4704
    s_waitcnt lgkmcnt(14)
    v_mfma_f32_16x16x32_bf16 v[64:67], v[116:119], v[232:235], v[64:67]
    ds_read_b64_tr_b16 v[112:113], v174 offset:128
    s_cmp_lt_u32 s32, 6
    s_cbranch_scc0 .Lk1wd_292
    s_add_u32 m0, s65, 20480
    s_nop 0
    buffer_load_dwordx4 v137, s[40:43], 0 offen lds
.Lk1wd_292:
    v_mfma_f32_16x16x32_bf16 v[68:71], v[116:119], v[236:239], v[68:71]
    ds_read_b64_tr_b16 v[114:115], v174 offset:4736
    s_waitcnt lgkmcnt(14)
    v_mfma_f32_16x16x32_bf16 v[72:75], v[120:123], v[232:235], v[72:75]
    ds_read_b64_tr_b16 v[116:117], v174 offset:160
    v_mfma_f32_16x16x32_bf16 v[76:79], v[120:123], v[236:239], v[76:79]
    ds_read_b64_tr_b16 v[118:119], v174 offset:4768
    s_waitcnt lgkmcnt(14)
    v_mfma_f32_16x16x32_bf16 v[80:83], v[124:127], v[232:235], v[80:83]
    ds_read_b64_tr_b16 v[120:121], v174 offset:192
    v_mfma_f32_16x16x32_bf16 v[84:87], v[124:127], v[236:239], v[84:87]
    ds_read_b64_tr_b16 v[122:123], v174 offset:4800
    s_waitcnt lgkmcnt(14)
    v_mfma_f32_16x16x32_bf16 v[88:91], v[128:131], v[232:235], v[88:91]
    ds_read_b64_tr_b16 v[124:125], v174 offset:224
    v_mfma_f32_16x16x32_bf16 v[92:95], v[128:131], v[236:239], v[92:95]
    ds_read_b64_tr_b16 v[126:127], v174 offset:4832
    s_cbranch_vccz .Lk1w2_293
    s_waitcnt vmcnt(6)
    s_branch .Lk1we_294
.Lk1w2_293:
    s_waitcnt vmcnt(7)
.Lk1we_294:
    s_barrier
    s_waitcnt lgkmcnt(14)
    v_mfma_f32_16x16x32_bf16 v[24:27], v[96:99], v[240:243], v[24:27]
    ds_read_b64_tr_b16 v[128:129], v174 offset:256
    v_mfma_f32_16x16x32_bf16 v[28:31], v[96:99], v[244:247], v[28:31]
    ds_read_b64_tr_b16 v[130:131], v174 offset:4864
    s_cmp_lt_u32 s32, 3
    s_cbranch_scc0 .Lk1wd_295
    s_add_u32 m0, s65, 36864
    s_nop 0
    buffer_load_dwordx4 v138, s[40:43], 0 offen lds
.Lk1wd_295:
    s_waitcnt lgkmcnt(14)
    v_mfma_f32_16x16x32_bf16 v[32:35], v[100:103], v[240:243], v[32:35]
    ds_read_b64_tr_b16 v[96:97], v174 offset:18432
    v_mfma_f32_16x16x32_bf16 v[36:39], v[100:103], v[244:247], v[36:39]
    ds_read_b64_tr_b16 v[98:99], v174 offset:23040
    s_waitcnt lgkmcnt(14)
    v_mfma_f32_16x16x32_bf16 v[40:43], v[104:107], v[240:243], v[40:43]
    ds_read_b64_tr_b16 v[100:101], v174 offset:18464
    v_mfma_f32_16x16x32_bf16 v[44:47], v[104:107], v[244:247], v[44:47]
    ds_read_b64_tr_b16 v[102:103], v174 offset:23072
    s_cmp_lt_u32 s32, 3
    s_cbranch_scc0 .Lk1wd_296
    s_add_u32 m0, s65, 37888
    s_nop 0
    buffer_load_dwordx4 v139, s[40:43], 0 offen lds
.Lk1wd_296:
    s_waitcnt lgkmcnt(14)
    v_mfma_f32_16x16x32_bf16 v[48:51], v[108:111], v[240:243], v[48:51]
    ds_read_b64_tr_b16 v[104:105], v174 offset:18496
    v_mfma_f32_16x16x32_bf16 v[52:55], v[108:111], v[244:247], v[52:55]
    ds_read_b64_tr_b16 v[106:107], v174 offset:23104
    s_waitcnt lgkmcnt(14)
    v_mfma_f32_16x16x32_bf16 v[56:59], v[112:115], v[240:243], v[56:59]
    ds_read_b64_tr_b16 v[108:109], v174 offset:18528
    v_mfma_f32_16x16x32_bf16 v[60:63], v[112:115], v[244:247], v[60:63]
    ds_read_b64_tr_b16 v[110:111], v174 offset:23136
    s_waitcnt lgkmcnt(14)
    v_mfma_f32_16x16x32_bf16 v[64:67], v[116:119], v[240:243], v[64:67]
    ds_read_b64_tr_b16 v[112:113], v174 offset:18560
    s_cmp_lt_u32 s32, 3
    s_cbranch_scc0 .Lk1wd_297
    s_add_u32 m0, s65, 38912
    s_nop 0
    buffer_load_dwordx4 v140, s[40:43], 0 offen lds
.Lk1wd_297:
    v_mfma_f32_16x16x32_bf16 v[68:71], v[116:119], v[244:247], v[68:71]
    ds_read_b64_tr_b16 v[114:115], v174 offset:23168
    s_waitcnt lgkmcnt(14)
    v_mfma_f32_16x16x32_bf16 v[72:75], v[120:123], v[240:243], v[72:75]
    ds_read_b64_tr_b16 v[116:117], v174 offset:18592
    v_mfma_f32_16x16x32_bf16 v[76:79], v[120:123], v[244:247], v[76:79]
    ds_read_b64_tr_b16 v[118:119], v174 offset:23200
    s_waitcnt lgkmcnt(14)
    v_mfma_f32_16x16x32_bf16 v[80:83], v[124:127], v[240:243], v[80:83]
    ds_read_b64_tr_b16 v[120:121], v174 offset:18624
    v_mfma_f32_16x16x32_bf16 v[84:87], v[124:127], v[244:247], v[84:87]
    ds_read_b64_tr_b16 v[122:123], v174 offset:23232
    s_waitcnt lgkmcnt(14)
    v_mfma_f32_16x16x32_bf16 v[88:91], v[128:131], v[240:243], v[88:91]
    ds_read_b64_tr_b16 v[124:125], v174 offset:18656
    v_mfma_f32_16x16x32_bf16 v[92:95], v[128:131], v[244:247], v[92:95]
    ds_read_b64_tr_b16 v[126:127], v174 offset:23264
    s_cbranch_vccz .Lk1w2_298
    s_waitcnt vmcnt(3)
    s_branch .Lk1we_299
.Lk1w2_298:
    s_waitcnt vmcnt(4)
.Lk1we_299:
    s_barrier
    s_waitcnt lgkmcnt(14)
    v_mfma_f32_16x16x32_bf16 v[24:27], v[96:99], v[248:251], v[24:27]
    ds_read_b64_tr_b16 v[128:129], v174 offset:18688
    v_mfma_f32_16x16x32_bf16 v[28:31], v[96:99], v[252:255], v[28:31]
    ds_read_b64_tr_b16 v[130:131], v174 offset:23296
    s_waitcnt lgkmcnt(14)
    v_mfma_f32_16x16x32_bf16 v[32:35], v[100:103], v[248:251], v[32:35]
    ds_read_b64_tr_b16 v[96:97], v172 offset:0
    v_mfma_f32_16x16x32_bf16 v[36:39], v[100:103], v[252:255], v[36:39]
    ds_read_b64_tr_b16 v[98:99], v172 offset:4608
    s_waitcnt lgkmcnt(14)
    v_mfma_f32_16x16x32_bf16 v[40:43], v[104:107], v[248:251], v[40:43]
    ds_read_b64_tr_b16 v[100:101], v172 offset:32
    v_mfma_f32_16x16x32_bf16 v[44:47], v[104:107], v[252:255], v[44:47]
    ds_read_b64_tr_b16 v[102:103], v172 offset:4640
    s_waitcnt lgkmcnt(14)
    v_mfma_f32_16x16x32_bf16 v[48:51], v[108:111], v[248:251], v[48:51]
    ds_read_b64_tr_b16 v[104:105], v172 offset:64
    v_mfma_f32_16x16x32_bf16 v[52:55], v[108:111], v[252:255], v[52:55]
    ds_read_b64_tr_b16 v[106:107], v172 offset:4672
    s_waitcnt lgkmcnt(14)
    v_mfma_f32_16x16x32_bf16 v[56:59], v[112:115], v[248:251], v[56:59]
    ds_read_b64_tr_b16 v[108:109], v172 offset:96
    v_mfma_f32_16x16x32_bf16 v[60:63], v[112:115], v[252:255], v[60:63]
    ds_read_b64_tr_b16 v[110:111], v172 offset:4704
    s_waitcnt lgkmcnt(14)
    v_mfma_f32_16x16x32_bf16 v[64:67], v[116:119], v[248:251], v[64:67]
    ds_read_b64_tr_b16 v[112:113], v172 offset:128
    v_mfma_f32_16x16x32_bf16 v[68:71], v[116:119], v[252:255], v[68:71]
    ds_read_b64_tr_b16 v[114:115], v172 offset:4736
    s_waitcnt lgkmcnt(14)
    v_mfma_f32_16x16x32_bf16 v[72:75], v[120:123], v[248:251], v[72:75]
    ds_read_b64_tr_b16 v[116:117], v172 offset:160
    v_mfma_f32_16x16x32_bf16 v[76:79], v[120:123], v[252:255], v[76:79]
    ds_read_b64_tr_b16 v[118:119], v172 offset:4768
    s_waitcnt lgkmcnt(14)
    v_mfma_f32_16x16x32_bf16 v[80:83], v[124:127], v[248:251], v[80:83]
    ds_read_b64_tr_b16 v[120:121], v172 offset:192
    v_mfma_f32_16x16x32_bf16 v[84:87], v[124:127], v[252:255], v[84:87]
    ds_read_b64_tr_b16 v[122:123], v172 offset:4800
    s_waitcnt lgkmcnt(14)
    v_mfma_f32_16x16x32_bf16 v[88:91], v[128:131], v[248:251], v[88:91]
    ds_read_b64_tr_b16 v[124:125], v172 offset:224
    v_mfma_f32_16x16x32_bf16 v[92:95], v[128:131], v[252:255], v[92:95]
    ds_read_b64_tr_b16 v[126:127], v172 offset:4832
    s_cbranch_vccz .Lk1w2_300
    s_waitcnt vmcnt(0)
    s_branch .Lk1we_301
.Lk1w2_300:
    s_waitcnt vmcnt(2)
.Lk1we_301:
    s_barrier
    s_waitcnt lgkmcnt(14)
    v_mfma_f32_16x16x32_bf16 v[24:27], v[96:99], v[184:187], v[24:27]
    ds_read_b64_tr_b16 v[128:129], v172 offset:256
    v_mfma_f32_16x16x32_bf16 v[28:31], v[96:99], v[188:191], v[28:31]
    ds_read_b64_tr_b16 v[130:131], v172 offset:4864
    s_waitcnt lgkmcnt(14)
    v_mfma_f32_16x16x32_bf16 v[32:35], v[100:103], v[184:187], v[32:35]
    ds_read_b64_tr_b16 v[96:97], v172 offset:18432
    v_mfma_f32_16x16x32_bf16 v[36:39], v[100:103], v[188:191], v[36:39]
    ds_read_b64_tr_b16 v[98:99], v172 offset:23040
    s_waitcnt lgkmcnt(14)
    v_mfma_f32_16x16x32_bf16 v[40:43], v[104:107], v[184:187], v[40:43]
    ds_read_b64_tr_b16 v[100:101], v172 offset:18464
    v_mfma_f32_16x16x32_bf16 v[44:47], v[104:107], v[188:191], v[44:47]
    ds_read_b64_tr_b16 v[102:103], v172 offset:23072
    s_waitcnt lgkmcnt(14)
    v_mfma_f32_16x16x32_bf16 v[48:51], v[108:111], v[184:187], v[48:51]
    ds_read_b64_tr_b16 v[104:105], v172 offset:18496
    v_mfma_f32_16x16x32_bf16 v[52:55], v[108:111], v[188:191], v[52:55]
    ds_read_b64_tr_b16 v[106:107], v172 offset:23104
    s_waitcnt lgkmcnt(14)
    v_mfma_f32_16x16x32_bf16 v[56:59], v[112:115], v[184:187], v[56:59]
    ds_read_b64_tr_b16 v[108:109], v172 offset:18528
    v_mfma_f32_16x16x32_bf16 v[60:63], v[112:115], v[188:191], v[60:63]
    ds_read_b64_tr_b16 v[110:111], v172 offset:23136
    s_waitcnt lgkmcnt(14)
    v_mfma_f32_16x16x32_bf16 v[64:67], v[116:119], v[184:187], v[64:67]
    ds_read_b64_tr_b16 v[112:113], v172 offset:18560
    v_mfma_f32_16x16x32_bf16 v[68:71], v[116:119], v[188:191], v[68:71]
    ds_read_b64_tr_b16 v[114:115], v172 offset:23168
    s_waitcnt lgkmcnt(14)
    v_mfma_f32_16x16x32_bf16 v[72:75], v[120:123], v[184:187], v[72:75]
    ds_read_b64_tr_b16 v[116:117], v172 offset:18592
    v_mfma_f32_16x16x32_bf16 v[76:79], v[120:123], v[188:191], v[76:79]
    ds_read_b64_tr_b16 v[118:119], v172 offset:23200
    s_waitcnt lgkmcnt(14)
    v_mfma_f32_16x16x32_bf16 v[80:83], v[124:127], v[184:187], v[80:83]
    ds_read_b64_tr_b16 v[120:121], v172 offset:18624
    v_mfma_f32_16x16x32_bf16 v[84:87], v[124:127], v[188:191], v[84:87]
    ds_read_b64_tr_b16 v[122:123], v172 offset:23232
    s_waitcnt lgkmcnt(14)
    v_mfma_f32_16x16x32_bf16 v[88:91], v[128:131], v[184:187], v[88:91]
    ds_read_b64_tr_b16 v[124:125], v172 offset:18656
    v_mfma_f32_16x16x32_bf16 v[92:95], v[128:131], v[188:191], v[92:95]
    ds_read_b64_tr_b16 v[126:127], v172 offset:23264
    s_waitcnt vmcnt(0)
    s_barrier
    s_waitcnt lgkmcnt(14)
    v_mfma_f32_16x16x32_bf16 v[24:27], v[96:99], v[192:195], v[24:27]
    ds_read_b64_tr_b16 v[128:129], v172 offset:18688
    v_mfma_f32_16x16x32_bf16 v[28:31], v[96:99], v[196:199], v[28:31]
    ds_read_b64_tr_b16 v[130:131], v172 offset:23296
    s_waitcnt lgkmcnt(14)
    v_mfma_f32_16x16x32_bf16 v[32:35], v[100:103], v[192:195], v[32:35]
    ds_read_b64_tr_b16 v[96:97], v172 offset:36864
    v_mfma_f32_16x16x32_bf16 v[36:39], v[100:103], v[196:199], v[36:39]
    ds_read_b64_tr_b16 v[98:99], v172 offset:41472
    s_waitcnt lgkmcnt(14)
    v_mfma_f32_16x16x32_bf16 v[40:43], v[104:107], v[192:195], v[40:43]
    ds_read_b64_tr_b16 v[100:101], v172 offset:36896
    v_mfma_f32_16x16x32_bf16 v[44:47], v[104:107], v[196:199], v[44:47]
    ds_read_b64_tr_b16 v[102:103], v172 offset:41504
    s_waitcnt lgkmcnt(14)
    v_mfma_f32_16x16x32_bf16 v[48:51], v[108:111], v[192:195], v[48:51]
    ds_read_b64_tr_b16 v[104:105], v172 offset:36928
    v_mfma_f32_16x16x32_bf16 v[52:55], v[108:111], v[196:199], v[52:55]
    ds_read_b64_tr_b16 v[106:107], v172 offset:41536
    s_waitcnt lgkmcnt(14)
    v_mfma_f32_16x16x32_bf16 v[56:59], v[112:115], v[192:195], v[56:59]
    ds_read_b64_tr_b16 v[108:109], v172 offset:36960
    v_mfma_f32_16x16x32_bf16 v[60:63], v[112:115], v[196:199], v[60:63]
    ds_read_b64_tr_b16 v[110:111], v172 offset:41568
    s_waitcnt lgkmcnt(14)
    v_mfma_f32_16x16x32_bf16 v[64:67], v[116:119], v[192:195], v[64:67]
    ds_read_b64_tr_b16 v[112:113], v172 offset:36992
    v_mfma_f32_16x16x32_bf16 v[68:71], v[116:119], v[196:199], v[68:71]
    ds_read_b64_tr_b16 v[114:115], v172 offset:41600
    s_waitcnt lgkmcnt(14)
    v_mfma_f32_16x16x32_bf16 v[72:75], v[120:123], v[192:195], v[72:75]
    ds_read_b64_tr_b16 v[116:117], v172 offset:37024
    v_mfma_f32_16x16x32_bf16 v[76:79], v[120:123], v[196:199], v[76:79]
    ds_read_b64_tr_b16 v[118:119], v172 offset:41632
    s_waitcnt lgkmcnt(14)
    v_mfma_f32_16x16x32_bf16 v[80:83], v[124:127], v[192:195], v[80:83]
    ds_read_b64_tr_b16 v[120:121], v172 offset:37056
    v_mfma_f32_16x16x32_bf16 v[84:87], v[124:127], v[196:199], v[84:87]
    ds_read_b64_tr_b16 v[122:123], v172 offset:41664
    s_waitcnt lgkmcnt(14)
    v_mfma_f32_16x16x32_bf16 v[88:91], v[128:131], v[192:195], v[88:91]
    ds_read_b64_tr_b16 v[124:125], v172 offset:37088
    v_mfma_f32_16x16x32_bf16 v[92:95], v[128:131], v[196:199], v[92:95]
    ds_read_b64_tr_b16 v[126:127], v172 offset:41696
    s_cbranch_vccz .Lk1w2_302
    s_waitcnt vmcnt(12)
    s_branch .Lk1we_303
.Lk1w2_302:
    s_waitcnt vmcnt(0)
.Lk1we_303:
    s_barrier
    s_cmp_eq_u32 s34, 1
    s_cbranch_scc0 .Lk1t20a_304
    s_nop 7
    s_mul_i32 s52, s32, 9216
    s_add_u32 s52, s52, 55296
    v_add_u32 v14, s52, v6
    ds_write_b128 v14, v[28:31] offset:0
    ds_write_b128 v14, v[36:39] offset:1024
    ds_write_b128 v14, v[44:47] offset:2048
    ds_write_b128 v14, v[52:55] offset:3072
    ds_write_b128 v14, v[60:63] offset:4096
    ds_write_b128 v14, v[68:71] offset:5120
    ds_write_b128 v14, v[76:79] offset:6144
    ds_write_b128 v14, v[84:87] offset:7168
    ds_write_b128 v14, v[92:95] offset:8192
    s_branch .Lk1t20e_305
.Lk1t20a_304:
    s_waitcnt lgkmcnt(14)
    v_mfma_f32_16x16x32_bf16 v[24:27], v[96:99], v[200:203], v[24:27]
    ds_read_b64_tr_b16 v[128:129], v172 offset:37120
    v_mfma_f32_16x16x32_bf16 v[28:31], v[96:99], v[204:207], v[28:31]
    ds_read_b64_tr_b16 v[130:131], v172 offset:41728
    s_waitcnt lgkmcnt(14)
    v_mfma_f32_16x16x32_bf16 v[32:35], v[100:103], v[200:203], v[32:35]
    v_mfma_f32_16x16x32_bf16 v[36:39], v[100:103], v[204:207], v[36:39]
    s_waitcnt lgkmcnt(12)
    v_mfma_f32_16x16x32_bf16 v[40:43], v[104:107], v[200:203], v[40:43]
    v_mfma_f32_16x16x32_bf16 v[44:47], v[104:107], v[204:207], v[44:47]
    s_waitcnt lgkmcnt(10)
    v_mfma_f32_16x16x32_bf16 v[48:51], v[108:111], v[200:203], v[48:51]
    v_mfma_f32_16x16x32_bf16 v[52:55], v[108:111], v[204:207], v[52:55]
    s_waitcnt lgkmcnt(8)
    v_mfma_f32_16x16x32_bf16 v[56:59], v[112:115], v[200:203], v[56:59]
    v_mfma_f32_16x16x32_bf16 v[60:63], v[112:115], v[204:207], v[60:63]
    s_waitcnt lgkmcnt(6)
    v_mfma_f32_16x16x32_bf16 v[64:67], v[116:119], v[200:203], v[64:67]
    v_mfma_f32_16x16x32_bf16 v[68:71], v[116:119], v[204:207], v[68:71]
    s_waitcnt lgkmcnt(4)
    v_mfma_f32_16x16x32_bf16 v[72:75], v[120:123], v[200:203], v[72:75]
    v_mfma_f32_16x16x32_bf16 v[76:79], v[120:123], v[204:207], v[76:79]
    s_waitcnt lgkmcnt(2)
    v_mfma_f32_16x16x32_bf16 v[80:83], v[124:127], v[200:203], v[80:83]
    v_mfma_f32_16x16x32_bf16 v[84:87], v[124:127], v[204:207], v[84:87]
    s_waitcnt lgkmcnt(0)
    v_mfma_f32_16x16x32_bf16 v[88:91], v[128:131], v[200:203], v[88:91]
    v_mfma_f32_16x16x32_bf16 v[92:95], v[128:131], v[204:207], v[92:95]
.Lk1t20e_305:
    s_setprio 0
    s_cmp_eq_u32 s34, 0
    s_cbranch_scc0 .Lk1xw_306
    s_nop 7
    s_mul_i32 s52, s32, 9216
    s_add_u32 s52, s52, 55296
    v_add_u32 v14, s52, v6
    ds_write_b128 v14, v[28:31] offset:0
    ds_write_b128 v14, v[36:39] offset:1024
    ds_write_b128 v14, v[44:47] offset:2048
    ds_write_b128 v14, v[52:55] offset:3072
    ds_write_b128 v14, v[60:63] offset:4096
    ds_write_b128 v14, v[68:71] offset:5120
    ds_write_b128 v14, v[76:79] offset:6144
    ds_write_b128 v14, v[84:87] offset:7168
    ds_write_b128 v14, v[92:95] offset:8192
.Lk1xw_306:
    s_xor_b32 s53, s32, 4
    s_mul_i32 s53, s53, 9216
    s_add_u32 s53, s53, 55296
    v_add_u32 v15, s53, v6
    s_waitcnt lgkmcnt(0)
    s_barrier
    ds_read_b128 v[96:99], v15 offset:0
    ds_read_b128 v[100:103], v15 offset:1024
    ds_read_b128 v[104:107], v15 offset:2048
    ds_read_b128 v[108:111], v15 offset:3072
    ds_read_b128 v[112:115], v15 offset:4096
    ds_read_b128 v[116:119], v15 offset:5120
    ds_read_b128 v[120:123], v15 offset:6144
    ds_read_b128 v[124:127], v15 offset:7168
    ds_read_b128 v[128:131], v15 offset:8192
    s_waitcnt lgkmcnt(8)
    v_add_f32 v96, v96, v24
    v_add_f32 v97, v97, v25
    v_add_f32 v98, v98, v26
    v_add_f32 v99, v99, v27
    s_waitcnt lgkmcnt(7)
    v_add_f32 v100, v100, v32
    v_add_f32 v101, v101, v33
    v_add_f32 v102, v102, v34
    v_add_f32 v103, v103, v35
    s_waitcnt lgkmcnt(6)
    v_add_f32 v104, v104, v40
    v_add_f32 v105, v105, v41
    v_add_f32 v106, v106, v42
    v_add_f32 v107, v107, v43
    s_waitcnt lgkmcnt(5)
    v_add_f32 v108, v108, v48
    v_add_f32 v109, v109, v49
    v_add_f32 v110, v110, v50
    v_add_f32 v111, v111, v51
    s_waitcnt lgkmcnt(4)
    v_add_f32 v112, v112, v56
    v_add_f32 v113, v113, v57
    v_add_f32 v114, v114, v58
    v_add_f32 v115, v115, v59
    s_waitcnt lgkmcnt(3)
    v_add_f32 v116, v116, v64
    v_add_f32 v117, v117, v65
    v_add_f32 v118, v118, v66
    v_add_f32 v119, v119, v67
    s_waitcnt lgkmcnt(2)
    v_add_f32 v120, v120, v72
    v_add_f32 v121, v121, v73
    v_add_f32 v122, v122, v74
    v_add_f32 v123, v123, v75
    s_waitcnt lgkmcnt(1)
    v_add_f32 v124, v124, v80
    v_add_f32 v125, v125, v81
    v_add_f32 v126, v126, v82
    v_add_f32 v127, v127, v83
    s_waitcnt lgkmcnt(0)
    v_add_f32 v128, v128, v88
    v_add_f32 v129, v129, v89
    v_add_f32 v130, v130, v90
    v_add_f32 v131, v131, v91
    s_lshl_b32 s63, s33, 1
    s_add_u32 s63, s63, s34
    s_cmp_eq_u32 s30, 1
    s_cbranch_scc1 .Lk1ks1_308
    s_cmp_eq_u32 s30, 2
    s_cbranch_scc1 .Lk1ks2_309
    s_cmp_eq_u32 s30, 3
    s_cbranch_scc1 .Lk1ks3_310
.Lk1ks0_307:
    v_cvt_pk_bf16_f32 v24, v108, v109
    v_cvt_pk_bf16_f32 v25, v110, v111
    v_cvt_pk_bf16_f32 v26, v112, v113
    v_cvt_pk_bf16_f32 v27, v114, v115
    s_lshl_b32 s52, s28, 2
    s_add_u32 s52, s52, s31
    s_lshl_b32 s52, s52, 2
    s_add_u32 s52, s52, 1
    s_lshl_b32 s52, s52, 2
    s_lshl_b32 s52, s52, 3
    s_add_u32 s52, s52, s63
    s_lshl_b32 s52, s52, 11
    s_add_u32 s52, s52, 33554432
    buffer_store_dwordx4 v[24:27], v6, s[44:47], s52 offen sc1
    v_cvt_pk_bf16_f32 v32, v116, v117
    v_cvt_pk_bf16_f32 v33, v118, v119
    v_cvt_pk_bf16_f32 v34, v120, v121
    v_cvt_pk_bf16_f32 v35, v122, v123
    s_lshl_b32 s52, s28, 2
    s_add_u32 s52, s52, s31
    s_lshl_b32 s52, s52, 2
    s_add_u32 s52, s52, 2
    s_lshl_b32 s52, s52, 2
    s_lshl_b32 s52, s52, 3
    s_add_u32 s52, s52, s63
    s_lshl_b32 s52, s52, 11
    s_add_u32 s52, s52, 33554432
    buffer_store_dwordx4 v[32:35], v6, s[44:47], s52 offen sc1
    v_cvt_pk_bf16_f32 v40, v124, v125
    v_cvt_pk_bf16_f32 v41, v126, v127
    v_cvt_pk_bf16_f32 v42, v128, v129
    v_cvt_pk_bf16_f32 v43, v130, v131
    s_lshl_b32 s52, s28, 2
    s_add_u32 s52, s52, s31
    s_lshl_b32 s52, s52, 2
    s_add_u32 s52, s52, 3
    s_lshl_b32 s52, s52, 2
    s_lshl_b32 s52, s52, 3
    s_add_u32 s52, s52, s63
    s_lshl_b32 s52, s52, 11
    s_add_u32 s52, s52, 33554432
    buffer_store_dwordx4 v[40:43], v6, s[44:47], s52 offen sc1
    s_waitcnt vmcnt(0)
    s_barrier
    s_cmp_eq_u32 s32, 0
    s_cbranch_scc0 .Lk1w0_312
    s_lshl_b32 s56, s28, 2
    s_add_u32 s56, s56, s31
    s_lshl_b32 s56, s56, 7
    s_add_u32 s56, s56, 206848
    s_lshl_b32 s57, s30, 2
    s_add_u32 s56, s56, s57
    v_mov_b32 v8, 0x7f000000
    v_mov_b32 v9, 0
    v_cmp_eq_u32 vcc, 0, v1
    s_nop 1
    v_cndmask_b32 v8, v8, v9, vcc
    v_mov_b32 v9, 1
    buffer_store_dword v9, v8, s[44:47], s56 offen sc1
.Lk1w0_312:
    s_mov_b32 s36, s22
    s_mov_b32 s37, s23
    s_and_b32 s37, s37, 0xffff
    s_mov_b32 s38, 2359296
    s_mov_b32 s39, 0x20000
    v_and_b32 v16, 15, v1
    v_lshrrev_b32 v17, 4, v1
    s_lshl_b32 s53, s28, 3
    s_add_u32 s53, s53, s63
    s_lshl_b32 s53, s53, 4
    v_add_u32 v16, s53, v16
    v_mul_u32_u24 v16, 1152, v16
    v_and_b32 v18, 1, v17
    v_lshlrev_b32 v18, 5, v18
    v_lshrrev_b32 v19, 1, v17
    v_lshl_add_u32 v18, v19, 4, v18
    v_add_u32 v18, v18, v16
    v_lshl_add_u32 v19, v17, 3, v16
    s_mul_i32 s58, s31, 288
    s_cmp_eq_u32 s32, 0
    s_cbranch_scc0 .Lk1w0_313
    s_mov_b32 s94, 0x20000
.Lk1f4p_314:
    s_lshl_b32 s56, s28, 2
    s_add_u32 s56, s56, s31
    s_lshl_b32 s56, s56, 7
    s_add_u32 s56, s56, 206848
    v_mov_b32 v14, 0
    buffer_load_dwordx4 v[168:171], v14, s[44:47], s56 offen sc1
    s_waitcnt vmcnt(0)
    v_min_u32 v168, v168, v169
    v_min_u32 v170, v170, v171
    v_min_u32 v168, v168, v170
    s_nop 0
    v_readfirstlane_b32 s56, v168
    s_nop 1
    s_cmp_lg_u32 s56, 0
    s_cbranch_scc1 .Lk1f4pd_315
    s_sub_u32 s94, s94, 1
    s_cmp_eq_u32 s94, 0
    s_cbranch_scc1 .Lk1f4pd_315
    s_sleep 1
    s_branch .Lk1f4p_314
.Lk1f4pd_315:
.Lk1w0_313:
    s_barrier
    s_lshl_b32 s52, s28, 2
    s_add_u32 s52, s52, s31
    s_lshl_b32 s52, s52, 2
    s_lshl_b32 s52, s52, 2
    s_add_u32 s52, s52, 1
    s_lshl_b32 s52, s52, 3
    s_add_u32 s52, s52, s63
    s_lshl_b32 s52, s52, 11
    s_add_u32 s52, s52, 33554432
    buffer_load_dwordx4 v[184:187], v6, s[44:47], s52 offen sc1
    v_lshrrev_b32 v14, 1, v6
    buffer_load_dwordx2 v[188:189], v14, s[44:47], s52 offen offset:1024 sc1
    s_lshl_b32 s52, s28, 2
    s_add_u32 s52, s52, s31
    s_lshl_b32 s52, s52, 2
    s_lshl_b32 s52, s52, 2
    s_add_u32 s52, s52, 2
    s_lshl_b32 s52, s52, 3
    s_add_u32 s52, s52, s63
    s_lshl_b32 s52, s52, 11
    s_add_u32 s52, s52, 33554432
    buffer_load_dwordx4 v[192:195], v6, s[44:47], s52 offen sc1
    v_lshrrev_b32 v14, 1, v6
    buffer_load_dwordx2 v[196:197], v14, s[44:47], s52 offen offset:1024 sc1
    s_lshl_b32 s52, s28, 2
    s_add_u32 s52, s52, s31
    s_lshl_b32 s52, s52, 2
    s_lshl_b32 s52, s52, 2
    s_add_u32 s52, s52, 3
    s_lshl_b32 s52, s52, 3
    s_add_u32 s52, s52, s63
    s_lshl_b32 s52, s52, 11
    s_add_u32 s52, s52, 33554432
    buffer_load_dwordx4 v[200:203], v6, s[44:47], s52 offen sc1
    v_lshrrev_b32 v14, 1, v6
    buffer_load_dwordx2 v[204:205], v14, s[44:47], s52 offen offset:1024 sc1
    s_waitcnt vmcnt(4)
    v_lshlrev_b32 v20, 16, v184
    v_and_b32 v21, 0xffff0000, v184
    v_add_f32 v96, v96, v20
    v_add_f32 v97, v97, v21
    v_lshlrev_b32 v20, 16, v185
    v_and_b32 v21, 0xffff0000, v185
    v_add_f32 v98, v98, v20
    v_add_f32 v99, v99, v21
    v_lshlrev_b32 v20, 16, v186
    v_and_b32 v21, 0xffff0000, v186
    v_add_f32 v100, v100, v20
    v_add_f32 v101, v101, v21
    v_lshlrev_b32 v20, 16, v187
    v_and_b32 v21, 0xffff0000, v187
    v_add_f32 v102, v102, v20
    v_add_f32 v103, v103, v21
    v_lshlrev_b32 v20, 16, v188
    v_and_b32 v21, 0xffff0000, v188
    v_add_f32 v104, v104, v20
    v_add_f32 v105, v105, v21
    v_lshlrev_b32 v20, 16, v189
    v_and_b32 v21, 0xffff0000, v189
    v_add_f32 v106, v106, v20
    v_add_f32 v107, v107, v21
    s_waitcnt vmcnt(2)
    v_lshlrev_b32 v20, 16, v192
    v_and_b32 v21, 0xffff0000, v192
    v_add_f32 v96, v96, v20
    v_add_f32 v97, v97, v21
    v_lshlrev_b32 v20, 16, v193
    v_and_b32 v21, 0xffff0000, v193
    v_add_f32 v98, v98, v20
    v_add_f32 v99, v99, v21
    v_lshlrev_b32 v20, 16, v194
    v_and_b32 v21, 0xffff0000, v194
    v_add_f32 v100, v100, v20
    v_add_f32 v101, v101, v21
    v_lshlrev_b32 v20, 16, v195
    v_and_b32 v21, 0xffff0000, v195
    v_add_f32 v102, v102, v20
    v_add_f32 v103, v103, v21
    v_lshlrev_b32 v20, 16, v196
    v_and_b32 v21, 0xffff0000, v196
    v_add_f32 v104, v104, v20
    v_add_f32 v105, v105, v21
    v_lshlrev_b32 v20, 16, v197
    v_and_b32 v21, 0xffff0000, v197
    v_add_f32 v106, v106, v20
    v_add_f32 v107, v107, v21
    s_waitcnt vmcnt(0)
    v_lshlrev_b32 v20, 16, v200
    v_and_b32 v21, 0xffff0000, v200
    v_add_f32 v96, v96, v20
    v_add_f32 v97, v97, v21
    v_lshlrev_b32 v20, 16, v201
    v_and_b32 v21, 0xffff0000, v201
    v_add_f32 v98, v98, v20
    v_add_f32 v99, v99, v21
    v_lshlrev_b32 v20, 16, v202
    v_and_b32 v21, 0xffff0000, v202
    v_add_f32 v100, v100, v20
    v_add_f32 v101, v101, v21
    v_lshlrev_b32 v20, 16, v203
    v_and_b32 v21, 0xffff0000, v203
    v_add_f32 v102, v102, v20
    v_add_f32 v103, v103, v21
    v_lshlrev_b32 v20, 16, v204
    v_and_b32 v21, 0xffff0000, v204
    v_add_f32 v104, v104, v20
    v_add_f32 v105, v105, v21
    v_lshlrev_b32 v20, 16, v205
    v_and_b32 v21, 0xffff0000, v205
    v_add_f32 v106, v106, v20
    v_add_f32 v107, v107, v21
    v_mul_f32 v96, v96, v181
    v_mul_f32 v97, v97, v181
    v_mul_f32 v98, v98, v181
    v_mul_f32 v99, v99, v181
    v_mul_f32 v100, v100, v181
    v_mul_f32 v101, v101, v181
    v_mul_f32 v102, v102, v181
    v_mul_f32 v103, v103, v181
    v_mul_f32 v104, v104, v181
    v_mul_f32 v105, v105, v181
    v_mul_f32 v106, v106, v181
    v_mul_f32 v107, v107, v181
    v_cvt_pk_bf16_f32 v56, v96, v97
    v_cvt_pk_bf16_f32 v57, v98, v99
    v_cvt_pk_bf16_f32 v58, v100, v101
    v_cvt_pk_bf16_f32 v59, v102, v103
    s_nop 1
    v_permlane16_swap_b32 v56, v58
    s_nop 1
    v_permlane16_swap_b32 v57, v59
    s_nop 1
    s_add_u32 s54, s58, 0
    buffer_store_dwordx4 v[56:59], v18, s[36:39], s54 offen
    v_cvt_pk_bf16_f32 v60, v104, v105
    v_cvt_pk_bf16_f32 v61, v106, v107
    s_add_u32 s54, s58, 64
    buffer_store_dwordx2 v[60:61], v19, s[36:39], s54 offen
    s_branch .Lk1fj_311
.Lk1ks1_308:
    v_cvt_pk_bf16_f32 v24, v96, v97
    v_cvt_pk_bf16_f32 v25, v98, v99
    v_cvt_pk_bf16_f32 v26, v100, v101
    v_cvt_pk_bf16_f32 v27, v102, v103
    v_cvt_pk_bf16_f32 v28, v104, v105
    v_cvt_pk_bf16_f32 v29, v106, v107
    s_lshl_b32 s52, s28, 2
    s_add_u32 s52, s52, s31
    s_lshl_b32 s52, s52, 2
    s_lshl_b32 s52, s52, 2
    s_add_u32 s52, s52, 1
    s_lshl_b32 s52, s52, 3
    s_add_u32 s52, s52, s63
    s_lshl_b32 s52, s52, 11
    s_add_u32 s52, s52, 33554432
    buffer_store_dwordx4 v[24:27], v6, s[44:47], s52 offen sc1
    v_lshrrev_b32 v14, 1, v6
    buffer_store_dwordx2 v[28:29], v14, s[44:47], s52 offen offset:1024 sc1
    v_cvt_pk_bf16_f32 v32, v116, v117
    v_cvt_pk_bf16_f32 v33, v118, v119
    v_cvt_pk_bf16_f32 v34, v120, v121
    v_cvt_pk_bf16_f32 v35, v122, v123
    s_lshl_b32 s52, s28, 2
    s_add_u32 s52, s52, s31
    s_lshl_b32 s52, s52, 2
    s_add_u32 s52, s52, 2
    s_lshl_b32 s52, s52, 2
    s_add_u32 s52, s52, 1
    s_lshl_b32 s52, s52, 3
    s_add_u32 s52, s52, s63
    s_lshl_b32 s52, s52, 11
    s_add_u32 s52, s52, 33554432
    buffer_store_dwordx4 v[32:35], v6, s[44:47], s52 offen sc1
    v_cvt_pk_bf16_f32 v40, v124, v125
    v_cvt_pk_bf16_f32 v41, v126, v127
    v_cvt_pk_bf16_f32 v42, v128, v129
    v_cvt_pk_bf16_f32 v43, v130, v131
    s_lshl_b32 s52, s28, 2
    s_add_u32 s52, s52, s31
    s_lshl_b32 s52, s52, 2
    s_add_u32 s52, s52, 3
    s_lshl_b32 s52, s52, 2
    s_add_u32 s52, s52, 1
    s_lshl_b32 s52, s52, 3
    s_add_u32 s52, s52, s63
    s_lshl_b32 s52, s52, 11
    s_add_u32 s52, s52, 33554432
    buffer_store_dwordx4 v[40:43], v6, s[44:47], s52 offen sc1
    s_waitcnt vmcnt(0)
    s_barrier
    s_cmp_eq_u32 s32, 0
    s_cbranch_scc0 .Lk1w0_316
    s_lshl_b32 s56, s28, 2
    s_add_u32 s56, s56, s31
    s_lshl_b32 s56, s56, 7
    s_add_u32 s56, s56, 206848
    s_lshl_b32 s57, s30, 2
    s_add_u32 s56, s56, s57
    v_mov_b32 v8, 0x7f000000
    v_mov_b32 v9, 0
    v_cmp_eq_u32 vcc, 0, v1
    s_nop 1
    v_cndmask_b32 v8, v8, v9, vcc
    v_mov_b32 v9, 1
    buffer_store_dword v9, v8, s[44:47], s56 offen sc1
.Lk1w0_316:
    s_mov_b32 s36, s22
    s_mov_b32 s37, s23
    s_and_b32 s37, s37, 0xffff
    s_mov_b32 s38, 2359296
    s_mov_b32 s39, 0x20000
    v_and_b32 v16, 15, v1
    v_lshrrev_b32 v17, 4, v1
    s_lshl_b32 s53, s28, 3
    s_add_u32 s53, s53, s63
    s_lshl_b32 s53, s53, 4
    v_add_u32 v16, s53, v16
    v_mul_u32_u24 v16, 1152, v16
    v_and_b32 v18, 1, v17
    v_lshlrev_b32 v18, 5, v18
    v_lshrrev_b32 v19, 1, v17
    v_lshl_add_u32 v18, v19, 4, v18
    v_add_u32 v18, v18, v16
    v_lshl_add_u32 v19, v17, 3, v16
    s_mul_i32 s58, s31, 288
    s_cmp_eq_u32 s32, 0
    s_cbranch_scc0 .Lk1w0_317
    s_mov_b32 s94, 0x20000
.Lk1f4p_318:
    s_lshl_b32 s56, s28, 2
    s_add_u32 s56, s56, s31
    s_lshl_b32 s56, s56, 7
    s_add_u32 s56, s56, 206848
    v_mov_b32 v14, 0
    buffer_load_dwordx4 v[168:171], v14, s[44:47], s56 offen sc1
    s_waitcnt vmcnt(0)
    v_min_u32 v168, v168, v169
    v_min_u32 v170, v170, v171
    v_min_u32 v168, v168, v170
    s_nop 0
    v_readfirstlane_b32 s56, v168
    s_nop 1
    s_cmp_lg_u32 s56, 0
    s_cbranch_scc1 .Lk1f4pd_319
    s_sub_u32 s94, s94, 1
    s_cmp_eq_u32 s94, 0
    s_cbranch_scc1 .Lk1f4pd_319
    s_sleep 1
    s_branch .Lk1f4p_318
.Lk1f4pd_319:
.Lk1w0_317:
    s_barrier
    s_lshl_b32 s52, s28, 2
    s_add_u32 s52, s52, s31
    s_lshl_b32 s52, s52, 2
    s_add_u32 s52, s52, 1
    s_lshl_b32 s52, s52, 2
    s_lshl_b32 s52, s52, 3
    s_add_u32 s52, s52, s63
    s_lshl_b32 s52, s52, 11
    s_add_u32 s52, s52, 33554432
    buffer_load_dwordx4 v[184:187], v6, s[44:47], s52 offen sc1
    s_lshl_b32 s52, s28, 2
    s_add_u32 s52, s52, s31
    s_lshl_b32 s52, s52, 2
    s_add_u32 s52, s52, 1
    s_lshl_b32 s52, s52, 2
    s_add_u32 s52, s52, 2
    s_lshl_b32 s52, s52, 3
    s_add_u32 s52, s52, s63
    s_lshl_b32 s52, s52, 11
    s_add_u32 s52, s52, 33554432
    buffer_load_dwordx4 v[192:195], v6, s[44:47], s52 offen sc1
    s_lshl_b32 s52, s28, 2
    s_add_u32 s52, s52, s31
    s_lshl_b32 s52, s52, 2
    s_add_u32 s52, s52, 1
    s_lshl_b32 s52, s52, 2
    s_add_u32 s52, s52, 3
    s_lshl_b32 s52, s52, 3
    s_add_u32 s52, s52, s63
    s_lshl_b32 s52, s52, 11
    s_add_u32 s52, s52, 33554432
    buffer_load_dwordx4 v[200:203], v6, s[44:47], s52 offen sc1
    s_waitcnt vmcnt(2)
    v_lshlrev_b32 v20, 16, v184
    v_and_b32 v21, 0xffff0000, v184
    v_add_f32 v108, v108, v20
    v_add_f32 v109, v109, v21
    v_lshlrev_b32 v20, 16, v185
    v_and_b32 v21, 0xffff0000, v185
    v_add_f32 v110, v110, v20
    v_add_f32 v111, v111, v21
    v_lshlrev_b32 v20, 16, v186
    v_and_b32 v21, 0xffff0000, v186
    v_add_f32 v112, v112, v20
    v_add_f32 v113, v113, v21
    v_lshlrev_b32 v20, 16, v187
    v_and_b32 v21, 0xffff0000, v187
    v_add_f32 v114, v114, v20
    v_add_f32 v115, v115, v21
    s_waitcnt vmcnt(1)
    v_lshlrev_b32 v20, 16, v192
    v_and_b32 v21, 0xffff0000, v192
    v_add_f32 v108, v108, v20
    v_add_f32 v109, v109, v21
    v_lshlrev_b32 v20, 16, v193
    v_and_b32 v21, 0xffff0000, v193
    v_add_f32 v110, v110, v20
    v_add_f32 v111, v111, v21
    v_lshlrev_b32 v20, 16, v194
    v_and_b32 v21, 0xffff0000, v194
    v_add_f32 v112, v112, v20
    v_add_f32 v113, v113, v21
    v_lshlrev_b32 v20, 16, v195
    v_and_b32 v21, 0xffff0000, v195
    v_add_f32 v114, v114, v20
    v_add_f32 v115, v115, v21
    s_waitcnt vmcnt(0)
    v_lshlrev_b32 v20, 16, v200
    v_and_b32 v21, 0xffff0000, v200
    v_add_f32 v108, v108, v20
    v_add_f32 v109, v109, v21
    v_lshlrev_b32 v20, 16, v201
    v_and_b32 v21, 0xffff0000, v201
    v_add_f32 v110, v110, v20
    v_add_f32 v111, v111, v21
    v_lshlrev_b32 v20, 16, v202
    v_and_b32 v21, 0xffff0000, v202
    v_add_f32 v112, v112, v20
    v_add_f32 v113, v113, v21
    v_lshlrev_b32 v20, 16, v203
    v_and_b32 v21, 0xffff0000, v203
    v_add_f32 v114, v114, v20
    v_add_f32 v115, v115, v21
    v_mul_f32 v108, v108, v181
    v_mul_f32 v109, v109, v181
    v_mul_f32 v110, v110, v181
    v_mul_f32 v111, v111, v181
    v_mul_f32 v112, v112, v181
    v_mul_f32 v113, v113, v181
    v_mul_f32 v114, v114, v181
    v_mul_f32 v115, v115, v181
    v_cvt_pk_bf16_f32 v56, v108, v109
    v_cvt_pk_bf16_f32 v57, v110, v111
    v_cvt_pk_bf16_f32 v58, v112, v113
    v_cvt_pk_bf16_f32 v59, v114, v115
    s_nop 1
    v_permlane16_swap_b32 v56, v58
    s_nop 1
    v_permlane16_swap_b32 v57, v59
    s_nop 1
    s_add_u32 s54, s58, 96
    buffer_store_dwordx4 v[56:59], v18, s[36:39], s54 offen
    s_branch .Lk1fj_311
.Lk1ks2_309:
    v_cvt_pk_bf16_f32 v24, v96, v97
    v_cvt_pk_bf16_f32 v25, v98, v99
    v_cvt_pk_bf16_f32 v26, v100, v101
    v_cvt_pk_bf16_f32 v27, v102, v103
    v_cvt_pk_bf16_f32 v28, v104, v105
    v_cvt_pk_bf16_f32 v29, v106, v107
    s_lshl_b32 s52, s28, 2
    s_add_u32 s52, s52, s31
    s_lshl_b32 s52, s52, 2
    s_lshl_b32 s52, s52, 2
    s_add_u32 s52, s52, 2
    s_lshl_b32 s52, s52, 3
    s_add_u32 s52, s52, s63
    s_lshl_b32 s52, s52, 11
    s_add_u32 s52, s52, 33554432
    buffer_store_dwordx4 v[24:27], v6, s[44:47], s52 offen sc1
    v_lshrrev_b32 v14, 1, v6
    buffer_store_dwordx2 v[28:29], v14, s[44:47], s52 offen offset:1024 sc1
    v_cvt_pk_bf16_f32 v32, v108, v109
    v_cvt_pk_bf16_f32 v33, v110, v111
    v_cvt_pk_bf16_f32 v34, v112, v113
    v_cvt_pk_bf16_f32 v35, v114, v115
    s_lshl_b32 s52, s28, 2
    s_add_u32 s52, s52, s31
    s_lshl_b32 s52, s52, 2
    s_add_u32 s52, s52, 1
    s_lshl_b32 s52, s52, 2
    s_add_u32 s52, s52, 2
    s_lshl_b32 s52, s52, 3
    s_add_u32 s52, s52, s63
    s_lshl_b32 s52, s52, 11
    s_add_u32 s52, s52, 33554432
    buffer_store_dwordx4 v[32:35], v6, s[44:47], s52 offen sc1
    v_cvt_pk_bf16_f32 v40, v124, v125
    v_cvt_pk_bf16_f32 v41, v126, v127
    v_cvt_pk_bf16_f32 v42, v128, v129
    v_cvt_pk_bf16_f32 v43, v130, v131
    s_lshl_b32 s52, s28, 2
    s_add_u32 s52, s52, s31
    s_lshl_b32 s52, s52, 2
    s_add_u32 s52, s52, 3
    s_lshl_b32 s52, s52, 2
    s_add_u32 s52, s52, 2
    s_lshl_b32 s52, s52, 3
    s_add_u32 s52, s52, s63
    s_lshl_b32 s52, s52, 11
    s_add_u32 s52, s52, 33554432
    buffer_store_dwordx4 v[40:43], v6, s[44:47], s52 offen sc1
    s_waitcnt vmcnt(0)
    s_barrier
    s_cmp_eq_u32 s32, 0
    s_cbranch_scc0 .Lk1w0_320
    s_lshl_b32 s56, s28, 2
    s_add_u32 s56, s56, s31
    s_lshl_b32 s56, s56, 7
    s_add_u32 s56, s56, 206848
    s_lshl_b32 s57, s30, 2
    s_add_u32 s56, s56, s57
    v_mov_b32 v8, 0x7f000000
    v_mov_b32 v9, 0
    v_cmp_eq_u32 vcc, 0, v1
    s_nop 1
    v_cndmask_b32 v8, v8, v9, vcc
    v_mov_b32 v9, 1
    buffer_store_dword v9, v8, s[44:47], s56 offen sc1
.Lk1w0_320:
    s_mov_b32 s36, s22
    s_mov_b32 s37, s23
    s_and_b32 s37, s37, 0xffff
    s_mov_b32 s38, 2359296
    s_mov_b32 s39, 0x20000
    v_and_b32 v16, 15, v1
    v_lshrrev_b32 v17, 4, v1
    s_lshl_b32 s53, s28, 3
    s_add_u32 s53, s53, s63
    s_lshl_b32 s53, s53, 4
    v_add_u32 v16, s53, v16
    v_mul_u32_u24 v16, 1152, v16
    v_and_b32 v18, 1, v17
    v_lshlrev_b32 v18, 5, v18
    v_lshrrev_b32 v19, 1, v17
    v_lshl_add_u32 v18, v19, 4, v18
    v_add_u32 v18, v18, v16
    v_lshl_add_u32 v19, v17, 3, v16
    s_mul_i32 s58, s31, 288
    s_cmp_eq_u32 s32, 0
    s_cbranch_scc0 .Lk1w0_321
    s_mov_b32 s94, 0x20000
.Lk1f4p_322:
    s_lshl_b32 s56, s28, 2
    s_add_u32 s56, s56, s31
    s_lshl_b32 s56, s56, 7
    s_add_u32 s56, s56, 206848
    v_mov_b32 v14, 0
    buffer_load_dwordx4 v[168:171], v14, s[44:47], s56 offen sc1
    s_waitcnt vmcnt(0)
    v_min_u32 v168, v168, v169
    v_min_u32 v170, v170, v171
    v_min_u32 v168, v168, v170
    s_nop 0
    v_readfirstlane_b32 s56, v168
    s_nop 1
    s_cmp_lg_u32 s56, 0
    s_cbranch_scc1 .Lk1f4pd_323
    s_sub_u32 s94, s94, 1
    s_cmp_eq_u32 s94, 0
    s_cbranch_scc1 .Lk1f4pd_323
    s_sleep 1
    s_branch .Lk1f4p_322
.Lk1f4pd_323:
.Lk1w0_321:
    s_barrier
    s_lshl_b32 s52, s28, 2
    s_add_u32 s52, s52, s31
    s_lshl_b32 s52, s52, 2
    s_add_u32 s52, s52, 2
    s_lshl_b32 s52, s52, 2
    s_lshl_b32 s52, s52, 3
    s_add_u32 s52, s52, s63
    s_lshl_b32 s52, s52, 11
    s_add_u32 s52, s52, 33554432
    buffer_load_dwordx4 v[184:187], v6, s[44:47], s52 offen sc1
    s_lshl_b32 s52, s28, 2
    s_add_u32 s52, s52, s31
    s_lshl_b32 s52, s52, 2
    s_add_u32 s52, s52, 2
    s_lshl_b32 s52, s52, 2
    s_add_u32 s52, s52, 1
    s_lshl_b32 s52, s52, 3
    s_add_u32 s52, s52, s63
    s_lshl_b32 s52, s52, 11
    s_add_u32 s52, s52, 33554432
    buffer_load_dwordx4 v[192:195], v6, s[44:47], s52 offen sc1
    s_lshl_b32 s52, s28, 2
    s_add_u32 s52, s52, s31
    s_lshl_b32 s52, s52, 2
    s_add_u32 s52, s52, 2
    s_lshl_b32 s52, s52, 2
    s_add_u32 s52, s52, 3
    s_lshl_b32 s52, s52, 3
    s_add_u32 s52, s52, s63
    s_lshl_b32 s52, s52, 11
    s_add_u32 s52, s52, 33554432
    buffer_load_dwordx4 v[200:203], v6, s[44:47], s52 offen sc1
    s_waitcnt vmcnt(2)
    v_lshlrev_b32 v20, 16, v184
    v_and_b32 v21, 0xffff0000, v184
    v_add_f32 v116, v116, v20
    v_add_f32 v117, v117, v21
    v_lshlrev_b32 v20, 16, v185
    v_and_b32 v21, 0xffff0000, v185
    v_add_f32 v118, v118, v20
    v_add_f32 v119, v119, v21
    v_lshlrev_b32 v20, 16, v186
    v_and_b32 v21, 0xffff0000, v186
    v_add_f32 v120, v120, v20
    v_add_f32 v121, v121, v21
    v_lshlrev_b32 v20, 16, v187
    v_and_b32 v21, 0xffff0000, v187
    v_add_f32 v122, v122, v20
    v_add_f32 v123, v123, v21
    s_waitcnt vmcnt(1)
    v_lshlrev_b32 v20, 16, v192
    v_and_b32 v21, 0xffff0000, v192
    v_add_f32 v116, v116, v20
    v_add_f32 v117, v117, v21
    v_lshlrev_b32 v20, 16, v193
    v_and_b32 v21, 0xffff0000, v193
    v_add_f32 v118, v118, v20
    v_add_f32 v119, v119, v21
    v_lshlrev_b32 v20, 16, v194
    v_and_b32 v21, 0xffff0000, v194
    v_add_f32 v120, v120, v20
    v_add_f32 v121, v121, v21
    v_lshlrev_b32 v20, 16, v195
    v_and_b32 v21, 0xffff0000, v195
    v_add_f32 v122, v122, v20
    v_add_f32 v123, v123, v21
    s_waitcnt vmcnt(0)
    v_lshlrev_b32 v20, 16, v200
    v_and_b32 v21, 0xffff0000, v200
    v_add_f32 v116, v116, v20
    v_add_f32 v117, v117, v21
    v_lshlrev_b32 v20, 16, v201
    v_and_b32 v21, 0xffff0000, v201
    v_add_f32 v118, v118, v20
    v_add_f32 v119, v119, v21
    v_lshlrev_b32 v20, 16, v202
    v_and_b32 v21, 0xffff0000, v202
    v_add_f32 v120, v120, v20
    v_add_f32 v121, v121, v21
    v_lshlrev_b32 v20, 16, v203
    v_and_b32 v21, 0xffff0000, v203
    v_add_f32 v122, v122, v20
    v_add_f32 v123, v123, v21
    v_mul_f32 v116, v116, v181
    v_mul_f32 v117, v117, v181
    v_mul_f32 v118, v118, v181
    v_mul_f32 v119, v119, v181
    v_mul_f32 v120, v120, v181
    v_mul_f32 v121, v121, v181
    v_mul_f32 v122, v122, v181
    v_mul_f32 v123, v123, v181
    v_cvt_pk_bf16_f32 v56, v116, v117
    v_cvt_pk_bf16_f32 v57, v118, v119
    v_cvt_pk_bf16_f32 v58, v120, v121
    v_cvt_pk_bf16_f32 v59, v122, v123
    s_nop 1
    v_permlane16_swap_b32 v56, v58
    s_nop 1
    v_permlane16_swap_b32 v57, v59
    s_nop 1
    s_add_u32 s54, s58, 160
    buffer_store_dwordx4 v[56:59], v18, s[36:39], s54 offen
    s_branch .Lk1fj_311
.Lk1ks3_310:
    v_cvt_pk_bf16_f32 v24, v96, v97
    v_cvt_pk_bf16_f32 v25, v98, v99
    v_cvt_pk_bf16_f32 v26, v100, v101
    v_cvt_pk_bf16_f32 v27, v102, v103
    v_cvt_pk_bf16_f32 v28, v104, v105
    v_cvt_pk_bf16_f32 v29, v106, v107
    s_lshl_b32 s52, s28, 2
    s_add_u32 s52, s52, s31
    s_lshl_b32 s52, s52, 2
    s_lshl_b32 s52, s52, 2
    s_add_u32 s52, s52, 3
    s_lshl_b32 s52, s52, 3
    s_add_u32 s52, s52, s63
    s_lshl_b32 s52, s52, 11
    s_add_u32 s52, s52, 33554432
    buffer_store_dwordx4 v[24:27], v6, s[44:47], s52 offen sc1
    v_lshrrev_b32 v14, 1, v6
    buffer_store_dwordx2 v[28:29], v14, s[44:47], s52 offen offset:1024 sc1
    v_cvt_pk_bf16_f32 v32, v108, v109
    v_cvt_pk_bf16_f32 v33, v110, v111
    v_cvt_pk_bf16_f32 v34, v112, v113
    v_cvt_pk_bf16_f32 v35, v114, v115
    s_lshl_b32 s52, s28, 2
    s_add_u32 s52, s52, s31
    s_lshl_b32 s52, s52, 2
    s_add_u32 s52, s52, 1
    s_lshl_b32 s52, s52, 2
    s_add_u32 s52, s52, 3
    s_lshl_b32 s52, s52, 3
    s_add_u32 s52, s52, s63
    s_lshl_b32 s52, s52, 11
    s_add_u32 s52, s52, 33554432
    buffer_store_dwordx4 v[32:35], v6, s[44:47], s52 offen sc1
    v_cvt_pk_bf16_f32 v40, v116, v117
    v_cvt_pk_bf16_f32 v41, v118, v119
    v_cvt_pk_bf16_f32 v42, v120, v121
    v_cvt_pk_bf16_f32 v43, v122, v123
    s_lshl_b32 s52, s28, 2
    s_add_u32 s52, s52, s31
    s_lshl_b32 s52, s52, 2
    s_add_u32 s52, s52, 2
    s_lshl_b32 s52, s52, 2
    s_add_u32 s52, s52, 3
    s_lshl_b32 s52, s52, 3
    s_add_u32 s52, s52, s63
    s_lshl_b32 s52, s52, 11
    s_add_u32 s52, s52, 33554432
    buffer_store_dwordx4 v[40:43], v6, s[44:47], s52 offen sc1
    s_waitcnt vmcnt(0)
    s_barrier
    s_cmp_eq_u32 s32, 0
    s_cbranch_scc0 .Lk1w0_324
    s_lshl_b32 s56, s28, 2
    s_add_u32 s56, s56, s31
    s_lshl_b32 s56, s56, 7
    s_add_u32 s56, s56, 206848
    s_lshl_b32 s57, s30, 2
    s_add_u32 s56, s56, s57
    v_mov_b32 v8, 0x7f000000
    v_mov_b32 v9, 0
    v_cmp_eq_u32 vcc, 0, v1
    s_nop 1
    v_cndmask_b32 v8, v8, v9, vcc
    v_mov_b32 v9, 1
    buffer_store_dword v9, v8, s[44:47], s56 offen sc1
.Lk1w0_324:
    s_mov_b32 s36, s22
    s_mov_b32 s37, s23
    s_and_b32 s37, s37, 0xffff
    s_mov_b32 s38, 2359296
    s_mov_b32 s39, 0x20000
    v_and_b32 v16, 15, v1
    v_lshrrev_b32 v17, 4, v1
    s_lshl_b32 s53, s28, 3
    s_add_u32 s53, s53, s63
    s_lshl_b32 s53, s53, 4
    v_add_u32 v16, s53, v16
    v_mul_u32_u24 v16, 1152, v16
    v_and_b32 v18, 1, v17
    v_lshlrev_b32 v18, 5, v18
    v_lshrrev_b32 v19, 1, v17
    v_lshl_add_u32 v18, v19, 4, v18
    v_add_u32 v18, v18, v16
    v_lshl_add_u32 v19, v17, 3, v16
    s_mul_i32 s58, s31, 288
    s_cmp_eq_u32 s32, 0
    s_cbranch_scc0 .Lk1w0_325
    s_mov_b32 s94, 0x20000
.Lk1f4p_326:
    s_lshl_b32 s56, s28, 2
    s_add_u32 s56, s56, s31
    s_lshl_b32 s56, s56, 7
    s_add_u32 s56, s56, 206848
    v_mov_b32 v14, 0
    buffer_load_dwordx4 v[168:171], v14, s[44:47], s56 offen sc1
    s_waitcnt vmcnt(0)
    v_min_u32 v168, v168, v169
    v_min_u32 v170, v170, v171
    v_min_u32 v168, v168, v170
    s_nop 0
    v_readfirstlane_b32 s56, v168
    s_nop 1
    s_cmp_lg_u32 s56, 0
    s_cbranch_scc1 .Lk1f4pd_327
    s_sub_u32 s94, s94, 1
    s_cmp_eq_u32 s94, 0
    s_cbranch_scc1 .Lk1f4pd_327
    s_sleep 1
    s_branch .Lk1f4p_326
.Lk1f4pd_327:
.Lk1w0_325:
    s_barrier
    s_lshl_b32 s52, s28, 2
    s_add_u32 s52, s52, s31
    s_lshl_b32 s52, s52, 2
    s_add_u32 s52, s52, 3
    s_lshl_b32 s52, s52, 2
    s_lshl_b32 s52, s52, 3
    s_add_u32 s52, s52, s63
    s_lshl_b32 s52, s52, 11
    s_add_u32 s52, s52, 33554432
    buffer_load_dwordx4 v[184:187], v6, s[44:47], s52 offen sc1
    s_lshl_b32 s52, s28, 2
    s_add_u32 s52, s52, s31
    s_lshl_b32 s52, s52, 2
    s_add_u32 s52, s52, 3
    s_lshl_b32 s52, s52, 2
    s_add_u32 s52, s52, 1
    s_lshl_b32 s52, s52, 3
    s_add_u32 s52, s52, s63
    s_lshl_b32 s52, s52, 11
    s_add_u32 s52, s52, 33554432
    buffer_load_dwordx4 v[192:195], v6, s[44:47], s52 offen sc1
    s_lshl_b32 s52, s28, 2
    s_add_u32 s52, s52, s31
    s_lshl_b32 s52, s52, 2
    s_add_u32 s52, s52, 3
    s_lshl_b32 s52, s52, 2
    s_add_u32 s52, s52, 2
    s_lshl_b32 s52, s52, 3
    s_add_u32 s52, s52, s63
    s_lshl_b32 s52, s52, 11
    s_add_u32 s52, s52, 33554432
    buffer_load_dwordx4 v[200:203], v6, s[44:47], s52 offen sc1
    s_waitcnt vmcnt(2)
    v_lshlrev_b32 v20, 16, v184
    v_and_b32 v21, 0xffff0000, v184
    v_add_f32 v124, v124, v20
    v_add_f32 v125, v125, v21
    v_lshlrev_b32 v20, 16, v185
    v_and_b32 v21, 0xffff0000, v185
    v_add_f32 v126, v126, v20
    v_add_f32 v127, v127, v21
    v_lshlrev_b32 v20, 16, v186
    v_and_b32 v21, 0xffff0000, v186
    v_add_f32 v128, v128, v20
    v_add_f32 v129, v129, v21
    v_lshlrev_b32 v20, 16, v187
    v_and_b32 v21, 0xffff0000, v187
    v_add_f32 v130, v130, v20
    v_add_f32 v131, v131, v21
    s_waitcnt vmcnt(1)
    v_lshlrev_b32 v20, 16, v192
    v_and_b32 v21, 0xffff0000, v192
    v_add_f32 v124, v124, v20
    v_add_f32 v125, v125, v21
    v_lshlrev_b32 v20, 16, v193
    v_and_b32 v21, 0xffff0000, v193
    v_add_f32 v126, v126, v20
    v_add_f32 v127, v127, v21
    v_lshlrev_b32 v20, 16, v194
    v_and_b32 v21, 0xffff0000, v194
    v_add_f32 v128, v128, v20
    v_add_f32 v129, v129, v21
    v_lshlrev_b32 v20, 16, v195
    v_and_b32 v21, 0xffff0000, v195
    v_add_f32 v130, v130, v20
    v_add_f32 v131, v131, v21
    s_waitcnt vmcnt(0)
    v_lshlrev_b32 v20, 16, v200
    v_and_b32 v21, 0xffff0000, v200
    v_add_f32 v124, v124, v20
    v_add_f32 v125, v125, v21
    v_lshlrev_b32 v20, 16, v201
    v_and_b32 v21, 0xffff0000, v201
    v_add_f32 v126, v126, v20
    v_add_f32 v127, v127, v21
    v_lshlrev_b32 v20, 16, v202
    v_and_b32 v21, 0xffff0000, v202
    v_add_f32 v128, v128, v20
    v_add_f32 v129, v129, v21
    v_lshlrev_b32 v20, 16, v203
    v_and_b32 v21, 0xffff0000, v203
    v_add_f32 v130, v130, v20
    v_add_f32 v131, v131, v21
    v_mul_f32 v124, v124, v181
    v_mul_f32 v125, v125, v181
    v_mul_f32 v126, v126, v181
    v_mul_f32 v127, v127, v181
    v_mul_f32 v128, v128, v181
    v_mul_f32 v129, v129, v181
    v_mul_f32 v130, v130, v181
    v_mul_f32 v131, v131, v181
    v_cvt_pk_bf16_f32 v56, v124, v125
    v_cvt_pk_bf16_f32 v57, v126, v127
    v_cvt_pk_bf16_f32 v58, v128, v129
    v_cvt_pk_bf16_f32 v59, v130, v131
    s_nop 1
    v_permlane16_swap_b32 v56, v58
    s_nop 1
    v_permlane16_swap_b32 v57, v59
    s_nop 1
    s_add_u32 s54, s58, 224
    buffer_store_dwordx4 v[56:59], v18, s[36:39], s54 offen
.Lk1fj_311:
    s_endpgm
.Lcode_end:
.Lk1redo_201:
    s_waitcnt vmcnt(0) lgkmcnt(0)
    s_barrier
    s_add_u32 m0, s68, 0
    s_add_u32 s69, s68, 0
    buffer_load_dwordx4 v6, s[44:47], s69 offen sc1 lds
    s_add_u32 m0, s68, 32768
    s_add_u32 s69, s68, 32768
    buffer_load_dwordx4 v6, s[44:47], s69 offen sc1 lds
    s_add_u32 m0, s68, 40960
    s_add_u32 s69, s68, 40960
    buffer_load_dwordx4 v6, s[44:47], s69 offen sc1 lds
    s_add_u32 m0, s68, 65536
    s_add_u32 s69, s68, 65536
    buffer_load_dwordx4 v6, s[44:47], s69 offen sc1 lds
    s_add_u32 m0, s68, 73728
    s_add_u32 s69, s68, 73728
    buffer_load_dwordx4 v6, s[44:47], s69 offen sc1 lds
    s_add_u32 m0, s68, 114688
    s_add_u32 s69, s68, 114688
    buffer_load_dwordx4 v6, s[44:47], s69 offen sc1 lds
    s_add_u32 m0, s68, 122880
    s_add_u32 s69, s68, 122880
    buffer_load_dwordx4 v6, s[44:47], s69 offen sc1 lds
    s_add_u32 m0, s68, 8192
    s_add_u32 s69, s68, 8192
    buffer_load_dwordx4 v6, s[44:47], s69 offen sc1 lds
    s_add_u32 m0, s68, 81920
    s_add_u32 s69, s68, 81920
    buffer_load_dwordx4 v6, s[44:47], s69 offen sc1 lds
    s_add_u32 m0, s68, 131072
    s_add_u32 s69, s68, 131072
    buffer_load_dwordx4 v6, s[44:47], s69 offen sc1 lds
    s_add_u32 m0, s68, 49152
    s_add_u32 s69, s68, 49152
    buffer_load_dwordx4 v6, s[44:47], s69 offen sc1 lds
    s_add_u32 m0, s68, 16384
    s_add_u32 s69, s68, 16384
    buffer_load_dwordx4 v6, s[44:47], s69 offen sc1 lds
    s_add_u32 m0, s68, 90112
    s_add_u32 s69, s68, 90112
    buffer_load_dwordx4 v6, s[44:47], s69 offen sc1 lds
    s_add_u32 m0, s68, 139264
    s_add_u32 s69, s68, 139264
    buffer_load_dwordx4 v6, s[44:47], s69 offen sc1 lds
    s_add_u32 m0, s68, 57344
    s_add_u32 s69, s68, 57344
    buffer_load_dwordx4 v6, s[44:47], s69 offen sc1 lds
    s_add_u32 m0, s68, 24576
    s_add_u32 s69, s68, 24576
    buffer_load_dwordx4 v6, s[44:47], s69 offen sc1 lds
    s_add_u32 m0, s68, 98304
    s_add_u32 s69, s68, 98304
    buffer_load_dwordx4 v6, s[44:47], s69 offen sc1 lds
    s_add_u32 m0, s68, 147456
    s_add_u32 s69, s68, 147456
    buffer_load_dwordx4 v6, s[44:47], s69 offen sc1 lds
    s_add_u32 m0, s68, 106496
    s_add_u32 s69, s68, 106496
    buffer_load_dwordx4 v6, s[44:47], s69 offen sc1 lds
    s_cmp_lt_u32 s32, 4
    s_cbranch_scc0 .Lk1kvs_328
    s_add_u32 m0, s68, 155648
    s_add_u32 s69, s68, 155648
    buffer_load_dwordx4 v6, s[44:47], s69 offen sc1 lds
.Lk1kvs_328:
    v_lshlrev_b32 v2, 4, v1
    s_mul_i32 s52, s34, 36864
    v_add_u32 v2, s52, v2
    v_and_b32 v9, 31, v1
    v_lshlrev_b32 v3, 2, v9
    s_mul_i32 s52, s34, 4608
    s_add_u32 s52, s52, 65536
    v_add_u32 v3, s52, v3
    v_mov_b32 v10, v9
    v_mov_b32 v11, 20
    v_cmp_le_u32 vcc, 20, v9
    s_nop 1
    v_cndmask_b32 v10, v10, v11, vcc
    v_mov_b32 v11, 19
    v_cmp_le_u32 vcc, 28, v9
    s_nop 1
    v_cndmask_b32 v10, v10, v11, vcc
    v_lshlrev_b32 v10, 4, v10
    v_lshrrev_b32 v11, 5, v1
    v_mul_u32_u24 v11, 336, v11
    v_add_u32 v4, v10, v11
    s_mul_i32 s52, s34, 48384
    s_add_u32 s52, s52, 73728
    v_add_u32 v4, s52, v4
    v_cmp_gt_u32 vcc, 32, v1
    v_mov_b32 v10, 0
    v_mov_b32 v11, 0x3f803f80
    v_mov_b32 v12, 0x3f80
    v_cndmask_b32 v121, v10, v11, vcc
    v_cndmask_b32 v122, v10, v12, vcc
    v_mov_b32 v123, 0
    v_cndmask_b32 v125, v10, v11, vcc
    v_cndmask_b32 v126, v10, v12, vcc
    v_mov_b32 v127, 0
    v_mov_b32 v33, 0
    v_mov_b32 v34, 0
    v_mov_b32 v16, 0xff800000
    v_mov_b32 v37, 0
    v_mov_b32 v38, 0
    v_mov_b32 v17, 0xff800000
    s_waitcnt vmcnt(0)
    s_barrier
    s_mul_i32 s60, s34, 8
    s_sub_u32 s60, 36, s60
.Lk1mx_329:
    ds_read_b128 v[112:115], v2
    ds_read_b32 v120, v3
    s_waitcnt lgkmcnt(0)
    v_mfma_f32_32x32x16_bf16 v[40:55], v[112:115], v[24:27], 0
    v_mfma_f32_32x32x16_bf16 v[40:55], v[120:123], v[32:35], v[40:55]
    v_mfma_f32_32x32x16_bf16 v[56:71], v[112:115], v[28:31], 0
    v_mfma_f32_32x32x16_bf16 v[56:71], v[120:123], v[36:39], v[56:71]
    s_nop 7
    s_nop 7
    v_max3_f32 v16, v16, v40, v41
    v_max3_f32 v16, v16, v42, v43
    v_max3_f32 v16, v16, v44, v45
    v_max3_f32 v16, v16, v46, v47
    v_max3_f32 v16, v16, v48, v49
    v_max3_f32 v16, v16, v50, v51
    v_max3_f32 v16, v16, v52, v53
    v_max3_f32 v16, v16, v54, v55
    v_max3_f32 v17, v17, v56, v57
    v_max3_f32 v17, v17, v58, v59
    v_max3_f32 v17, v17, v60, v61
    v_max3_f32 v17, v17, v62, v63
    v_max3_f32 v17, v17, v64, v65
    v_max3_f32 v17, v17, v66, v67
    v_max3_f32 v17, v17, v68, v69
    v_max3_f32 v17, v17, v70, v71
    v_add_u32 v2, 1024, v2
    v_add_u32 v3, 128, v3
    s_sub_u32 s60, s60, 1
    s_cmp_lg_u32 s60, 0
    s_cbranch_scc1 .Lk1mx_329
    v_and_b32 v9, 31, v1
    v_lshlrev_b32 v9, 2, v9
    s_lshl_b32 s52, s32, 8
    s_add_u32 s52, s52, 159872
    v_add_u32 v10, s52, v9
    s_xor_b32 s52, s32, 4
    s_lshl_b32 s52, s52, 8
    s_add_u32 s52, s52, 159872
    v_add_u32 v11, s52, v9
    v_mov_b32 v9, v16
    s_nop 1
    v_permlane32_swap_b32 v16, v9
    s_nop 1
    v_max_f32 v16, v16, v9
    ds_write_b32 v10, v16 offset:0
    v_mov_b32 v9, v17
    s_nop 1
    v_permlane32_swap_b32 v17, v9
    s_nop 1
    v_max_f32 v17, v17, v9
    ds_write_b32 v10, v17 offset:128
    s_waitcnt lgkmcnt(0)
    s_barrier
    ds_read_b32 v18, v11 offset:0
    ds_read_b32 v19, v11 offset:128
    s_waitcnt lgkmcnt(0)
    v_cmp_gt_u32 vcc, 32, v1
    v_max_f32 v16, v16, v18
    v_sub_f32 v16, 0, v16
    v_cvt_pk_bf16_f32 v12, v16, v16
    v_lshlrev_b32 v13, 16, v12
    v_sub_f32 v14, v16, v13
    v_cvt_pk_bf16_f32 v12, v16, v14
    v_and_b32 v13, 0xffff0000, v12
    v_sub_f32 v14, v14, v13
    v_mov_b32 v15, 0
    v_cvt_pk_bf16_f32 v13, v14, v15
    v_cndmask_b32 v33, v15, v12, vcc
    v_cndmask_b32 v34, v15, v13, vcc
    v_max_f32 v17, v17, v19
    v_sub_f32 v17, 0, v17
    v_cvt_pk_bf16_f32 v12, v17, v17
    v_lshlrev_b32 v13, 16, v12
    v_sub_f32 v14, v17, v13
    v_cvt_pk_bf16_f32 v12, v17, v14
    v_and_b32 v13, 0xffff0000, v12
    v_sub_f32 v14, v14, v13
    v_mov_b32 v15, 0
    v_cvt_pk_bf16_f32 v13, v14, v15
    v_cndmask_b32 v37, v15, v12, vcc
    v_cndmask_b32 v38, v15, v13, vcc
    v_lshlrev_b32 v2, 4, v1
    s_mul_i32 s52, s34, 36864
    v_add_u32 v2, s52, v2
    v_and_b32 v9, 31, v1
    v_lshlrev_b32 v3, 2, v9
    s_mul_i32 s52, s34, 4608
    s_add_u32 s52, s52, 65536
    v_add_u32 v3, s52, v3
    v_mov_b32 v10, v9
    v_mov_b32 v11, 20
    v_cmp_le_u32 vcc, 20, v9
    s_nop 1
    v_cndmask_b32 v10, v10, v11, vcc
    v_mov_b32 v11, 19
    v_cmp_le_u32 vcc, 28, v9
    s_nop 1
    v_cndmask_b32 v10, v10, v11, vcc
    v_lshlrev_b32 v10, 4, v10
    v_lshrrev_b32 v11, 5, v1
    v_mul_u32_u24 v11, 336, v11
    v_add_u32 v4, v10, v11
    s_mul_i32 s52, s34, 48384
    s_add_u32 s52, s52, 73728
    v_add_u32 v4, s52, v4
    v_cmp_gt_u32 vcc, 32, v1
    v_mov_b32 v10, 0
    v_mov_b32 v11, 0x3f803f80
    v_mov_b32 v12, 0x3f80
    v_cndmask_b32 v121, v10, v11, vcc
    v_cndmask_b32 v122, v10, v12, vcc
    v_mov_b32 v123, 0
    v_cndmask_b32 v125, v10, v11, vcc
    v_cndmask_b32 v126, v10, v12, vcc
    v_mov_b32 v127, 0
    v_mov_b32 v72, 0
    v_mov_b32 v73, 0
    v_mov_b32 v74, 0
    v_mov_b32 v75, 0
    v_mov_b32 v76, 0
    v_mov_b32 v77, 0
    v_mov_b32 v78, 0
    v_mov_b32 v79, 0
    v_mov_b32 v80, 0
    v_mov_b32 v81, 0
    v_mov_b32 v82, 0
    v_mov_b32 v83, 0
    v_mov_b32 v84, 0
    v_mov_b32 v85, 0
    v_mov_b32 v86, 0
    v_mov_b32 v87, 0
    v_mov_b32 v88, 0
    v_mov_b32 v89, 0
    v_mov_b32 v90, 0
    v_mov_b32 v91, 0
    v_mov_b32 v92, 0
    v_mov_b32 v93, 0
    v_mov_b32 v94, 0
    v_mov_b32 v95, 0
    v_mov_b32 v96, 0
    v_mov_b32 v97, 0
    v_mov_b32 v98, 0
    v_mov_b32 v99, 0
    v_mov_b32 v100, 0
    v_mov_b32 v101, 0
    v_mov_b32 v102, 0
    v_mov_b32 v103, 0
    ds_read_b128 v[112:115], v2 offset:0
    ds_read_b32 v120, v3 offset:0
    ds_read_b128 v[128:131], v4 offset:0
    ds_read_b128 v[116:119], v2 offset:1024
    ds_read_b32 v124, v3 offset:128
    ds_read_b128 v[136:139], v4 offset:672
    s_waitcnt lgkmcnt(4)
    v_mfma_f32_32x32x16_bf16 v[40:55], v[112:115], v[24:27], 0
    v_mfma_f32_32x32x16_bf16 v[40:55], v[120:123], v[32:35], v[40:55]
    s_nop 7
    s_nop 3
    v_mfma_f32_32x32x16_bf16 v[56:71], v[112:115], v[28:31], 0
    ds_read_b128 v[132:135], v4 offset:1344
    v_exp_f32 v40, v40
    v_exp_f32 v41, v41
    v_exp_f32 v42, v42
    v_exp_f32 v43, v43
    v_exp_f32 v44, v44
    v_exp_f32 v45, v45
    v_exp_f32 v46, v46
    v_exp_f32 v47, v47
    v_cvt_pk_bf16_f32 v104, v40, v41
    v_cvt_pk_bf16_f32 v105, v42, v43
    v_mfma_f32_32x32x16_bf16 v[56:71], v[120:123], v[36:39], v[56:71]
    v_exp_f32 v48, v48
    v_exp_f32 v49, v49
    v_exp_f32 v50, v50
    v_exp_f32 v51, v51
    v_cvt_pk_bf16_f32 v106, v44, v45
    v_cvt_pk_bf16_f32 v107, v46, v47
    v_exp_f32 v52, v52
    v_exp_f32 v53, v53
    s_waitcnt lgkmcnt(4)
    v_mfma_f32_32x32x16_bf16 v[72:87], v[128:131], v[104:107], v[72:87]
    v_exp_f32 v54, v54
    v_exp_f32 v55, v55
    v_cvt_pk_bf16_f32 v108, v48, v49
    v_cvt_pk_bf16_f32 v109, v50, v51
    v_cvt_pk_bf16_f32 v110, v52, v53
    v_cvt_pk_bf16_f32 v111, v54, v55
    s_waitcnt lgkmcnt(2)
    v_mfma_f32_32x32x16_bf16 v[40:55], v[116:119], v[24:27], 0
    v_exp_f32 v56, v56
    v_exp_f32 v57, v57
    v_exp_f32 v58, v58
    v_exp_f32 v59, v59
    s_waitcnt lgkmcnt(1)
    v_mfma_f32_32x32x16_bf16 v[72:87], v[136:139], v[108:111], v[72:87]
    v_exp_f32 v60, v60
    v_exp_f32 v61, v61
    v_exp_f32 v62, v62
    v_exp_f32 v63, v63
    v_cvt_pk_bf16_f32 v104, v56, v57
    v_cvt_pk_bf16_f32 v105, v58, v59
    v_mfma_f32_32x32x16_bf16 v[40:55], v[124:127], v[32:35], v[40:55]
    ds_read_b128 v[112:115], v2 offset:2048
    ds_read_b32 v120, v3 offset:256
    ds_read_b128 v[140:143], v4 offset:2016
    v_exp_f32 v64, v64
    v_exp_f32 v65, v65
    v_exp_f32 v66, v66
    v_exp_f32 v67, v67
    v_cvt_pk_bf16_f32 v106, v60, v61
    v_cvt_pk_bf16_f32 v107, v62, v63
    v_exp_f32 v68, v68
    v_exp_f32 v69, v69
    v_mfma_f32_32x32x16_bf16 v[88:103], v[128:131], v[104:107], v[88:103]
    v_exp_f32 v70, v70
    v_exp_f32 v71, v71
    v_cvt_pk_bf16_f32 v108, v64, v65
    v_cvt_pk_bf16_f32 v109, v66, v67
    v_cvt_pk_bf16_f32 v110, v68, v69
    v_cvt_pk_bf16_f32 v111, v70, v71
    v_mfma_f32_32x32x16_bf16 v[56:71], v[116:119], v[28:31], 0
    ds_read_b128 v[128:131], v4 offset:2688
    v_exp_f32 v40, v40
    v_exp_f32 v41, v41
    v_exp_f32 v42, v42
    v_exp_f32 v43, v43
    v_mfma_f32_32x32x16_bf16 v[88:103], v[136:139], v[108:111], v[88:103]
    v_exp_f32 v44, v44
    v_exp_f32 v45, v45
    v_exp_f32 v46, v46
    v_exp_f32 v47, v47
    v_cvt_pk_bf16_f32 v104, v40, v41
    v_cvt_pk_bf16_f32 v105, v42, v43
    v_mfma_f32_32x32x16_bf16 v[56:71], v[124:127], v[36:39], v[56:71]
    v_exp_f32 v48, v48
    v_exp_f32 v49, v49
    v_exp_f32 v50, v50
    v_exp_f32 v51, v51
    v_cvt_pk_bf16_f32 v106, v44, v45
    v_cvt_pk_bf16_f32 v107, v46, v47
    v_exp_f32 v52, v52
    v_exp_f32 v53, v53
    s_waitcnt lgkmcnt(4)
    v_mfma_f32_32x32x16_bf16 v[72:87], v[132:135], v[104:107], v[72:87]
    v_exp_f32 v54, v54
    v_exp_f32 v55, v55
    v_cvt_pk_bf16_f32 v108, v48, v49
    v_cvt_pk_bf16_f32 v109, v50, v51
    v_cvt_pk_bf16_f32 v110, v52, v53
    v_cvt_pk_bf16_f32 v111, v54, v55
    s_waitcnt lgkmcnt(2)
    v_mfma_f32_32x32x16_bf16 v[40:55], v[112:115], v[24:27], 0
    v_exp_f32 v56, v56
    v_exp_f32 v57, v57
    v_exp_f32 v58, v58
    v_exp_f32 v59, v59
    s_waitcnt lgkmcnt(1)
    v_mfma_f32_32x32x16_bf16 v[72:87], v[140:143], v[108:111], v[72:87]
    v_exp_f32 v60, v60
    v_exp_f32 v61, v61
    v_exp_f32 v62, v62
    v_exp_f32 v63, v63
    v_cvt_pk_bf16_f32 v104, v56, v57
    v_cvt_pk_bf16_f32 v105, v58, v59
    v_mfma_f32_32x32x16_bf16 v[40:55], v[120:123], v[32:35], v[40:55]
    ds_read_b128 v[116:119], v2 offset:3072
    ds_read_b32 v124, v3 offset:384
    ds_read_b128 v[136:139], v4 offset:3360
    v_exp_f32 v64, v64
    v_exp_f32 v65, v65
    v_exp_f32 v66, v66
    v_exp_f32 v67, v67
    v_cvt_pk_bf16_f32 v106, v60, v61
    v_cvt_pk_bf16_f32 v107, v62, v63
    v_exp_f32 v68, v68
    v_exp_f32 v69, v69
    v_mfma_f32_32x32x16_bf16 v[88:103], v[132:135], v[104:107], v[88:103]
    v_exp_f32 v70, v70
    v_exp_f32 v71, v71
    v_cvt_pk_bf16_f32 v108, v64, v65
    v_cvt_pk_bf16_f32 v109, v66, v67
    v_cvt_pk_bf16_f32 v110, v68, v69
    v_cvt_pk_bf16_f32 v111, v70, v71
    v_mfma_f32_32x32x16_bf16 v[56:71], v[112:115], v[28:31], 0
    ds_read_b128 v[132:135], v4 offset:4032
    v_exp_f32 v40, v40
    v_exp_f32 v41, v41
    v_exp_f32 v42, v42
    v_exp_f32 v43, v43
    v_mfma_f32_32x32x16_bf16 v[88:103], v[140:143], v[108:111], v[88:103]
    v_exp_f32 v44, v44
    v_exp_f32 v45, v45
    v_exp_f32 v46, v46
    v_exp_f32 v47, v47
    v_cvt_pk_bf16_f32 v104, v40, v41
    v_cvt_pk_bf16_f32 v105, v42, v43
    v_mfma_f32_32x32x16_bf16 v[56:71], v[120:123], v[36:39], v[56:71]
    v_exp_f32 v48, v48
    v_exp_f32 v49, v49
    v_exp_f32 v50, v50
    v_exp_f32 v51, v51
    v_cvt_pk_bf16_f32 v106, v44, v45
    v_cvt_pk_bf16_f32 v107, v46, v47
    v_exp_f32 v52, v52
    v_exp_f32 v53, v53
    s_waitcnt lgkmcnt(4)
    v_mfma_f32_32x32x16_bf16 v[72:87], v[128:131], v[104:107], v[72:87]
    v_exp_f32 v54, v54
    v_exp_f32 v55, v55
    v_cvt_pk_bf16_f32 v108, v48, v49
    v_cvt_pk_bf16_f32 v109, v50, v51
    v_cvt_pk_bf16_f32 v110, v52, v53
    v_cvt_pk_bf16_f32 v111, v54, v55
    s_waitcnt lgkmcnt(2)
    v_mfma_f32_32x32x16_bf16 v[40:55], v[116:119], v[24:27], 0
    v_exp_f32 v56, v56
    v_exp_f32 v57, v57
    v_exp_f32 v58, v58
    v_exp_f32 v59, v59
    s_waitcnt lgkmcnt(1)
    v_mfma_f32_32x32x16_bf16 v[72:87], v[136:139], v[108:111], v[72:87]
    v_exp_f32 v60, v60
    v_exp_f32 v61, v61
    v_exp_f32 v62, v62
    v_exp_f32 v63, v63
    v_cvt_pk_bf16_f32 v104, v56, v57
    v_cvt_pk_bf16_f32 v105, v58, v59
    v_mfma_f32_32x32x16_bf16 v[40:55], v[124:127], v[32:35], v[40:55]
    ds_read_b128 v[112:115], v2 offset:4096
    ds_read_b32 v120, v3 offset:512
    ds_read_b128 v[140:143], v4 offset:4704
    v_exp_f32 v64, v64
    v_exp_f32 v65, v65
    v_exp_f32 v66, v66
    v_exp_f32 v67, v67
    v_cvt_pk_bf16_f32 v106, v60, v61
    v_cvt_pk_bf16_f32 v107, v62, v63
    v_exp_f32 v68, v68
    v_exp_f32 v69, v69
    v_mfma_f32_32x32x16_bf16 v[88:103], v[128:131], v[104:107], v[88:103]
    v_exp_f32 v70, v70
    v_exp_f32 v71, v71
    v_cvt_pk_bf16_f32 v108, v64, v65
    v_cvt_pk_bf16_f32 v109, v66, v67
    v_cvt_pk_bf16_f32 v110, v68, v69
    v_cvt_pk_bf16_f32 v111, v70, v71
    v_mfma_f32_32x32x16_bf16 v[56:71], v[116:119], v[28:31], 0
    ds_read_b128 v[128:131], v4 offset:5376
    v_exp_f32 v40, v40
    v_exp_f32 v41, v41
    v_exp_f32 v42, v42
    v_exp_f32 v43, v43
    v_mfma_f32_32x32x16_bf16 v[88:103], v[136:139], v[108:111], v[88:103]
    v_exp_f32 v44, v44
    v_exp_f32 v45, v45
    v_exp_f32 v46, v46
    v_exp_f32 v47, v47
    v_cvt_pk_bf16_f32 v104, v40, v41
    v_cvt_pk_bf16_f32 v105, v42, v43
    v_mfma_f32_32x32x16_bf16 v[56:71], v[124:127], v[36:39], v[56:71]
    v_exp_f32 v48, v48
    v_exp_f32 v49, v49
    v_exp_f32 v50, v50
    v_exp_f32 v51, v51
    v_cvt_pk_bf16_f32 v106, v44, v45
    v_cvt_pk_bf16_f32 v107, v46, v47
    v_exp_f32 v52, v52
    v_exp_f32 v53, v53
    s_waitcnt lgkmcnt(4)
    v_mfma_f32_32x32x16_bf16 v[72:87], v[132:135], v[104:107], v[72:87]
    v_exp_f32 v54, v54
    v_exp_f32 v55, v55
    v_cvt_pk_bf16_f32 v108, v48, v49
    v_cvt_pk_bf16_f32 v109, v50, v51
    v_cvt_pk_bf16_f32 v110, v52, v53
    v_cvt_pk_bf16_f32 v111, v54, v55
    s_waitcnt lgkmcnt(2)
    v_mfma_f32_32x32x16_bf16 v[40:55], v[112:115], v[24:27], 0
    v_exp_f32 v56, v56
    v_exp_f32 v57, v57
    v_exp_f32 v58, v58
    v_exp_f32 v59, v59
    s_waitcnt lgkmcnt(1)
    v_mfma_f32_32x32x16_bf16 v[72:87], v[140:143], v[108:111], v[72:87]
    v_exp_f32 v60, v60
    v_exp_f32 v61, v61
    v_exp_f32 v62, v62
    v_exp_f32 v63, v63
    v_cvt_pk_bf16_f32 v104, v56, v57
    v_cvt_pk_bf16_f32 v105, v58, v59
    v_mfma_f32_32x32x16_bf16 v[40:55], v[120:123], v[32:35], v[40:55]
    ds_read_b128 v[116:119], v2 offset:5120
    ds_read_b32 v124, v3 offset:640
    ds_read_b128 v[136:139], v4 offset:6048
    v_exp_f32 v64, v64
    v_exp_f32 v65, v65
    v_exp_f32 v66, v66
    v_exp_f32 v67, v67
    v_cvt_pk_bf16_f32 v106, v60, v61
    v_cvt_pk_bf16_f32 v107, v62, v63
    v_exp_f32 v68, v68
    v_exp_f32 v69, v69
    v_mfma_f32_32x32x16_bf16 v[88:103], v[132:135], v[104:107], v[88:103]
    v_exp_f32 v70, v70
    v_exp_f32 v71, v71
    v_cvt_pk_bf16_f32 v108, v64, v65
    v_cvt_pk_bf16_f32 v109, v66, v67
    v_cvt_pk_bf16_f32 v110, v68, v69
    v_cvt_pk_bf16_f32 v111, v70, v71
    v_mfma_f32_32x32x16_bf16 v[56:71], v[112:115], v[28:31], 0
    ds_read_b128 v[132:135], v4 offset:6720
    v_exp_f32 v40, v40
    v_exp_f32 v41, v41
    v_exp_f32 v42, v42
    v_exp_f32 v43, v43
    v_mfma_f32_32x32x16_bf16 v[88:103], v[140:143], v[108:111], v[88:103]
    v_exp_f32 v44, v44
    v_exp_f32 v45, v45
    v_exp_f32 v46, v46
    v_exp_f32 v47, v47
    v_cvt_pk_bf16_f32 v104, v40, v41
    v_cvt_pk_bf16_f32 v105, v42, v43
    v_mfma_f32_32x32x16_bf16 v[56:71], v[120:123], v[36:39], v[56:71]
    v_exp_f32 v48, v48
    v_exp_f32 v49, v49
    v_exp_f32 v50, v50
    v_exp_f32 v51, v51
    v_cvt_pk_bf16_f32 v106, v44, v45
    v_cvt_pk_bf16_f32 v107, v46, v47
    v_exp_f32 v52, v52
    v_exp_f32 v53, v53
    s_waitcnt lgkmcnt(4)
    v_mfma_f32_32x32x16_bf16 v[72:87], v[128:131], v[104:107], v[72:87]
    v_exp_f32 v54, v54
    v_exp_f32 v55, v55
    v_cvt_pk_bf16_f32 v108, v48, v49
    v_cvt_pk_bf16_f32 v109, v50, v51
    v_cvt_pk_bf16_f32 v110, v52, v53
    v_cvt_pk_bf16_f32 v111, v54, v55
    s_waitcnt lgkmcnt(2)
    v_mfma_f32_32x32x16_bf16 v[40:55], v[116:119], v[24:27], 0
    v_exp_f32 v56, v56
    v_exp_f32 v57, v57
    v_exp_f32 v58, v58
    v_exp_f32 v59, v59
    s_waitcnt lgkmcnt(1)
    v_mfma_f32_32x32x16_bf16 v[72:87], v[136:139], v[108:111], v[72:87]
    v_exp_f32 v60, v60
    v_exp_f32 v61, v61
    v_exp_f32 v62, v62
    v_exp_f32 v63, v63
    v_cvt_pk_bf16_f32 v104, v56, v57
    v_cvt_pk_bf16_f32 v105, v58, v59
    v_mfma_f32_32x32x16_bf16 v[40:55], v[124:127], v[32:35], v[40:55]
    ds_read_b128 v[112:115], v2 offset:6144
    ds_read_b32 v120, v3 offset:768
    ds_read_b128 v[140:143], v4 offset:7392
    v_exp_f32 v64, v64
    v_exp_f32 v65, v65
    v_exp_f32 v66, v66
    v_exp_f32 v67, v67
    v_cvt_pk_bf16_f32 v106, v60, v61
    v_cvt_pk_bf16_f32 v107, v62, v63
    v_exp_f32 v68, v68
    v_exp_f32 v69, v69
    v_mfma_f32_32x32x16_bf16 v[88:103], v[128:131], v[104:107], v[88:103]
    v_exp_f32 v70, v70
    v_exp_f32 v71, v71
    v_cvt_pk_bf16_f32 v108, v64, v65
    v_cvt_pk_bf16_f32 v109, v66, v67
    v_cvt_pk_bf16_f32 v110, v68, v69
    v_cvt_pk_bf16_f32 v111, v70, v71
    v_mfma_f32_32x32x16_bf16 v[56:71], v[116:119], v[28:31], 0
    ds_read_b128 v[128:131], v4 offset:8064
    v_exp_f32 v40, v40
    v_exp_f32 v41, v41
    v_exp_f32 v42, v42
    v_exp_f32 v43, v43
    v_mfma_f32_32x32x16_bf16 v[88:103], v[136:139], v[108:111], v[88:103]
    v_exp_f32 v44, v44
    v_exp_f32 v45, v45
    v_exp_f32 v46, v46
    v_exp_f32 v47, v47
    v_cvt_pk_bf16_f32 v104, v40, v41
    v_cvt_pk_bf16_f32 v105, v42, v43
    v_mfma_f32_32x32x16_bf16 v[56:71], v[124:127], v[36:39], v[56:71]
    v_exp_f32 v48, v48
    v_exp_f32 v49, v49
    v_exp_f32 v50, v50
    v_exp_f32 v51, v51
    v_cvt_pk_bf16_f32 v106, v44, v45
    v_cvt_pk_bf16_f32 v107, v46, v47
    v_exp_f32 v52, v52
    v_exp_f32 v53, v53
    s_waitcnt lgkmcnt(4)
    v_mfma_f32_32x32x16_bf16 v[72:87], v[132:135], v[104:107], v[72:87]
    v_exp_f32 v54, v54
    v_exp_f32 v55, v55
    v_cvt_pk_bf16_f32 v108, v48, v49
    v_cvt_pk_bf16_f32 v109, v50, v51
    v_cvt_pk_bf16_f32 v110, v52, v53
    v_cvt_pk_bf16_f32 v111, v54, v55
    s_waitcnt lgkmcnt(2)
    v_mfma_f32_32x32x16_bf16 v[40:55], v[112:115], v[24:27], 0
    v_exp_f32 v56, v56
    v_exp_f32 v57, v57
    v_exp_f32 v58, v58
    v_exp_f32 v59, v59
    s_waitcnt lgkmcnt(1)
    v_mfma_f32_32x32x16_bf16 v[72:87], v[140:143], v[108:111], v[72:87]
    v_exp_f32 v60, v60
    v_exp_f32 v61, v61
    v_exp_f32 v62, v62
    v_exp_f32 v63, v63
    v_cvt_pk_bf16_f32 v104, v56, v57
    v_cvt_pk_bf16_f32 v105, v58, v59
    v_mfma_f32_32x32x16_bf16 v[40:55], v[120:123], v[32:35], v[40:55]
    ds_read_b128 v[116:119], v2 offset:7168
    ds_read_b32 v124, v3 offset:896
    ds_read_b128 v[136:139], v4 offset:8736
    v_exp_f32 v64, v64
    v_exp_f32 v65, v65
    v_exp_f32 v66, v66
    v_exp_f32 v67, v67
    v_cvt_pk_bf16_f32 v106, v60, v61
    v_cvt_pk_bf16_f32 v107, v62, v63
    v_exp_f32 v68, v68
    v_exp_f32 v69, v69
    v_mfma_f32_32x32x16_bf16 v[88:103], v[132:135], v[104:107], v[88:103]
    v_exp_f32 v70, v70
    v_exp_f32 v71, v71
    v_cvt_pk_bf16_f32 v108, v64, v65
    v_cvt_pk_bf16_f32 v109, v66, v67
    v_cvt_pk_bf16_f32 v110, v68, v69
    v_cvt_pk_bf16_f32 v111, v70, v71
    v_mfma_f32_32x32x16_bf16 v[56:71], v[112:115], v[28:31], 0
    ds_read_b128 v[132:135], v4 offset:9408
    v_exp_f32 v40, v40
    v_exp_f32 v41, v41
    v_exp_f32 v42, v42
    v_exp_f32 v43, v43
    v_mfma_f32_32x32x16_bf16 v[88:103], v[140:143], v[108:111], v[88:103]
    v_exp_f32 v44, v44
    v_exp_f32 v45, v45
    v_exp_f32 v46, v46
    v_exp_f32 v47, v47
    v_cvt_pk_bf16_f32 v104, v40, v41
    v_cvt_pk_bf16_f32 v105, v42, v43
    v_mfma_f32_32x32x16_bf16 v[56:71], v[120:123], v[36:39], v[56:71]
    v_exp_f32 v48, v48
    v_exp_f32 v49, v49
    v_exp_f32 v50, v50
    v_exp_f32 v51, v51
    v_cvt_pk_bf16_f32 v106, v44, v45
    v_cvt_pk_bf16_f32 v107, v46, v47
    v_exp_f32 v52, v52
    v_exp_f32 v53, v53
    s_waitcnt lgkmcnt(4)
    v_mfma_f32_32x32x16_bf16 v[72:87], v[128:131], v[104:107], v[72:87]
    v_exp_f32 v54, v54
    v_exp_f32 v55, v55
    v_cvt_pk_bf16_f32 v108, v48, v49
    v_cvt_pk_bf16_f32 v109, v50, v51
    v_cvt_pk_bf16_f32 v110, v52, v53
    v_cvt_pk_bf16_f32 v111, v54, v55
    s_waitcnt lgkmcnt(2)
    v_mfma_f32_32x32x16_bf16 v[40:55], v[116:119], v[24:27], 0
    v_exp_f32 v56, v56
    v_exp_f32 v57, v57
    v_exp_f32 v58, v58
    v_exp_f32 v59, v59
    s_waitcnt lgkmcnt(1)
    v_mfma_f32_32x32x16_bf16 v[72:87], v[136:139], v[108:111], v[72:87]
    v_exp_f32 v60, v60
    v_exp_f32 v61, v61
    v_exp_f32 v62, v62
    v_exp_f32 v63, v63
    v_cvt_pk_bf16_f32 v104, v56, v57
    v_cvt_pk_bf16_f32 v105, v58, v59
    v_mfma_f32_32x32x16_bf16 v[40:55], v[124:127], v[32:35], v[40:55]
    ds_read_b128 v[112:115], v2 offset:8192
    ds_read_b32 v120, v3 offset:1024
    ds_read_b128 v[140:143], v4 offset:10080
    v_exp_f32 v64, v64
    v_exp_f32 v65, v65
    v_exp_f32 v66, v66
    v_exp_f32 v67, v67
    v_cvt_pk_bf16_f32 v106, v60, v61
    v_cvt_pk_bf16_f32 v107, v62, v63
    v_exp_f32 v68, v68
    v_exp_f32 v69, v69
    v_mfma_f32_32x32x16_bf16 v[88:103], v[128:131], v[104:107], v[88:103]
    v_exp_f32 v70, v70
    v_exp_f32 v71, v71
    v_cvt_pk_bf16_f32 v108, v64, v65
    v_cvt_pk_bf16_f32 v109, v66, v67
    v_cvt_pk_bf16_f32 v110, v68, v69
    v_cvt_pk_bf16_f32 v111, v70, v71
    v_mfma_f32_32x32x16_bf16 v[56:71], v[116:119], v[28:31], 0
    ds_read_b128 v[128:131], v4 offset:10752
    v_exp_f32 v40, v40
    v_exp_f32 v41, v41
    v_exp_f32 v42, v42
    v_exp_f32 v43, v43
    v_mfma_f32_32x32x16_bf16 v[88:103], v[136:139], v[108:111], v[88:103]
    v_exp_f32 v44, v44
    v_exp_f32 v45, v45
    v_exp_f32 v46, v46
    v_exp_f32 v47, v47
    v_cvt_pk_bf16_f32 v104, v40, v41
    v_cvt_pk_bf16_f32 v105, v42, v43
    v_mfma_f32_32x32x16_bf16 v[56:71], v[124:127], v[36:39], v[56:71]
    v_exp_f32 v48, v48
    v_exp_f32 v49, v49
    v_exp_f32 v50, v50
    v_exp_f32 v51, v51
    v_cvt_pk_bf16_f32 v106, v44, v45
    v_cvt_pk_bf16_f32 v107, v46, v47
    v_exp_f32 v52, v52
    v_exp_f32 v53, v53
    s_waitcnt lgkmcnt(4)
    v_mfma_f32_32x32x16_bf16 v[72:87], v[132:135], v[104:107], v[72:87]
    v_exp_f32 v54, v54
    v_exp_f32 v55, v55
    v_cvt_pk_bf16_f32 v108, v48, v49
    v_cvt_pk_bf16_f32 v109, v50, v51
    v_cvt_pk_bf16_f32 v110, v52, v53
    v_cvt_pk_bf16_f32 v111, v54, v55
    s_waitcnt lgkmcnt(2)
    v_mfma_f32_32x32x16_bf16 v[40:55], v[112:115], v[24:27], 0
    v_exp_f32 v56, v56
    v_exp_f32 v57, v57
    v_exp_f32 v58, v58
    v_exp_f32 v59, v59
    s_waitcnt lgkmcnt(1)
    v_mfma_f32_32x32x16_bf16 v[72:87], v[140:143], v[108:111], v[72:87]
    v_exp_f32 v60, v60
    v_exp_f32 v61, v61
    v_exp_f32 v62, v62
    v_exp_f32 v63, v63
    v_cvt_pk_bf16_f32 v104, v56, v57
    v_cvt_pk_bf16_f32 v105, v58, v59
    v_mfma_f32_32x32x16_bf16 v[40:55], v[120:123], v[32:35], v[40:55]
    ds_read_b128 v[116:119], v2 offset:9216
    ds_read_b32 v124, v3 offset:1152
    ds_read_b128 v[136:139], v4 offset:11424
    v_exp_f32 v64, v64
    v_exp_f32 v65, v65
    v_exp_f32 v66, v66
    v_exp_f32 v67, v67
    v_cvt_pk_bf16_f32 v106, v60, v61
    v_cvt_pk_bf16_f32 v107, v62, v63
    v_exp_f32 v68, v68
    v_exp_f32 v69, v69
    v_mfma_f32_32x32x16_bf16 v[88:103], v[132:135], v[104:107], v[88:103]
    v_exp_f32 v70, v70
    v_exp_f32 v71, v71
    v_cvt_pk_bf16_f32 v108, v64, v65
    v_cvt_pk_bf16_f32 v109, v66, v67
    v_cvt_pk_bf16_f32 v110, v68, v69
    v_cvt_pk_bf16_f32 v111, v70, v71
    v_add_u32 v2, 4096, v2
    v_add_u32 v3, 512, v3
    v_add_u32 v4, 5376, v4
    s_mul_i32 s60, s34, 2
    s_sub_u32 s60, 6, s60
    s_mov_b32 s59, 0
.Lk1att_330:
    v_add_u32 v2, 4096, v2
    v_add_u32 v3, 512, v3
    v_add_u32 v4, 5376, v4
    v_mfma_f32_32x32x16_bf16 v[56:71], v[112:115], v[28:31], 0
    ds_read_b128 v[132:135], v4 offset:1344
    v_exp_f32 v40, v40
    v_exp_f32 v41, v41
    v_exp_f32 v42, v42
    v_exp_f32 v43, v43
    v_mfma_f32_32x32x16_bf16 v[88:103], v[140:143], v[108:111], v[88:103]
    v_exp_f32 v44, v44
    v_exp_f32 v45, v45
    v_exp_f32 v46, v46
    v_exp_f32 v47, v47
    v_cvt_pk_bf16_f32 v104, v40, v41
    v_cvt_pk_bf16_f32 v105, v42, v43
    v_mfma_f32_32x32x16_bf16 v[56:71], v[120:123], v[36:39], v[56:71]
    v_exp_f32 v48, v48
    v_exp_f32 v49, v49
    v_exp_f32 v50, v50
    v_exp_f32 v51, v51
    v_cvt_pk_bf16_f32 v106, v44, v45
    v_cvt_pk_bf16_f32 v107, v46, v47
    v_exp_f32 v52, v52
    v_exp_f32 v53, v53
    s_waitcnt lgkmcnt(4)
    v_mfma_f32_32x32x16_bf16 v[72:87], v[128:131], v[104:107], v[72:87]
    v_exp_f32 v54, v54
    v_exp_f32 v55, v55
    v_cvt_pk_bf16_f32 v108, v48, v49
    v_cvt_pk_bf16_f32 v109, v50, v51
    v_cvt_pk_bf16_f32 v110, v52, v53
    v_cvt_pk_bf16_f32 v111, v54, v55
    s_waitcnt lgkmcnt(2)
    v_mfma_f32_32x32x16_bf16 v[40:55], v[116:119], v[24:27], 0
    v_exp_f32 v56, v56
    v_exp_f32 v57, v57
    v_exp_f32 v58, v58
    v_exp_f32 v59, v59
    s_waitcnt lgkmcnt(1)
    v_mfma_f32_32x32x16_bf16 v[72:87], v[136:139], v[108:111], v[72:87]
    v_exp_f32 v60, v60
    v_exp_f32 v61, v61
    v_exp_f32 v62, v62
    v_exp_f32 v63, v63
    v_cvt_pk_bf16_f32 v104, v56, v57
    v_cvt_pk_bf16_f32 v105, v58, v59
    v_mfma_f32_32x32x16_bf16 v[40:55], v[124:127], v[32:35], v[40:55]
    ds_read_b128 v[112:115], v2 offset:2048
    ds_read_b32 v120, v3 offset:256
    ds_read_b128 v[140:143], v4 offset:2016
    v_exp_f32 v64, v64
    v_exp_f32 v65, v65
    v_exp_f32 v66, v66
    v_exp_f32 v67, v67
    v_cvt_pk_bf16_f32 v106, v60, v61
    v_cvt_pk_bf16_f32 v107, v62, v63
    v_exp_f32 v68, v68
    v_exp_f32 v69, v69
    v_mfma_f32_32x32x16_bf16 v[88:103], v[128:131], v[104:107], v[88:103]
    v_exp_f32 v70, v70
    v_exp_f32 v71, v71
    v_cvt_pk_bf16_f32 v108, v64, v65
    v_cvt_pk_bf16_f32 v109, v66, v67
    v_cvt_pk_bf16_f32 v110, v68, v69
    v_cvt_pk_bf16_f32 v111, v70, v71
    v_mfma_f32_32x32x16_bf16 v[56:71], v[116:119], v[28:31], 0
    ds_read_b128 v[128:131], v4 offset:2688
    v_exp_f32 v40, v40
    v_exp_f32 v41, v41
    v_exp_f32 v42, v42
    v_exp_f32 v43, v43
    v_mfma_f32_32x32x16_bf16 v[88:103], v[136:139], v[108:111], v[88:103]
    v_exp_f32 v44, v44
    v_exp_f32 v45, v45
    v_exp_f32 v46, v46
    v_exp_f32 v47, v47
    v_cvt_pk_bf16_f32 v104, v40, v41
    v_cvt_pk_bf16_f32 v105, v42, v43
    v_mfma_f32_32x32x16_bf16 v[56:71], v[124:127], v[36:39], v[56:71]
    v_exp_f32 v48, v48
    v_exp_f32 v49, v49
    v_exp_f32 v50, v50
    v_exp_f32 v51, v51
    v_cvt_pk_bf16_f32 v106, v44, v45
    v_cvt_pk_bf16_f32 v107, v46, v47
    v_exp_f32 v52, v52
    v_exp_f32 v53, v53
    s_waitcnt lgkmcnt(4)
    v_mfma_f32_32x32x16_bf16 v[72:87], v[132:135], v[104:107], v[72:87]
    v_exp_f32 v54, v54
    v_exp_f32 v55, v55
    v_cvt_pk_bf16_f32 v108, v48, v49
    v_cvt_pk_bf16_f32 v109, v50, v51
    v_cvt_pk_bf16_f32 v110, v52, v53
    v_cvt_pk_bf16_f32 v111, v54, v55
    s_waitcnt lgkmcnt(2)
    v_mfma_f32_32x32x16_bf16 v[40:55], v[112:115], v[24:27], 0
    v_exp_f32 v56, v56
    v_exp_f32 v57, v57
    v_exp_f32 v58, v58
    v_exp_f32 v59, v59
    s_waitcnt lgkmcnt(1)
    v_mfma_f32_32x32x16_bf16 v[72:87], v[140:143], v[108:111], v[72:87]
    v_exp_f32 v60, v60
    v_exp_f32 v61, v61
    v_exp_f32 v62, v62
    v_exp_f32 v63, v63
    v_cvt_pk_bf16_f32 v104, v56, v57
    v_cvt_pk_bf16_f32 v105, v58, v59
    v_mfma_f32_32x32x16_bf16 v[40:55], v[120:123], v[32:35], v[40:55]
    ds_read_b128 v[116:119], v2 offset:3072
    ds_read_b32 v124, v3 offset:384
    ds_read_b128 v[136:139], v4 offset:3360
    v_exp_f32 v64, v64
    v_exp_f32 v65, v65
    v_exp_f32 v66, v66
    v_exp_f32 v67, v67
    v_cvt_pk_bf16_f32 v106, v60, v61
    v_cvt_pk_bf16_f32 v107, v62, v63
    v_exp_f32 v68, v68
    v_exp_f32 v69, v69
    v_mfma_f32_32x32x16_bf16 v[88:103], v[132:135], v[104:107], v[88:103]
    v_exp_f32 v70, v70
    v_exp_f32 v71, v71
    v_cvt_pk_bf16_f32 v108, v64, v65
    v_cvt_pk_bf16_f32 v109, v66, v67
    v_cvt_pk_bf16_f32 v110, v68, v69
    v_cvt_pk_bf16_f32 v111, v70, v71
    v_mfma_f32_32x32x16_bf16 v[56:71], v[112:115], v[28:31], 0
    ds_read_b128 v[132:135], v4 offset:4032
    v_exp_f32 v40, v40
    v_exp_f32 v41, v41
    v_exp_f32 v42, v42
    v_exp_f32 v43, v43
    v_mfma_f32_32x32x16_bf16 v[88:103], v[140:143], v[108:111], v[88:103]
    v_exp_f32 v44, v44
    v_exp_f32 v45, v45
    v_exp_f32 v46, v46
    v_exp_f32 v47, v47
    v_cvt_pk_bf16_f32 v104, v40, v41
    v_cvt_pk_bf16_f32 v105, v42, v43
    v_mfma_f32_32x32x16_bf16 v[56:71], v[120:123], v[36:39], v[56:71]
    v_exp_f32 v48, v48
    v_exp_f32 v49, v49
    v_exp_f32 v50, v50
    v_exp_f32 v51, v51
    v_cvt_pk_bf16_f32 v106, v44, v45
    v_cvt_pk_bf16_f32 v107, v46, v47
    v_exp_f32 v52, v52
    v_exp_f32 v53, v53
    s_waitcnt lgkmcnt(4)
    v_mfma_f32_32x32x16_bf16 v[72:87], v[128:131], v[104:107], v[72:87]
    v_exp_f32 v54, v54
    v_exp_f32 v55, v55
    v_cvt_pk_bf16_f32 v108, v48, v49
    v_cvt_pk_bf16_f32 v109, v50, v51
    v_cvt_pk_bf16_f32 v110, v52, v53
    v_cvt_pk_bf16_f32 v111, v54, v55
    s_waitcnt lgkmcnt(2)
    v_mfma_f32_32x32x16_bf16 v[40:55], v[116:119], v[24:27], 0
    v_exp_f32 v56, v56
    v_exp_f32 v57, v57
    v_exp_f32 v58, v58
    v_exp_f32 v59, v59
    s_waitcnt lgkmcnt(1)
    v_mfma_f32_32x32x16_bf16 v[72:87], v[136:139], v[108:111], v[72:87]
    v_exp_f32 v60, v60
    v_exp_f32 v61, v61
    v_exp_f32 v62, v62
    v_exp_f32 v63, v63
    v_cvt_pk_bf16_f32 v104, v56, v57
    v_cvt_pk_bf16_f32 v105, v58, v59
    v_mfma_f32_32x32x16_bf16 v[40:55], v[124:127], v[32:35], v[40:55]
    ds_read_b128 v[112:115], v2 offset:4096
    ds_read_b32 v120, v3 offset:512
    ds_read_b128 v[140:143], v4 offset:4704
    v_exp_f32 v64, v64
    v_exp_f32 v65, v65
    v_exp_f32 v66, v66
    v_exp_f32 v67, v67
    v_cvt_pk_bf16_f32 v106, v60, v61
    v_cvt_pk_bf16_f32 v107, v62, v63
    v_exp_f32 v68, v68
    v_exp_f32 v69, v69
    v_mfma_f32_32x32x16_bf16 v[88:103], v[128:131], v[104:107], v[88:103]
    v_exp_f32 v70, v70
    v_exp_f32 v71, v71
    v_cvt_pk_bf16_f32 v108, v64, v65
    v_cvt_pk_bf16_f32 v109, v66, v67
    v_cvt_pk_bf16_f32 v110, v68, v69
    v_cvt_pk_bf16_f32 v111, v70, v71
    v_mfma_f32_32x32x16_bf16 v[56:71], v[116:119], v[28:31], 0
    ds_read_b128 v[128:131], v4 offset:5376
    v_exp_f32 v40, v40
    v_exp_f32 v41, v41
    v_exp_f32 v42, v42
    v_exp_f32 v43, v43
    v_mfma_f32_32x32x16_bf16 v[88:103], v[136:139], v[108:111], v[88:103]
    v_exp_f32 v44, v44
    v_exp_f32 v45, v45
    v_exp_f32 v46, v46
    v_exp_f32 v47, v47
    v_cvt_pk_bf16_f32 v104, v40, v41
    v_cvt_pk_bf16_f32 v105, v42, v43
    v_mfma_f32_32x32x16_bf16 v[56:71], v[124:127], v[36:39], v[56:71]
    v_exp_f32 v48, v48
    v_exp_f32 v49, v49
    v_exp_f32 v50, v50
    v_exp_f32 v51, v51
    v_cvt_pk_bf16_f32 v106, v44, v45
    v_cvt_pk_bf16_f32 v107, v46, v47
    v_exp_f32 v52, v52
    v_exp_f32 v53, v53
    s_waitcnt lgkmcnt(4)
    v_mfma_f32_32x32x16_bf16 v[72:87], v[132:135], v[104:107], v[72:87]
    v_exp_f32 v54, v54
    v_exp_f32 v55, v55
    v_cvt_pk_bf16_f32 v108, v48, v49
    v_cvt_pk_bf16_f32 v109, v50, v51
    v_cvt_pk_bf16_f32 v110, v52, v53
    v_cvt_pk_bf16_f32 v111, v54, v55
    s_waitcnt lgkmcnt(2)
    v_mfma_f32_32x32x16_bf16 v[40:55], v[112:115], v[24:27], 0
    v_exp_f32 v56, v56
    v_exp_f32 v57, v57
    v_exp_f32 v58, v58
    v_exp_f32 v59, v59
    s_waitcnt lgkmcnt(1)
    v_mfma_f32_32x32x16_bf16 v[72:87], v[140:143], v[108:111], v[72:87]
    v_exp_f32 v60, v60
    v_exp_f32 v61, v61
    v_exp_f32 v62, v62
    v_exp_f32 v63, v63
    v_cvt_pk_bf16_f32 v104, v56, v57
    v_cvt_pk_bf16_f32 v105, v58, v59
    v_mfma_f32_32x32x16_bf16 v[40:55], v[120:123], v[32:35], v[40:55]
    ds_read_b128 v[116:119], v2 offset:5120
    ds_read_b32 v124, v3 offset:640
    ds_read_b128 v[136:139], v4 offset:6048
    v_exp_f32 v64, v64
    v_exp_f32 v65, v65
    v_exp_f32 v66, v66
    v_exp_f32 v67, v67
    v_cvt_pk_bf16_f32 v106, v60, v61
    v_cvt_pk_bf16_f32 v107, v62, v63
    v_exp_f32 v68, v68
    v_exp_f32 v69, v69
    v_mfma_f32_32x32x16_bf16 v[88:103], v[132:135], v[104:107], v[88:103]
    v_exp_f32 v70, v70
    v_exp_f32 v71, v71
    v_cvt_pk_bf16_f32 v108, v64, v65
    v_cvt_pk_bf16_f32 v109, v66, v67
    v_cvt_pk_bf16_f32 v110, v68, v69
    v_cvt_pk_bf16_f32 v111, v70, v71
    s_add_u32 s59, s59, 1
    s_sub_u32 s60, s60, 1
    s_cmp_lg_u32 s60, 0
    s_cbranch_scc1 .Lk1att_330
    v_add_u32 v2, 4096, v2
    v_add_u32 v3, 512, v3
    v_add_u32 v4, 5376, v4
    v_mfma_f32_32x32x16_bf16 v[56:71], v[112:115], v[28:31], 0
    ds_read_b128 v[132:135], v4 offset:1344
    v_exp_f32 v40, v40
    v_exp_f32 v41, v41
    v_exp_f32 v42, v42
    v_exp_f32 v43, v43
    v_mfma_f32_32x32x16_bf16 v[88:103], v[140:143], v[108:111], v[88:103]
    v_exp_f32 v44, v44
    v_exp_f32 v45, v45
    v_exp_f32 v46, v46
    v_exp_f32 v47, v47
    v_cvt_pk_bf16_f32 v104, v40, v41
    v_cvt_pk_bf16_f32 v105, v42, v43
    v_mfma_f32_32x32x16_bf16 v[56:71], v[120:123], v[36:39], v[56:71]
    v_exp_f32 v48, v48
    v_exp_f32 v49, v49
    v_exp_f32 v50, v50
    v_exp_f32 v51, v51
    v_cvt_pk_bf16_f32 v106, v44, v45
    v_cvt_pk_bf16_f32 v107, v46, v47
    v_exp_f32 v52, v52
    v_exp_f32 v53, v53
    s_waitcnt lgkmcnt(4)
    v_mfma_f32_32x32x16_bf16 v[72:87], v[128:131], v[104:107], v[72:87]
    v_exp_f32 v54, v54
    v_exp_f32 v55, v55
    v_cvt_pk_bf16_f32 v108, v48, v49
    v_cvt_pk_bf16_f32 v109, v50, v51
    v_cvt_pk_bf16_f32 v110, v52, v53
    v_cvt_pk_bf16_f32 v111, v54, v55
    s_waitcnt lgkmcnt(2)
    v_mfma_f32_32x32x16_bf16 v[40:55], v[116:119], v[24:27], 0
    v_exp_f32 v56, v56
    v_exp_f32 v57, v57
    v_exp_f32 v58, v58
    v_exp_f32 v59, v59
    s_waitcnt lgkmcnt(1)
    v_mfma_f32_32x32x16_bf16 v[72:87], v[136:139], v[108:111], v[72:87]
    v_exp_f32 v60, v60
    v_exp_f32 v61, v61
    v_exp_f32 v62, v62
    v_exp_f32 v63, v63
    v_cvt_pk_bf16_f32 v104, v56, v57
    v_cvt_pk_bf16_f32 v105, v58, v59
    v_mfma_f32_32x32x16_bf16 v[40:55], v[124:127], v[32:35], v[40:55]
    ds_read_b128 v[112:115], v2 offset:2048
    ds_read_b32 v120, v3 offset:256
    ds_read_b128 v[140:143], v4 offset:2016
    v_exp_f32 v64, v64
    v_exp_f32 v65, v65
    v_exp_f32 v66, v66
    v_exp_f32 v67, v67
    v_cvt_pk_bf16_f32 v106, v60, v61
    v_cvt_pk_bf16_f32 v107, v62, v63
    v_exp_f32 v68, v68
    v_exp_f32 v69, v69
    v_mfma_f32_32x32x16_bf16 v[88:103], v[128:131], v[104:107], v[88:103]
    v_exp_f32 v70, v70
    v_exp_f32 v71, v71
    v_cvt_pk_bf16_f32 v108, v64, v65
    v_cvt_pk_bf16_f32 v109, v66, v67
    v_cvt_pk_bf16_f32 v110, v68, v69
    v_cvt_pk_bf16_f32 v111, v70, v71
    v_mfma_f32_32x32x16_bf16 v[56:71], v[116:119], v[28:31], 0
    ds_read_b128 v[128:131], v4 offset:2688
    v_exp_f32 v40, v40
    v_exp_f32 v41, v41
    v_exp_f32 v42, v42
    v_exp_f32 v43, v43
    v_mfma_f32_32x32x16_bf16 v[88:103], v[136:139], v[108:111], v[88:103]
    v_exp_f32 v44, v44
    v_exp_f32 v45, v45
    v_exp_f32 v46, v46
    v_exp_f32 v47, v47
    v_cvt_pk_bf16_f32 v104, v40, v41
    v_cvt_pk_bf16_f32 v105, v42, v43
    v_mfma_f32_32x32x16_bf16 v[56:71], v[124:127], v[36:39], v[56:71]
    v_exp_f32 v48, v48
    v_exp_f32 v49, v49
    v_exp_f32 v50, v50
    v_exp_f32 v51, v51
    v_cvt_pk_bf16_f32 v106, v44, v45
    v_cvt_pk_bf16_f32 v107, v46, v47
    v_exp_f32 v52, v52
    v_exp_f32 v53, v53
    s_waitcnt lgkmcnt(4)
    v_mfma_f32_32x32x16_bf16 v[72:87], v[132:135], v[104:107], v[72:87]
    v_exp_f32 v54, v54
    v_exp_f32 v55, v55
    v_cvt_pk_bf16_f32 v108, v48, v49
    v_cvt_pk_bf16_f32 v109, v50, v51
    v_cvt_pk_bf16_f32 v110, v52, v53
    v_cvt_pk_bf16_f32 v111, v54, v55
    s_waitcnt lgkmcnt(2)
    v_mfma_f32_32x32x16_bf16 v[40:55], v[112:115], v[24:27], 0
    v_exp_f32 v56, v56
    v_exp_f32 v57, v57
    v_exp_f32 v58, v58
    v_exp_f32 v59, v59
    s_waitcnt lgkmcnt(1)
    v_mfma_f32_32x32x16_bf16 v[72:87], v[140:143], v[108:111], v[72:87]
    v_exp_f32 v60, v60
    v_exp_f32 v61, v61
    v_exp_f32 v62, v62
    v_exp_f32 v63, v63
    v_cvt_pk_bf16_f32 v104, v56, v57
    v_cvt_pk_bf16_f32 v105, v58, v59
    v_mfma_f32_32x32x16_bf16 v[40:55], v[120:123], v[32:35], v[40:55]
    ds_read_b128 v[116:119], v2 offset:3072
    ds_read_b32 v124, v3 offset:384
    ds_read_b128 v[136:139], v4 offset:3360
    v_exp_f32 v64, v64
    v_exp_f32 v65, v65
    v_exp_f32 v66, v66
    v_exp_f32 v67, v67
    v_cvt_pk_bf16_f32 v106, v60, v61
    v_cvt_pk_bf16_f32 v107, v62, v63
    v_exp_f32 v68, v68
    v_exp_f32 v69, v69
    v_mfma_f32_32x32x16_bf16 v[88:103], v[132:135], v[104:107], v[88:103]
    v_exp_f32 v70, v70
    v_exp_f32 v71, v71
    v_cvt_pk_bf16_f32 v108, v64, v65
    v_cvt_pk_bf16_f32 v109, v66, v67
    v_cvt_pk_bf16_f32 v110, v68, v69
    v_cvt_pk_bf16_f32 v111, v70, v71
    v_mfma_f32_32x32x16_bf16 v[56:71], v[112:115], v[28:31], 0
    ds_read_b128 v[132:135], v4 offset:4032
    v_exp_f32 v40, v40
    v_exp_f32 v41, v41
    v_exp_f32 v42, v42
    v_exp_f32 v43, v43
    v_mfma_f32_32x32x16_bf16 v[88:103], v[140:143], v[108:111], v[88:103]
    v_exp_f32 v44, v44
    v_exp_f32 v45, v45
    v_exp_f32 v46, v46
    v_exp_f32 v47, v47
    v_cvt_pk_bf16_f32 v104, v40, v41
    v_cvt_pk_bf16_f32 v105, v42, v43
    v_mfma_f32_32x32x16_bf16 v[56:71], v[120:123], v[36:39], v[56:71]
    v_exp_f32 v48, v48
    v_exp_f32 v49, v49
    v_exp_f32 v50, v50
    v_exp_f32 v51, v51
    v_cvt_pk_bf16_f32 v106, v44, v45
    v_cvt_pk_bf16_f32 v107, v46, v47
    v_exp_f32 v52, v52
    v_exp_f32 v53, v53
    s_waitcnt lgkmcnt(4)
    v_mfma_f32_32x32x16_bf16 v[72:87], v[128:131], v[104:107], v[72:87]
    v_exp_f32 v54, v54
    v_exp_f32 v55, v55
    v_cvt_pk_bf16_f32 v108, v48, v49
    v_cvt_pk_bf16_f32 v109, v50, v51
    v_cvt_pk_bf16_f32 v110, v52, v53
    v_cvt_pk_bf16_f32 v111, v54, v55
    s_waitcnt lgkmcnt(2)
    v_mfma_f32_32x32x16_bf16 v[40:55], v[116:119], v[24:27], 0
    v_exp_f32 v56, v56
    v_exp_f32 v57, v57
    v_exp_f32 v58, v58
    v_exp_f32 v59, v59
    s_waitcnt lgkmcnt(1)
    v_mfma_f32_32x32x16_bf16 v[72:87], v[136:139], v[108:111], v[72:87]
    v_exp_f32 v60, v60
    v_exp_f32 v61, v61
    v_exp_f32 v62, v62
    v_exp_f32 v63, v63
    v_cvt_pk_bf16_f32 v104, v56, v57
    v_cvt_pk_bf16_f32 v105, v58, v59
    v_mfma_f32_32x32x16_bf16 v[40:55], v[124:127], v[32:35], v[40:55]
    ds_read_b128 v[140:143], v4 offset:4704
    v_exp_f32 v64, v64
    v_exp_f32 v65, v65
    v_exp_f32 v66, v66
    v_exp_f32 v67, v67
    v_cvt_pk_bf16_f32 v106, v60, v61
    v_cvt_pk_bf16_f32 v107, v62, v63
    v_exp_f32 v68, v68
    v_exp_f32 v69, v69
    v_mfma_f32_32x32x16_bf16 v[88:103], v[128:131], v[104:107], v[88:103]
    v_exp_f32 v70, v70
    v_exp_f32 v71, v71
    v_cvt_pk_bf16_f32 v108, v64, v65
    v_cvt_pk_bf16_f32 v109, v66, v67
    v_cvt_pk_bf16_f32 v110, v68, v69
    v_cvt_pk_bf16_f32 v111, v70, v71
    v_mfma_f32_32x32x16_bf16 v[56:71], v[116:119], v[28:31], 0
    v_exp_f32 v40, v40
    v_exp_f32 v41, v41
    v_exp_f32 v42, v42
    v_exp_f32 v43, v43
    v_mfma_f32_32x32x16_bf16 v[88:103], v[136:139], v[108:111], v[88:103]
    v_exp_f32 v44, v44
    v_exp_f32 v45, v45
    v_exp_f32 v46, v46
    v_exp_f32 v47, v47
    v_cvt_pk_bf16_f32 v104, v40, v41
    v_cvt_pk_bf16_f32 v105, v42, v43
    v_mfma_f32_32x32x16_bf16 v[56:71], v[124:127], v[36:39], v[56:71]
    v_exp_f32 v48, v48
    v_exp_f32 v49, v49
    v_exp_f32 v50, v50
    v_exp_f32 v51, v51
    v_cvt_pk_bf16_f32 v106, v44, v45
    v_cvt_pk_bf16_f32 v107, v46, v47
    v_exp_f32 v52, v52
    v_exp_f32 v53, v53
    s_waitcnt lgkmcnt(1)
    v_mfma_f32_32x32x16_bf16 v[72:87], v[132:135], v[104:107], v[72:87]
    v_exp_f32 v54, v54
    v_exp_f32 v55, v55
    v_cvt_pk_bf16_f32 v108, v48, v49
    v_cvt_pk_bf16_f32 v109, v50, v51
    v_cvt_pk_bf16_f32 v110, v52, v53
    v_cvt_pk_bf16_f32 v111, v54, v55
    v_exp_f32 v56, v56
    v_exp_f32 v57, v57
    v_exp_f32 v58, v58
    v_exp_f32 v59, v59
    s_waitcnt lgkmcnt(0)
    v_mfma_f32_32x32x16_bf16 v[72:87], v[140:143], v[108:111], v[72:87]
    v_exp_f32 v60, v60
    v_exp_f32 v61, v61
    v_exp_f32 v62, v62
    v_exp_f32 v63, v63
    v_cvt_pk_bf16_f32 v104, v56, v57
    v_cvt_pk_bf16_f32 v105, v58, v59
    v_exp_f32 v64, v64
    v_exp_f32 v65, v65
    v_exp_f32 v66, v66
    v_exp_f32 v67, v67
    v_cvt_pk_bf16_f32 v106, v60, v61
    v_cvt_pk_bf16_f32 v107, v62, v63
    v_exp_f32 v68, v68
    v_exp_f32 v69, v69
    v_mfma_f32_32x32x16_bf16 v[88:103], v[132:135], v[104:107], v[88:103]
    v_exp_f32 v70, v70
    v_exp_f32 v71, v71
    v_cvt_pk_bf16_f32 v108, v64, v65
    v_cvt_pk_bf16_f32 v109, v66, v67
    v_cvt_pk_bf16_f32 v110, v68, v69
    v_cvt_pk_bf16_f32 v111, v70, v71
    s_nop 1
    v_mfma_f32_32x32x16_bf16 v[88:103], v[140:143], v[108:111], v[88:103]
    s_nop 7
    s_nop 7
    s_barrier
    s_cmp_lt_u32 s32, 6
    s_cbranch_scc0 .Lk1wd_331
    s_add_u32 m0, s65, 73728
    s_add_u32 s52, s61, 0
    buffer_load_dwordx4 v175, s[36:39], s52 offen lds
.Lk1wd_331:
    s_cmp_lt_u32 s32, 6
    s_cbranch_scc0 .Lk1wd_332
    s_add_u32 m0, s65, 74752
    s_add_u32 s52, s61, 0
    buffer_load_dwordx4 v176, s[36:39], s52 offen lds
.Lk1wd_332:
    s_cmp_lt_u32 s32, 6
    s_cbranch_scc0 .Lk1wd_333
    s_add_u32 m0, s65, 75776
    s_add_u32 s52, s61, 0
    buffer_load_dwordx4 v177, s[36:39], s52 offen lds
.Lk1wd_333:
    s_cmp_lt_u32 s32, 6
    s_cbranch_scc0 .Lk1wd_334
    s_add_u32 m0, s65, 122112
    s_add_u32 s52, s61, 36864
    buffer_load_dwordx4 v175, s[36:39], s52 offen lds
.Lk1wd_334:
    s_cmp_lt_u32 s32, 6
    s_cbranch_scc0 .Lk1wd_335
    s_add_u32 m0, s65, 123136
    s_add_u32 s52, s61, 36864
    buffer_load_dwordx4 v176, s[36:39], s52 offen lds
.Lk1wd_335:
    s_cmp_lt_u32 s32, 6
    s_cbranch_scc0 .Lk1wd_336
    s_add_u32 m0, s65, 124160
    s_add_u32 s52, s61, 36864
    buffer_load_dwordx4 v177, s[36:39], s52 offen lds
.Lk1wd_336:
    s_waitcnt vmcnt(0)
    s_mov_b32 s95, 1
    s_branch .Lk1epi_191
    s_endpgm
.section .rodata,"a"
.p2align 6
.amdhsa_kernel gated_mix__grouped_kv_mqa__dense_activation_relu__prompt_kernel
  .amdhsa_next_free_vgpr 256
  .amdhsa_next_free_sgpr 102
  .amdhsa_accum_offset 256
  .amdhsa_group_segment_fixed_size 0
  .amdhsa_kernarg_size 96
  .amdhsa_user_sgpr_count 2
  .amdhsa_user_sgpr_kernarg_segment_ptr 1
  .amdhsa_system_sgpr_workgroup_id_x 1
  .amdhsa_float_denorm_mode_32 3
.end_amdhsa_kernel
```
